```python
import torch

def _softmax(x, axis=-1):
    return torch.softmax(x, dim=axis)
def _gelu(x):
    return torch.nn.functional.gelu(x, approximate="tanh")
def _silu(x):
    return torch.nn.functional.silu(x)
def _sigmoid(x):
    return torch.sigmoid(x)
def _layernorm(x, axis=-1, eps=1e-5):
    m = x.mean(dim=axis, keepdim=True)
    v = x.var(dim=axis, keepdim=True, unbiased=False)
    return (x - m) / torch.sqrt(v + eps)
def _scatter_add(tgt, idx, src, axis=0):
    return tgt.clone().index_add_(axis, idx, src)
def _segment_sum(src, seg, n):
    out = torch.zeros((n,) + src.shape[1:], dtype=src.dtype)
    return out.index_add_(0, seg, src)
def _pad(x, pw):
    flat = tuple(v for pair in reversed(pw) for v in pair)
    return torch.nn.functional.pad(x, flat)

kernel_name = 'parallel_sum__softmax_full_mha__glu_gated_geglu__prompt'

def setup_inputs():

    _w = (lambda a: (lambda t: t.to(torch.bfloat16) if t.is_floating_point() else t)(torch.as_tensor(a)))
    def _A_setup():
        B, S, D = 1, 2048, 576
        return {
            "x": _w((lambda *s: torch.randn(*s, dtype=torch.bfloat16) * 0.05)(B, S, D)),
            "wqkv": _w((lambda *s: torch.randn(*s, dtype=torch.bfloat16) * 0.05)(D, 3 * D)),
            "wo": _w((lambda *s: torch.randn(*s, dtype=torch.bfloat16) * 0.05)(D, D)),
        }
    _A_in = _A_setup()

    def _B_setup():
        B, S, Dm, Df = 1, 2048, 576, 4608
        return {
            "x": _w((lambda *s: torch.randn(*s, dtype=torch.bfloat16) * 0.05)(B, S, Dm)),
            "w_gate": _w((lambda *s: torch.randn(*s, dtype=torch.bfloat16) * 0.8)(Dm, Df) * (Dm ** -0.5)),
            "w_up": _w((lambda *s: torch.randn(*s, dtype=torch.bfloat16) * 0.8)(Dm, Df) * (Dm ** -0.5)),
            "w_down": _w((lambda *s: torch.randn(*s, dtype=torch.bfloat16) * 0.8)(Df, Dm) * (Df ** -0.5)),
        }
    _B_in = _B_setup()

    return {
        "A_x": _A_in["x"],
        "A_wqkv": _A_in["wqkv"],
        "A_wo": _A_in["wo"],
        "B_x": _B_in["x"],
        "B_w_gate": _B_in["w_gate"],
        "B_w_up": _B_in["w_up"],
        "B_w_down": _B_in["w_down"],
    }

def reference(A_x, A_wqkv, A_wo, B_x, B_w_gate, B_w_up, B_w_down):
    def _A_ref(x, wqkv, wo):
        B, S, D = x.shape
        H = 32; Dh = D // H
        qkv = (lambda x, *d: x.permute(*d))((x @ wqkv).reshape(B, S, 3, H, Dh), 2, 0, 3, 1, 4)
        q, k, v = qkv[0], qkv[1], qkv[2]
        scale = Dh ** -0.5
        scores = torch.einsum("bhqd,bhkd->bhqk", q, k) * scale
        p = _softmax(scores, axis=-1)
        o = torch.einsum("bhqk,bhkd->bhqd", p, v)
        return (lambda x, *d: x.permute(*d))(o, 0, 2, 1, 3).reshape(B, S, D) @ wo

    def _B_ref(x, w_gate, w_up, w_down):
        g = torch.einsum("bsd,df->bsf", x, w_gate)
        u = torch.einsum("bsd,df->bsf", x, w_up)
        h = _gelu(g) * u
        return torch.einsum("bsf,fd->bsd", h, w_down)

    x = A_x
    xn = _layernorm(x, axis=-1)
    return x + _A_ref(xn, A_wqkv, A_wo) + _B_ref(xn, B_w_gate, B_w_up, B_w_down)
```

```asm
; @launch grid=(256,1,1) block=(256,1,1) lds=155920
.amdgcn_target "amdgcn-amd-amdhsa--gfx950"
.macro MA d, a, b, c
v_mfma_f32_16x16x32_bf16 \d, \a, \b, \c
.endm
.macro MB d, a, b, c
v_mfma_f32_32x32x16_bf16 \d, \a, \b, \c
.endm
.macro RT d, a, o
ds_read_b64_tr_b16 \d, \a offset:\o
.endm
.macro CV d, a, b
v_cvt_pk_bf16_f32 \d, \a, \b
.endm
.macro WL n
s_waitcnt lgkmcnt(\n)
.endm
.text
.globl parallel_sum__softmax_full_mha__glu_gated_geglu__prompt_kernel
.p2align 8
.type parallel_sum__softmax_full_mha__glu_gated_geglu__prompt_kernel,@function
parallel_sum__softmax_full_mha__glu_gated_geglu__prompt_kernel:
s_cmp_lt_u32 s2,256
s_cbranch_scc1 L_la_go
s_endpgm
L_la_go:
s_load_dwordx2 s[6:7],s[0:1],0
s_load_dwordx2 s[8:9],s[0:1],8
s_load_dwordx4 s[12:15],s[0:1],32
s_load_dwordx2 s[10:11],s[0:1],48
s_load_dwordx4 s[16:19],s[0:1],64
s_getpc_b64 s[20:21]
L_pc_ref:
s_lshr_b32 s22,s2,3
s_mul_i32 s22,s22,24
v_and_b32 v2,63,v0
v_min_u32 v2,23,v2
v_add_u32 v2,s22,v2
v_lshlrev_b32 v2,7,v2
v_min_u32 v2,L_code_end-L_pc_ref-8,v2
v_mov_b32 v3,s21
v_add_co_u32 v2,vcc,s20,v2
s_nop 1
v_addc_co_u32 v3,vcc,0,v3,vcc
s_mov_b32 m0,147456
s_nop 0
global_load_lds_dword v[2:3],off
v_lshrrev_b32 v9,6,v0
v_and_b32 v252,63,v0
v_mov_b32 v253,v0
v_readfirstlane_b32 s3,v9
s_and_b32 s64,s2,7
s_bfe_u32 s63,s2,0x10003
s_lshr_b32 s4,s2,4
v_lshrrev_b32 v9,3,v252
v_and_b32 v10,6,v9
v_and_b32 v11,7,v252
v_xor_b32 v10,v10,v11
v_mul_u32_u24 v9,1152,v9
v_lshl_add_u32 v27,v10,4,v9
s_lshl_b32 s72,s4,7
s_lshl_b32 s73,s3,5
s_add_u32 s72,s72,s73
s_mul_i32 s72,s72,1152
s_mul_i32 s69,s3,36864
WL 0
s_add_u32 s20,s6,s72
s_addc_u32 s21,s7,0
s_sub_u32 s22,2359296,s72
s_mov_b32 s23,0x20000
s_lshl_b32 s72,s2,10
s_add_u32 s72,s72,53739520
v_mov_b32 v9,s72
v_mov_b32 v12,0
v_mov_b32 v13,0
v_mov_b32 v14,0
v_mov_b32 v15,0
global_store_dwordx4 v9,v[12:15],s[18:19] sc1
s_cmp_lg_u32 s63,0
s_cbranch_scc1 L_role_a
s_add_u32 m0,s69,0
s_mov_b32 s70,0
buffer_load_dwordx4 v27,s[20:23],s70 offen lds
v_and_b32 v9,7,v252
v_and_b32 v10,6,v9
v_lshrrev_b32 v11,4,v252
v_xor_b32 v10,v10,v11
v_lshlrev_b32 v9,7,v9
v_lshl_add_u32 v9,v10,4,v9
v_bfe_u32 v10,v252,3,1
v_mul_u32_u24 v10,9216,v10
v_add_u32 v9,v9,v10
v_add_u32 v78,s69,v9
v_xor_b32 v79,64,v78
s_add_u32 m0,s69,9216
s_mov_b32 s70,9216
buffer_load_dwordx4 v27,s[20:23],s70 offen lds
s_lshr_b32 s75,s3,1
s_mul_i32 s72,s75,147456
s_mul_i32 s73,s64,1152
s_add_u32 s72,s72,s73
s_add_u32 s28,s12,s72
s_addc_u32 s29,s13,0
s_sub_u32 s30,5308416,s72
s_mov_b32 s31,0x20000
s_add_u32 m0,s69,18432
s_mov_b32 s70,18432
buffer_load_dwordx4 v27,s[20:23],s70 offen lds
s_add_u32 s32,s14,s72
s_addc_u32 s33,s15,0
s_sub_u32 s34,5308416,s72
s_mov_b32 s35,0x20000
s_add_u32 m0,s69,27648
s_mov_b32 s70,27648
buffer_load_dwordx4 v27,s[20:23],s70 offen lds
s_add_u32 m0,s69,1024
s_mov_b32 s70,128
buffer_load_dwordx4 v27,s[20:23],s70 offen lds
s_and_b32 s72,s3,1
s_lshl_b32 s72,s72,4
s_lshl_b32 s73,s75,3
s_add_u32 s72,s72,s73
s_mul_i32 s72,s72,1152
s_mul_i32 s73,s64,663552
s_add_u32 s72,s72,s73
s_add_u32 m0,s69,10240
s_mov_b32 s70,9344
buffer_load_dwordx4 v27,s[20:23],s70 offen lds
s_add_u32 s36,s10,s72
s_addc_u32 s37,s11,0
s_sub_u32 s38,5308416,s72
s_mov_b32 s39,0x20000
s_sub_u32 s36,s36,4096
s_subb_u32 s37,s37,0
s_add_u32 s38,s38,4096
s_add_u32 m0,s69,19456
s_mov_b32 s70,18560
buffer_load_dwordx4 v27,s[20:23],s70 offen lds
s_mov_b32 s40,s18
s_mov_b32 s41,s19
s_mov_b32 s42,54001664
s_mov_b32 s43,0x20000
s_add_u32 m0,s69,28672
s_mov_b32 s70,27776
buffer_load_dwordx4 v27,s[20:23],s70 offen lds
s_add_u32 m0,s69,2048
s_mov_b32 s70,256
buffer_load_dwordx4 v27,s[20:23],s70 offen lds
s_bitcmp1_b32 s3,0
s_mov_b32 s44,0
s_cselect_b32 s44,1216512,s44
s_mov_b32 s53,4096
s_add_u32 m0,s69,11264
s_mov_b32 s70,9472
buffer_load_dwordx4 v27,s[20:23],s70 offen lds
s_bitcmp1_b32 s3,0
s_mov_b32 s45,35840
s_cselect_b32 s45,1473536,s45
s_mov_b32 s54,3200
s_add_u32 m0,s69,20480
s_mov_b32 s70,18688
buffer_load_dwordx4 v27,s[20:23],s70 offen lds
s_bitcmp1_b32 s3,0
s_mov_b32 s46,292864
s_cselect_b32 s46,1509376,s46
s_mov_b32 s55,2304
s_add_u32 m0,s69,29696
s_mov_b32 s70,27904
buffer_load_dwordx4 v27,s[20:23],s70 offen lds
s_add_u32 m0,s69,3072
s_mov_b32 s70,384
buffer_load_dwordx4 v27,s[20:23],s70 offen lds
s_bitcmp1_b32 s3,0
s_mov_b32 s47,328704
s_cselect_b32 s47,1766400,s47
s_mov_b32 s56,1408
s_add_u32 m0,s69,12288
s_mov_b32 s70,9600
buffer_load_dwordx4 v27,s[20:23],s70 offen lds
s_bitcmp1_b32 s3,0
s_mov_b32 s48,589824
s_cselect_b32 s48,1806336,s48
s_mov_b32 s57,4608
s_add_u32 m0,s69,21504
s_mov_b32 s70,18816
buffer_load_dwordx4 v27,s[20:23],s70 offen lds
s_bitcmp1_b32 s3,0
s_mov_b32 s49,625664
s_cselect_b32 s49,2063360,s49
s_mov_b32 s58,3712
s_add_u32 m0,s69,30720
s_mov_b32 s70,28032
buffer_load_dwordx4 v27,s[20:23],s70 offen lds
s_add_u32 m0,s69,4096
s_mov_b32 s70,512
buffer_load_dwordx4 v27,s[20:23],s70 offen lds
s_bitcmp1_b32 s3,0
s_mov_b32 s50,882688
s_cselect_b32 s50,2099200,s50
s_mov_b32 s59,2816
s_add_u32 m0,s69,13312
s_mov_b32 s70,9728
buffer_load_dwordx4 v27,s[20:23],s70 offen lds
s_bitcmp1_b32 s3,0
s_mov_b32 s51,918528
s_cselect_b32 s51,2356224,s51
s_mov_b32 s60,1920
s_add_u32 m0,s69,22528
s_mov_b32 s70,18944
buffer_load_dwordx4 v27,s[20:23],s70 offen lds
s_bitcmp1_b32 s3,0
s_mov_b32 s52,1179648
s_cselect_b32 s52,2396160,s52
s_mov_b32 s61,5120
s_add_u32 m0,s69,31744
s_mov_b32 s70,28160
buffer_load_dwordx4 v27,s[20:23],s70 offen lds
s_add_u32 m0,s69,5120
s_mov_b32 s70,640
buffer_load_dwordx4 v27,s[20:23],s70 offen lds
s_mul_i32 s71,s3,9216
s_mov_b32 s65,s71
s_add_u32 s66,s71,73728
s_mov_b32 s67,73728
s_mov_b32 s68,1
s_add_u32 m0,s69,14336
s_mov_b32 s70,9856
buffer_load_dwordx4 v27,s[20:23],s70 offen lds
v_and_b32 v9,31,v252
v_lshlrev_b32 v9,3,v9
v_lshrrev_b32 v10,5,v252
v_mul_u32_u24 v10,18432,v10
v_add_u32 v0,v9,v10
s_add_u32 m0,s69,23552
s_mov_b32 s70,19072
buffer_load_dwordx4 v27,s[20:23],s70 offen lds
v_bfe_u32 v9,v252,3,1
v_lshlrev_b32 v9,3,v9
v_bfe_u32 v10,v252,1,2
v_add_u32 v9,v9,v10
v_mul_u32_u24 v9,9216,v9
v_lshrrev_b32 v10,4,v252
v_lshl_add_u32 v9,v10,5,v9
v_and_b32 v10,1,v252
v_lshl_add_u32 v1,v10,4,v9
s_add_u32 m0,s69,32768
s_mov_b32 s70,28288
buffer_load_dwordx4 v27,s[20:23],s70 offen lds
s_add_u32 m0,s69,6144
s_mov_b32 s70,768
buffer_load_dwordx4 v27,s[20:23],s70 offen lds
v_bfe_u32 v9,v252,1,3
v_mul_u32_u24 v9,1152,v9
v_lshrrev_b32 v11,4,v252
v_lshl_add_u32 v9,v11,5,v9
v_lshl_add_u32 v2,v10,4,v9
s_add_u32 m0,s69,15360
s_mov_b32 s70,9984
buffer_load_dwordx4 v27,s[20:23],s70 offen lds
s_lshl_b32 s72,s4,2
s_add_u32 s72,s72,s3
s_mul_i32 s87,s64,2359296
s_mul_i32 s73,s72,36864
s_add_u32 s87,s87,s73
s_add_u32 s87,s87,8388608
s_add_u32 m0,s69,24576
s_mov_b32 s70,19200
buffer_load_dwordx4 v27,s[20:23],s70 offen lds
s_cmp_eq_u32 s3,2
s_mov_b32 s76,9216
s_cselect_b32 s76,128,s76
s_mov_b32 s93,128
s_cselect_b32 s93,73728,s93
s_add_u32 m0,s69,33792
s_mov_b32 s70,28416
buffer_load_dwordx4 v27,s[20:23],s70 offen lds
s_add_u32 m0,s69,7168
s_mov_b32 s70,896
buffer_load_dwordx4 v27,s[20:23],s70 offen lds
s_mul_i32 s77,s4,36
v_add_u32 v9,s77,v252
v_mul_lo_u32 v7,v9,s76
v_mov_b32 v10,0x80000000
v_cmp_gt_u32 vcc,36,v252
s_nop 1
v_cndmask_b32 v7,v10,v7,vcc
s_add_u32 m0,s69,16384
s_mov_b32 s70,10112
buffer_load_dwordx4 v27,s[20:23],s70 offen lds
s_cmp_eq_u32 s3,2
s_mov_b32 s72,1152
s_cselect_b32 s72,663552,s72
s_mul_i32 s72,s72,s64
s_add_u32 m0,s69,25600
s_mov_b32 s70,19328
buffer_load_dwordx4 v27,s[20:23],s70 offen lds
s_cmp_eq_u32 s3,1
s_cselect_b32 s73,s14,s12
s_cselect_b32 s74,s15,s13
s_cmp_eq_u32 s3,2
s_cselect_b32 s73,s10,s73
s_cselect_b32 s74,s11,s74
s_add_u32 s24,s73,s72
s_addc_u32 s25,s74,0
s_sub_u32 s26,5308416,s72
s_cmp_eq_u32 s3,3
s_cselect_b32 s26,0,s26
s_mov_b32 s27,0x20000
s_mul_i32 s92,s93,0
s_add_u32 m0,s69,34816
s_mov_b32 s70,28544
buffer_load_dwordx4 v27,s[20:23],s70 offen lds
s_add_u32 m0,s69,8192
s_mov_b32 s70,1024
buffer_load_dwordx4 v27,s[20:23],s70 offen lds
s_add_u32 m0,s69,17408
s_mov_b32 s70,10240
buffer_load_dwordx4 v27,s[20:23],s70 offen lds
s_add_u32 m0,s69,26624
s_mov_b32 s70,19456
buffer_load_dwordx4 v27,s[20:23],s70 offen lds
s_add_u32 m0,s69,35840
s_mov_b32 s70,28672
buffer_load_dwordx4 v27,s[20:23],s70 offen lds
s_mov_b32 m0,147456
s_nop 0
buffer_load_dword v7,s[24:27],s92 offen lds
s_add_u32 s92,s92,s93
v_mov_b32 v48,0
v_mov_b32 v49,0
v_mov_b32 v50,0
v_mov_b32 v51,0
v_mov_b32 v52,0
v_mov_b32 v53,0
v_mov_b32 v54,0
v_mov_b32 v55,0
v_mov_b32 v56,0
v_mov_b32 v57,0
v_mov_b32 v58,0
v_mov_b32 v59,0
v_mov_b32 v60,0
v_mov_b32 v61,0
v_mov_b32 v62,0
v_mov_b32 v63,0
s_mov_b32 s72,0x3f803f80
s_waitcnt vmcnt(33)
ds_read_b128 v[80:83],v78 offset:0
ds_read_b128 v[88:91],v79 offset:0
ds_read_b128 v[84:87],v78 offset:18432
ds_read_b128 v[92:95],v79 offset:18432
s_waitcnt vmcnt(29)
ds_read_b128 v[96:99],v78 offset:1024
ds_read_b128 v[104:107],v79 offset:1024
ds_read_b128 v[100:103],v78 offset:19456
ds_read_b128 v[108:111],v79 offset:19456
s_waitcnt vmcnt(25)
ds_read_b128 v[112:115],v78 offset:2048
ds_read_b128 v[120:123],v79 offset:2048
ds_read_b128 v[116:119],v78 offset:20480
ds_read_b128 v[124:127],v79 offset:20480
s_waitcnt vmcnt(21)
ds_read_b128 v[128:131],v78 offset:3072
ds_read_b128 v[136:139],v79 offset:3072
ds_read_b128 v[132:135],v78 offset:21504
ds_read_b128 v[140:143],v79 offset:21504
WL 15
v_dot2c_f32_bf16 v48,s72,v80
v_dot2c_f32_bf16 v49,s72,v81
v_dot2c_f32_bf16 v50,s72,v82
v_dot2c_f32_bf16 v51,s72,v83
v_dot2c_f32_bf16 v52,v80,v80
v_dot2c_f32_bf16 v53,v81,v81
v_dot2c_f32_bf16 v54,v82,v82
v_dot2c_f32_bf16 v55,v83,v83
WL 14
v_dot2c_f32_bf16 v48,s72,v88
v_dot2c_f32_bf16 v49,s72,v89
v_dot2c_f32_bf16 v50,s72,v90
v_dot2c_f32_bf16 v51,s72,v91
v_dot2c_f32_bf16 v52,v88,v88
v_dot2c_f32_bf16 v53,v89,v89
v_dot2c_f32_bf16 v54,v90,v90
v_dot2c_f32_bf16 v55,v91,v91
WL 13
v_dot2c_f32_bf16 v56,s72,v84
v_dot2c_f32_bf16 v57,s72,v85
v_dot2c_f32_bf16 v58,s72,v86
v_dot2c_f32_bf16 v59,s72,v87
v_dot2c_f32_bf16 v60,v84,v84
v_dot2c_f32_bf16 v61,v85,v85
v_dot2c_f32_bf16 v62,v86,v86
v_dot2c_f32_bf16 v63,v87,v87
WL 12
v_dot2c_f32_bf16 v56,s72,v92
v_dot2c_f32_bf16 v57,s72,v93
v_dot2c_f32_bf16 v58,s72,v94
v_dot2c_f32_bf16 v59,s72,v95
v_dot2c_f32_bf16 v60,v92,v92
v_dot2c_f32_bf16 v61,v93,v93
v_dot2c_f32_bf16 v62,v94,v94
v_dot2c_f32_bf16 v63,v95,v95
s_waitcnt vmcnt(17)
ds_read_b128 v[144:147],v78 offset:4096
ds_read_b128 v[152:155],v79 offset:4096
ds_read_b128 v[148:151],v78 offset:22528
ds_read_b128 v[156:159],v79 offset:22528
WL 15
v_dot2c_f32_bf16 v48,s72,v96
v_dot2c_f32_bf16 v49,s72,v97
v_dot2c_f32_bf16 v50,s72,v98
v_dot2c_f32_bf16 v51,s72,v99
v_dot2c_f32_bf16 v52,v96,v96
v_dot2c_f32_bf16 v53,v97,v97
v_dot2c_f32_bf16 v54,v98,v98
v_dot2c_f32_bf16 v55,v99,v99
WL 14
v_dot2c_f32_bf16 v48,s72,v104
v_dot2c_f32_bf16 v49,s72,v105
v_dot2c_f32_bf16 v50,s72,v106
v_dot2c_f32_bf16 v51,s72,v107
v_dot2c_f32_bf16 v52,v104,v104
v_dot2c_f32_bf16 v53,v105,v105
v_dot2c_f32_bf16 v54,v106,v106
v_dot2c_f32_bf16 v55,v107,v107
WL 13
v_dot2c_f32_bf16 v56,s72,v100
v_dot2c_f32_bf16 v57,s72,v101
v_dot2c_f32_bf16 v58,s72,v102
v_dot2c_f32_bf16 v59,s72,v103
v_dot2c_f32_bf16 v60,v100,v100
v_dot2c_f32_bf16 v61,v101,v101
v_dot2c_f32_bf16 v62,v102,v102
v_dot2c_f32_bf16 v63,v103,v103
WL 12
v_dot2c_f32_bf16 v56,s72,v108
v_dot2c_f32_bf16 v57,s72,v109
v_dot2c_f32_bf16 v58,s72,v110
v_dot2c_f32_bf16 v59,s72,v111
v_dot2c_f32_bf16 v60,v108,v108
v_dot2c_f32_bf16 v61,v109,v109
v_dot2c_f32_bf16 v62,v110,v110
v_dot2c_f32_bf16 v63,v111,v111
s_waitcnt vmcnt(13)
ds_read_b128 v[160:163],v78 offset:5120
ds_read_b128 v[168:171],v79 offset:5120
ds_read_b128 v[164:167],v78 offset:23552
ds_read_b128 v[172:175],v79 offset:23552
WL 15
v_dot2c_f32_bf16 v48,s72,v112
v_dot2c_f32_bf16 v49,s72,v113
v_dot2c_f32_bf16 v50,s72,v114
v_dot2c_f32_bf16 v51,s72,v115
v_dot2c_f32_bf16 v52,v112,v112
v_dot2c_f32_bf16 v53,v113,v113
v_dot2c_f32_bf16 v54,v114,v114
v_dot2c_f32_bf16 v55,v115,v115
WL 14
v_dot2c_f32_bf16 v48,s72,v120
v_dot2c_f32_bf16 v49,s72,v121
v_dot2c_f32_bf16 v50,s72,v122
v_dot2c_f32_bf16 v51,s72,v123
v_dot2c_f32_bf16 v52,v120,v120
v_dot2c_f32_bf16 v53,v121,v121
v_dot2c_f32_bf16 v54,v122,v122
v_dot2c_f32_bf16 v55,v123,v123
WL 13
v_dot2c_f32_bf16 v56,s72,v116
v_dot2c_f32_bf16 v57,s72,v117
v_dot2c_f32_bf16 v58,s72,v118
v_dot2c_f32_bf16 v59,s72,v119
v_dot2c_f32_bf16 v60,v116,v116
v_dot2c_f32_bf16 v61,v117,v117
v_dot2c_f32_bf16 v62,v118,v118
v_dot2c_f32_bf16 v63,v119,v119
WL 12
v_dot2c_f32_bf16 v56,s72,v124
v_dot2c_f32_bf16 v57,s72,v125
v_dot2c_f32_bf16 v58,s72,v126
v_dot2c_f32_bf16 v59,s72,v127
v_dot2c_f32_bf16 v60,v124,v124
v_dot2c_f32_bf16 v61,v125,v125
v_dot2c_f32_bf16 v62,v126,v126
v_dot2c_f32_bf16 v63,v127,v127
s_waitcnt vmcnt(9)
ds_read_b128 v[176:179],v78 offset:6144
ds_read_b128 v[184:187],v79 offset:6144
ds_read_b128 v[180:183],v78 offset:24576
ds_read_b128 v[188:191],v79 offset:24576
WL 15
v_dot2c_f32_bf16 v48,s72,v128
v_dot2c_f32_bf16 v49,s72,v129
v_dot2c_f32_bf16 v50,s72,v130
v_dot2c_f32_bf16 v51,s72,v131
v_dot2c_f32_bf16 v52,v128,v128
v_dot2c_f32_bf16 v53,v129,v129
v_dot2c_f32_bf16 v54,v130,v130
v_dot2c_f32_bf16 v55,v131,v131
WL 14
v_dot2c_f32_bf16 v48,s72,v136
v_dot2c_f32_bf16 v49,s72,v137
v_dot2c_f32_bf16 v50,s72,v138
v_dot2c_f32_bf16 v51,s72,v139
v_dot2c_f32_bf16 v52,v136,v136
v_dot2c_f32_bf16 v53,v137,v137
v_dot2c_f32_bf16 v54,v138,v138
v_dot2c_f32_bf16 v55,v139,v139
WL 13
v_dot2c_f32_bf16 v56,s72,v132
v_dot2c_f32_bf16 v57,s72,v133
v_dot2c_f32_bf16 v58,s72,v134
v_dot2c_f32_bf16 v59,s72,v135
v_dot2c_f32_bf16 v60,v132,v132
v_dot2c_f32_bf16 v61,v133,v133
v_dot2c_f32_bf16 v62,v134,v134
v_dot2c_f32_bf16 v63,v135,v135
WL 12
v_dot2c_f32_bf16 v56,s72,v140
v_dot2c_f32_bf16 v57,s72,v141
v_dot2c_f32_bf16 v58,s72,v142
v_dot2c_f32_bf16 v59,s72,v143
v_dot2c_f32_bf16 v60,v140,v140
v_dot2c_f32_bf16 v61,v141,v141
v_dot2c_f32_bf16 v62,v142,v142
v_dot2c_f32_bf16 v63,v143,v143
s_waitcnt vmcnt(5)
ds_read_b128 v[192:195],v78 offset:7168
ds_read_b128 v[200:203],v79 offset:7168
ds_read_b128 v[196:199],v78 offset:25600
ds_read_b128 v[204:207],v79 offset:25600
WL 15
v_dot2c_f32_bf16 v48,s72,v144
v_dot2c_f32_bf16 v49,s72,v145
v_dot2c_f32_bf16 v50,s72,v146
v_dot2c_f32_bf16 v51,s72,v147
v_dot2c_f32_bf16 v52,v144,v144
v_dot2c_f32_bf16 v53,v145,v145
v_dot2c_f32_bf16 v54,v146,v146
v_dot2c_f32_bf16 v55,v147,v147
WL 14
v_dot2c_f32_bf16 v48,s72,v152
v_dot2c_f32_bf16 v49,s72,v153
v_dot2c_f32_bf16 v50,s72,v154
v_dot2c_f32_bf16 v51,s72,v155
v_dot2c_f32_bf16 v52,v152,v152
v_dot2c_f32_bf16 v53,v153,v153
v_dot2c_f32_bf16 v54,v154,v154
v_dot2c_f32_bf16 v55,v155,v155
WL 13
v_dot2c_f32_bf16 v56,s72,v148
v_dot2c_f32_bf16 v57,s72,v149
v_dot2c_f32_bf16 v58,s72,v150
v_dot2c_f32_bf16 v59,s72,v151
v_dot2c_f32_bf16 v60,v148,v148
v_dot2c_f32_bf16 v61,v149,v149
v_dot2c_f32_bf16 v62,v150,v150
v_dot2c_f32_bf16 v63,v151,v151
WL 12
v_dot2c_f32_bf16 v56,s72,v156
v_dot2c_f32_bf16 v57,s72,v157
v_dot2c_f32_bf16 v58,s72,v158
v_dot2c_f32_bf16 v59,s72,v159
v_dot2c_f32_bf16 v60,v156,v156
v_dot2c_f32_bf16 v61,v157,v157
v_dot2c_f32_bf16 v62,v158,v158
v_dot2c_f32_bf16 v63,v159,v159
s_waitcnt vmcnt(1)
ds_read_b128 v[208:211],v78 offset:8192
ds_read_b128 v[216:219],v79 offset:8192
ds_read_b128 v[212:215],v78 offset:26624
ds_read_b128 v[220:223],v79 offset:26624
WL 15
v_dot2c_f32_bf16 v48,s72,v160
v_dot2c_f32_bf16 v49,s72,v161
v_dot2c_f32_bf16 v50,s72,v162
v_dot2c_f32_bf16 v51,s72,v163
v_dot2c_f32_bf16 v52,v160,v160
v_dot2c_f32_bf16 v53,v161,v161
v_dot2c_f32_bf16 v54,v162,v162
v_dot2c_f32_bf16 v55,v163,v163
WL 14
v_dot2c_f32_bf16 v48,s72,v168
v_dot2c_f32_bf16 v49,s72,v169
v_dot2c_f32_bf16 v50,s72,v170
v_dot2c_f32_bf16 v51,s72,v171
v_dot2c_f32_bf16 v52,v168,v168
v_dot2c_f32_bf16 v53,v169,v169
v_dot2c_f32_bf16 v54,v170,v170
v_dot2c_f32_bf16 v55,v171,v171
WL 13
v_dot2c_f32_bf16 v56,s72,v164
v_dot2c_f32_bf16 v57,s72,v165
v_dot2c_f32_bf16 v58,s72,v166
v_dot2c_f32_bf16 v59,s72,v167
v_dot2c_f32_bf16 v60,v164,v164
v_dot2c_f32_bf16 v61,v165,v165
v_dot2c_f32_bf16 v62,v166,v166
v_dot2c_f32_bf16 v63,v167,v167
WL 12
v_dot2c_f32_bf16 v56,s72,v172
v_dot2c_f32_bf16 v57,s72,v173
v_dot2c_f32_bf16 v58,s72,v174
v_dot2c_f32_bf16 v59,s72,v175
v_dot2c_f32_bf16 v60,v172,v172
v_dot2c_f32_bf16 v61,v173,v173
v_dot2c_f32_bf16 v62,v174,v174
v_dot2c_f32_bf16 v63,v175,v175
WL 0
s_barrier
s_add_u32 m0,s65,0
s_nop 0
buffer_load_dwordx4 v1,s[28:31],s44 offen offset:0 lds
buffer_load_dwordx4 v1,s[28:31],s45 offen offset:1024 lds
buffer_load_dwordx4 v1,s[28:31],s46 offen offset:2048 lds
WL 11
v_dot2c_f32_bf16 v48,s72,v176
v_dot2c_f32_bf16 v49,s72,v177
v_dot2c_f32_bf16 v50,s72,v178
v_dot2c_f32_bf16 v51,s72,v179
v_dot2c_f32_bf16 v52,v176,v176
v_dot2c_f32_bf16 v53,v177,v177
v_dot2c_f32_bf16 v54,v178,v178
v_dot2c_f32_bf16 v55,v179,v179
WL 10
v_dot2c_f32_bf16 v48,s72,v184
v_dot2c_f32_bf16 v49,s72,v185
v_dot2c_f32_bf16 v50,s72,v186
v_dot2c_f32_bf16 v51,s72,v187
v_dot2c_f32_bf16 v52,v184,v184
v_dot2c_f32_bf16 v53,v185,v185
v_dot2c_f32_bf16 v54,v186,v186
v_dot2c_f32_bf16 v55,v187,v187
buffer_load_dwordx4 v1,s[28:31],s47 offen offset:3072 lds
WL 9
v_dot2c_f32_bf16 v56,s72,v180
v_dot2c_f32_bf16 v57,s72,v181
v_dot2c_f32_bf16 v58,s72,v182
v_dot2c_f32_bf16 v59,s72,v183
v_dot2c_f32_bf16 v60,v180,v180
v_dot2c_f32_bf16 v61,v181,v181
v_dot2c_f32_bf16 v62,v182,v182
v_dot2c_f32_bf16 v63,v183,v183
WL 8
v_dot2c_f32_bf16 v56,s72,v188
v_dot2c_f32_bf16 v57,s72,v189
v_dot2c_f32_bf16 v58,s72,v190
v_dot2c_f32_bf16 v59,s72,v191
v_dot2c_f32_bf16 v60,v188,v188
v_dot2c_f32_bf16 v61,v189,v189
v_dot2c_f32_bf16 v62,v190,v190
v_dot2c_f32_bf16 v63,v191,v191
s_add_u32 m0,s65,4096
s_nop 0
buffer_load_dwordx4 v1,s[28:31],s48 offen offset:0 lds
WL 7
v_dot2c_f32_bf16 v48,s72,v192
v_dot2c_f32_bf16 v49,s72,v193
v_dot2c_f32_bf16 v50,s72,v194
v_dot2c_f32_bf16 v51,s72,v195
v_dot2c_f32_bf16 v52,v192,v192
v_dot2c_f32_bf16 v53,v193,v193
v_dot2c_f32_bf16 v54,v194,v194
v_dot2c_f32_bf16 v55,v195,v195
WL 6
v_dot2c_f32_bf16 v48,s72,v200
v_dot2c_f32_bf16 v49,s72,v201
v_dot2c_f32_bf16 v50,s72,v202
v_dot2c_f32_bf16 v51,s72,v203
v_dot2c_f32_bf16 v52,v200,v200
v_dot2c_f32_bf16 v53,v201,v201
v_dot2c_f32_bf16 v54,v202,v202
v_dot2c_f32_bf16 v55,v203,v203
buffer_load_dwordx4 v1,s[28:31],s49 offen offset:1024 lds
WL 5
v_dot2c_f32_bf16 v56,s72,v196
v_dot2c_f32_bf16 v57,s72,v197
v_dot2c_f32_bf16 v58,s72,v198
v_dot2c_f32_bf16 v59,s72,v199
v_dot2c_f32_bf16 v60,v196,v196
v_dot2c_f32_bf16 v61,v197,v197
v_dot2c_f32_bf16 v62,v198,v198
v_dot2c_f32_bf16 v63,v199,v199
WL 4
v_dot2c_f32_bf16 v56,s72,v204
v_dot2c_f32_bf16 v57,s72,v205
v_dot2c_f32_bf16 v58,s72,v206
v_dot2c_f32_bf16 v59,s72,v207
v_dot2c_f32_bf16 v60,v204,v204
v_dot2c_f32_bf16 v61,v205,v205
v_dot2c_f32_bf16 v62,v206,v206
v_dot2c_f32_bf16 v63,v207,v207
buffer_load_dwordx4 v1,s[28:31],s50 offen offset:2048 lds
WL 3
v_dot2c_f32_bf16 v48,s72,v208
v_dot2c_f32_bf16 v49,s72,v209
v_dot2c_f32_bf16 v50,s72,v210
v_dot2c_f32_bf16 v51,s72,v211
v_dot2c_f32_bf16 v52,v208,v208
v_dot2c_f32_bf16 v53,v209,v209
v_dot2c_f32_bf16 v54,v210,v210
v_dot2c_f32_bf16 v55,v211,v211
WL 2
v_dot2c_f32_bf16 v48,s72,v216
v_dot2c_f32_bf16 v49,s72,v217
v_dot2c_f32_bf16 v50,s72,v218
v_dot2c_f32_bf16 v51,s72,v219
v_dot2c_f32_bf16 v52,v216,v216
v_dot2c_f32_bf16 v53,v217,v217
v_dot2c_f32_bf16 v54,v218,v218
v_dot2c_f32_bf16 v55,v219,v219
buffer_load_dwordx4 v1,s[28:31],s51 offen offset:3072 lds
WL 1
v_dot2c_f32_bf16 v56,s72,v212
v_dot2c_f32_bf16 v57,s72,v213
v_dot2c_f32_bf16 v58,s72,v214
v_dot2c_f32_bf16 v59,s72,v215
v_dot2c_f32_bf16 v60,v212,v212
v_dot2c_f32_bf16 v61,v213,v213
v_dot2c_f32_bf16 v62,v214,v214
v_dot2c_f32_bf16 v63,v215,v215
WL 0
v_dot2c_f32_bf16 v56,s72,v220
v_dot2c_f32_bf16 v57,s72,v221
v_dot2c_f32_bf16 v58,s72,v222
v_dot2c_f32_bf16 v59,s72,v223
v_dot2c_f32_bf16 v60,v220,v220
v_dot2c_f32_bf16 v61,v221,v221
v_dot2c_f32_bf16 v62,v222,v222
v_dot2c_f32_bf16 v63,v223,v223
s_add_u32 m0,s65,8192
s_nop 0
buffer_load_dwordx4 v1,s[28:31],s52 offen offset:0 lds
v_add_u32 v1,2654208,v1
s_nop 2
v_add_f32 v48,v48,v49
v_add_f32 v50,v50,v51
v_add_f32 v52,v52,v53
v_add_f32 v54,v54,v55
v_add_f32 v56,v56,v57
v_add_f32 v58,v58,v59
v_add_f32 v60,v60,v61
v_add_f32 v62,v62,v63
v_add_f32 v32,v48,v50
v_add_f32 v34,v52,v54
v_add_f32 v33,v56,v58
v_add_f32 v35,v60,v62
v_mov_b32 v36,v32
v_mov_b32 v37,v33
v_mov_b32 v38,v34
v_mov_b32 v39,v35
s_nop 1
v_permlane32_swap_b32 v32,v36
v_permlane32_swap_b32 v33,v37
v_permlane32_swap_b32 v34,v38
v_permlane32_swap_b32 v35,v39
s_nop 1
v_add_f32 v32,v32,v36
v_add_f32 v33,v33,v37
v_add_f32 v34,v34,v38
v_add_f32 v35,v35,v39
v_mov_b32 v36,v32
v_mov_b32 v37,v33
v_mov_b32 v38,v34
v_mov_b32 v39,v35
s_nop 1
v_permlane16_swap_b32 v32,v36
v_permlane16_swap_b32 v33,v37
v_permlane16_swap_b32 v34,v38
v_permlane16_swap_b32 v35,v39
s_nop 1
v_add_f32 v32,v32,v36
v_add_f32 v33,v33,v37
v_add_f32 v34,v34,v38
v_add_f32 v35,v35,v39
s_mov_b32 s72,0x3ae38e39
s_mov_b32 s73,0x7f800000
s_mov_b32 s74,0x007fffff
v_mul_f32 v32,s72,v32
v_mul_f32 v34,s72,v34
v_fma_f32 v34,-v32,v32,v34
v_max_f32 v34,0,v34
v_add_f32 v34,0x3727c5ac,v34
v_rsq_f32 v34,v34
s_nop 0
v_and_b32 v42,s73,v34
v_lshrrev_b32 v40,16,v42
v_and_b32 v46,s74,v34
v_or_b32 v46,1.0,v46
v_mul_f32 v44,v32,v42
v_sub_f32 v44,0,v44
v_mov_b32 v64,v34
v_mov_b32 v65,v34
v_mul_f32 v66,v32,v34
v_sub_f32 v66,0,v66
v_mov_b32 v67,v66
v_mul_f32 v33,s72,v33
v_mul_f32 v35,s72,v35
v_fma_f32 v35,-v33,v33,v35
v_max_f32 v35,0,v35
v_add_f32 v35,0x3727c5ac,v35
v_rsq_f32 v35,v35
s_nop 0
v_and_b32 v43,s73,v35
v_lshrrev_b32 v41,16,v43
v_and_b32 v47,s74,v35
v_or_b32 v47,1.0,v47
v_mul_f32 v45,v33,v43
v_sub_f32 v45,0,v45
v_mov_b32 v68,v35
v_mov_b32 v69,v35
v_mul_f32 v70,v33,v35
v_sub_f32 v70,0,v70
v_mov_b32 v71,v70
v_mov_b32 v4,0xbdd2d3e8
s_mov_b32 s72,0xffff0000
s_add_u32 m0,s65,36864
s_nop 0
buffer_load_dwordx4 v1,s[28:31],s44 offen offset:0 lds
v_lshlrev_b32 v56,16,v80
v_and_b32 v57,s72,v80
v_lshlrev_b32 v58,16,v81
v_and_b32 v59,s72,v81
v_lshlrev_b32 v60,16,v82
v_and_b32 v61,s72,v82
v_lshlrev_b32 v62,16,v83
v_and_b32 v63,s72,v83
v_pk_fma_f32 v[56:57],v[56:57],v[64:65],v[66:67]
v_pk_fma_f32 v[58:59],v[58:59],v[64:65],v[66:67]
v_pk_fma_f32 v[60:61],v[60:61],v[64:65],v[66:67]
v_pk_fma_f32 v[62:63],v[62:63],v[64:65],v[66:67]
CV v80,v56,v57
CV v81,v58,v59
CV v82,v60,v61
CV v83,v62,v63
v_lshlrev_b32 v56,16,v84
v_and_b32 v57,s72,v84
v_lshlrev_b32 v58,16,v85
v_and_b32 v59,s72,v85
v_lshlrev_b32 v60,16,v86
v_and_b32 v61,s72,v86
v_lshlrev_b32 v62,16,v87
v_and_b32 v63,s72,v87
v_pk_fma_f32 v[56:57],v[56:57],v[68:69],v[70:71]
v_pk_fma_f32 v[58:59],v[58:59],v[68:69],v[70:71]
v_pk_fma_f32 v[60:61],v[60:61],v[68:69],v[70:71]
v_pk_fma_f32 v[62:63],v[62:63],v[68:69],v[70:71]
CV v84,v56,v57
CV v85,v58,v59
CV v86,v60,v61
CV v87,v62,v63
buffer_load_dwordx4 v1,s[28:31],s45 offen offset:1024 lds
v_lshlrev_b32 v56,16,v88
v_and_b32 v57,s72,v88
v_lshlrev_b32 v58,16,v89
v_and_b32 v59,s72,v89
v_lshlrev_b32 v60,16,v90
v_and_b32 v61,s72,v90
v_lshlrev_b32 v62,16,v91
v_and_b32 v63,s72,v91
v_pk_fma_f32 v[56:57],v[56:57],v[64:65],v[66:67]
v_pk_fma_f32 v[58:59],v[58:59],v[64:65],v[66:67]
v_pk_fma_f32 v[60:61],v[60:61],v[64:65],v[66:67]
v_pk_fma_f32 v[62:63],v[62:63],v[64:65],v[66:67]
CV v88,v56,v57
CV v89,v58,v59
CV v90,v60,v61
CV v91,v62,v63
v_lshlrev_b32 v56,16,v92
v_and_b32 v57,s72,v92
v_lshlrev_b32 v58,16,v93
v_and_b32 v59,s72,v93
v_lshlrev_b32 v60,16,v94
v_and_b32 v61,s72,v94
v_lshlrev_b32 v62,16,v95
v_and_b32 v63,s72,v95
v_pk_fma_f32 v[56:57],v[56:57],v[68:69],v[70:71]
v_pk_fma_f32 v[58:59],v[58:59],v[68:69],v[70:71]
v_pk_fma_f32 v[60:61],v[60:61],v[68:69],v[70:71]
v_pk_fma_f32 v[62:63],v[62:63],v[68:69],v[70:71]
CV v92,v56,v57
CV v93,v58,v59
CV v94,v60,v61
CV v95,v62,v63
buffer_load_dwordx4 v1,s[28:31],s46 offen offset:2048 lds
v_lshlrev_b32 v56,16,v96
v_and_b32 v57,s72,v96
v_lshlrev_b32 v58,16,v97
v_and_b32 v59,s72,v97
v_lshlrev_b32 v60,16,v98
v_and_b32 v61,s72,v98
v_lshlrev_b32 v62,16,v99
v_and_b32 v63,s72,v99
v_pk_fma_f32 v[56:57],v[56:57],v[64:65],v[66:67]
v_pk_fma_f32 v[58:59],v[58:59],v[64:65],v[66:67]
v_pk_fma_f32 v[60:61],v[60:61],v[64:65],v[66:67]
v_pk_fma_f32 v[62:63],v[62:63],v[64:65],v[66:67]
CV v96,v56,v57
CV v97,v58,v59
CV v98,v60,v61
CV v99,v62,v63
v_lshlrev_b32 v56,16,v100
v_and_b32 v57,s72,v100
v_lshlrev_b32 v58,16,v101
v_and_b32 v59,s72,v101
v_lshlrev_b32 v60,16,v102
v_and_b32 v61,s72,v102
v_lshlrev_b32 v62,16,v103
v_and_b32 v63,s72,v103
v_pk_fma_f32 v[56:57],v[56:57],v[68:69],v[70:71]
v_pk_fma_f32 v[58:59],v[58:59],v[68:69],v[70:71]
v_pk_fma_f32 v[60:61],v[60:61],v[68:69],v[70:71]
v_pk_fma_f32 v[62:63],v[62:63],v[68:69],v[70:71]
CV v100,v56,v57
CV v101,v58,v59
CV v102,v60,v61
CV v103,v62,v63
buffer_load_dwordx4 v1,s[28:31],s47 offen offset:3072 lds
v_lshlrev_b32 v56,16,v104
v_and_b32 v57,s72,v104
v_lshlrev_b32 v58,16,v105
v_and_b32 v59,s72,v105
v_lshlrev_b32 v60,16,v106
v_and_b32 v61,s72,v106
v_lshlrev_b32 v62,16,v107
v_and_b32 v63,s72,v107
v_pk_fma_f32 v[56:57],v[56:57],v[64:65],v[66:67]
v_pk_fma_f32 v[58:59],v[58:59],v[64:65],v[66:67]
v_pk_fma_f32 v[60:61],v[60:61],v[64:65],v[66:67]
v_pk_fma_f32 v[62:63],v[62:63],v[64:65],v[66:67]
CV v104,v56,v57
CV v105,v58,v59
CV v106,v60,v61
CV v107,v62,v63
v_lshlrev_b32 v56,16,v108
v_and_b32 v57,s72,v108
v_lshlrev_b32 v58,16,v109
v_and_b32 v59,s72,v109
v_lshlrev_b32 v60,16,v110
v_and_b32 v61,s72,v110
v_lshlrev_b32 v62,16,v111
v_and_b32 v63,s72,v111
v_pk_fma_f32 v[56:57],v[56:57],v[68:69],v[70:71]
v_pk_fma_f32 v[58:59],v[58:59],v[68:69],v[70:71]
v_pk_fma_f32 v[60:61],v[60:61],v[68:69],v[70:71]
v_pk_fma_f32 v[62:63],v[62:63],v[68:69],v[70:71]
CV v108,v56,v57
CV v109,v58,v59
CV v110,v60,v61
CV v111,v62,v63
s_add_u32 m0,s65,40960
s_nop 0
buffer_load_dwordx4 v1,s[28:31],s48 offen offset:0 lds
v_lshlrev_b32 v56,16,v112
v_and_b32 v57,s72,v112
v_lshlrev_b32 v58,16,v113
v_and_b32 v59,s72,v113
v_lshlrev_b32 v60,16,v114
v_and_b32 v61,s72,v114
v_lshlrev_b32 v62,16,v115
v_and_b32 v63,s72,v115
v_pk_fma_f32 v[56:57],v[56:57],v[64:65],v[66:67]
v_pk_fma_f32 v[58:59],v[58:59],v[64:65],v[66:67]
v_pk_fma_f32 v[60:61],v[60:61],v[64:65],v[66:67]
v_pk_fma_f32 v[62:63],v[62:63],v[64:65],v[66:67]
CV v112,v56,v57
CV v113,v58,v59
CV v114,v60,v61
CV v115,v62,v63
v_lshlrev_b32 v56,16,v116
v_and_b32 v57,s72,v116
v_lshlrev_b32 v58,16,v117
v_and_b32 v59,s72,v117
v_lshlrev_b32 v60,16,v118
v_and_b32 v61,s72,v118
v_lshlrev_b32 v62,16,v119
v_and_b32 v63,s72,v119
v_pk_fma_f32 v[56:57],v[56:57],v[68:69],v[70:71]
v_pk_fma_f32 v[58:59],v[58:59],v[68:69],v[70:71]
v_pk_fma_f32 v[60:61],v[60:61],v[68:69],v[70:71]
v_pk_fma_f32 v[62:63],v[62:63],v[68:69],v[70:71]
CV v116,v56,v57
CV v117,v58,v59
CV v118,v60,v61
CV v119,v62,v63
buffer_load_dwordx4 v1,s[28:31],s49 offen offset:1024 lds
v_lshlrev_b32 v56,16,v120
v_and_b32 v57,s72,v120
v_lshlrev_b32 v58,16,v121
v_and_b32 v59,s72,v121
v_lshlrev_b32 v60,16,v122
v_and_b32 v61,s72,v122
v_lshlrev_b32 v62,16,v123
v_and_b32 v63,s72,v123
v_pk_fma_f32 v[56:57],v[56:57],v[64:65],v[66:67]
v_pk_fma_f32 v[58:59],v[58:59],v[64:65],v[66:67]
v_pk_fma_f32 v[60:61],v[60:61],v[64:65],v[66:67]
v_pk_fma_f32 v[62:63],v[62:63],v[64:65],v[66:67]
CV v120,v56,v57
CV v121,v58,v59
CV v122,v60,v61
CV v123,v62,v63
v_lshlrev_b32 v56,16,v124
v_and_b32 v57,s72,v124
v_lshlrev_b32 v58,16,v125
v_and_b32 v59,s72,v125
v_lshlrev_b32 v60,16,v126
v_and_b32 v61,s72,v126
v_lshlrev_b32 v62,16,v127
v_and_b32 v63,s72,v127
v_pk_fma_f32 v[56:57],v[56:57],v[68:69],v[70:71]
v_pk_fma_f32 v[58:59],v[58:59],v[68:69],v[70:71]
v_pk_fma_f32 v[60:61],v[60:61],v[68:69],v[70:71]
v_pk_fma_f32 v[62:63],v[62:63],v[68:69],v[70:71]
CV v124,v56,v57
CV v125,v58,v59
CV v126,v60,v61
CV v127,v62,v63
buffer_load_dwordx4 v1,s[28:31],s50 offen offset:2048 lds
v_lshlrev_b32 v56,16,v128
v_and_b32 v57,s72,v128
v_lshlrev_b32 v58,16,v129
v_and_b32 v59,s72,v129
v_lshlrev_b32 v60,16,v130
v_and_b32 v61,s72,v130
v_lshlrev_b32 v62,16,v131
v_and_b32 v63,s72,v131
v_pk_fma_f32 v[56:57],v[56:57],v[64:65],v[66:67]
v_pk_fma_f32 v[58:59],v[58:59],v[64:65],v[66:67]
v_pk_fma_f32 v[60:61],v[60:61],v[64:65],v[66:67]
v_pk_fma_f32 v[62:63],v[62:63],v[64:65],v[66:67]
CV v128,v56,v57
CV v129,v58,v59
CV v130,v60,v61
CV v131,v62,v63
v_lshlrev_b32 v56,16,v132
v_and_b32 v57,s72,v132
v_lshlrev_b32 v58,16,v133
v_and_b32 v59,s72,v133
v_lshlrev_b32 v60,16,v134
v_and_b32 v61,s72,v134
v_lshlrev_b32 v62,16,v135
v_and_b32 v63,s72,v135
v_pk_fma_f32 v[56:57],v[56:57],v[68:69],v[70:71]
v_pk_fma_f32 v[58:59],v[58:59],v[68:69],v[70:71]
v_pk_fma_f32 v[60:61],v[60:61],v[68:69],v[70:71]
v_pk_fma_f32 v[62:63],v[62:63],v[68:69],v[70:71]
CV v132,v56,v57
CV v133,v58,v59
CV v134,v60,v61
CV v135,v62,v63
buffer_load_dwordx4 v1,s[28:31],s51 offen offset:3072 lds
v_lshlrev_b32 v56,16,v136
v_and_b32 v57,s72,v136
v_lshlrev_b32 v58,16,v137
v_and_b32 v59,s72,v137
v_lshlrev_b32 v60,16,v138
v_and_b32 v61,s72,v138
v_lshlrev_b32 v62,16,v139
v_and_b32 v63,s72,v139
v_pk_fma_f32 v[56:57],v[56:57],v[64:65],v[66:67]
v_pk_fma_f32 v[58:59],v[58:59],v[64:65],v[66:67]
v_pk_fma_f32 v[60:61],v[60:61],v[64:65],v[66:67]
v_pk_fma_f32 v[62:63],v[62:63],v[64:65],v[66:67]
CV v136,v56,v57
CV v137,v58,v59
CV v138,v60,v61
CV v139,v62,v63
v_lshlrev_b32 v56,16,v140
v_and_b32 v57,s72,v140
v_lshlrev_b32 v58,16,v141
v_and_b32 v59,s72,v141
v_lshlrev_b32 v60,16,v142
v_and_b32 v61,s72,v142
v_lshlrev_b32 v62,16,v143
v_and_b32 v63,s72,v143
v_pk_fma_f32 v[56:57],v[56:57],v[68:69],v[70:71]
v_pk_fma_f32 v[58:59],v[58:59],v[68:69],v[70:71]
v_pk_fma_f32 v[60:61],v[60:61],v[68:69],v[70:71]
v_pk_fma_f32 v[62:63],v[62:63],v[68:69],v[70:71]
CV v140,v56,v57
CV v141,v58,v59
CV v142,v60,v61
CV v143,v62,v63
s_add_u32 m0,s65,45056
s_nop 0
buffer_load_dwordx4 v1,s[28:31],s52 offen offset:0 lds
v_add_u32 v1,4292313088,v1
v_lshlrev_b32 v56,16,v144
v_and_b32 v57,s72,v144
v_lshlrev_b32 v58,16,v145
v_and_b32 v59,s72,v145
v_lshlrev_b32 v60,16,v146
v_and_b32 v61,s72,v146
v_lshlrev_b32 v62,16,v147
v_and_b32 v63,s72,v147
v_pk_fma_f32 v[56:57],v[56:57],v[64:65],v[66:67]
v_pk_fma_f32 v[58:59],v[58:59],v[64:65],v[66:67]
v_pk_fma_f32 v[60:61],v[60:61],v[64:65],v[66:67]
v_pk_fma_f32 v[62:63],v[62:63],v[64:65],v[66:67]
CV v144,v56,v57
CV v145,v58,v59
CV v146,v60,v61
CV v147,v62,v63
v_lshlrev_b32 v56,16,v148
v_and_b32 v57,s72,v148
v_lshlrev_b32 v58,16,v149
v_and_b32 v59,s72,v149
v_lshlrev_b32 v60,16,v150
v_and_b32 v61,s72,v150
v_lshlrev_b32 v62,16,v151
v_and_b32 v63,s72,v151
v_pk_fma_f32 v[56:57],v[56:57],v[68:69],v[70:71]
v_pk_fma_f32 v[58:59],v[58:59],v[68:69],v[70:71]
v_pk_fma_f32 v[60:61],v[60:61],v[68:69],v[70:71]
v_pk_fma_f32 v[62:63],v[62:63],v[68:69],v[70:71]
CV v148,v56,v57
CV v149,v58,v59
CV v150,v60,v61
CV v151,v62,v63
s_add_u32 m0,s66,0
s_nop 0
buffer_load_dwordx4 v1,s[32:35],s44 offen offset:0 lds
v_lshlrev_b32 v56,16,v152
v_and_b32 v57,s72,v152
v_lshlrev_b32 v58,16,v153
v_and_b32 v59,s72,v153
v_lshlrev_b32 v60,16,v154
v_and_b32 v61,s72,v154
v_lshlrev_b32 v62,16,v155
v_and_b32 v63,s72,v155
v_pk_fma_f32 v[56:57],v[56:57],v[64:65],v[66:67]
v_pk_fma_f32 v[58:59],v[58:59],v[64:65],v[66:67]
v_pk_fma_f32 v[60:61],v[60:61],v[64:65],v[66:67]
v_pk_fma_f32 v[62:63],v[62:63],v[64:65],v[66:67]
CV v152,v56,v57
CV v153,v58,v59
CV v154,v60,v61
CV v155,v62,v63
v_lshlrev_b32 v56,16,v156
v_and_b32 v57,s72,v156
v_lshlrev_b32 v58,16,v157
v_and_b32 v59,s72,v157
v_lshlrev_b32 v60,16,v158
v_and_b32 v61,s72,v158
v_lshlrev_b32 v62,16,v159
v_and_b32 v63,s72,v159
v_pk_fma_f32 v[56:57],v[56:57],v[68:69],v[70:71]
v_pk_fma_f32 v[58:59],v[58:59],v[68:69],v[70:71]
v_pk_fma_f32 v[60:61],v[60:61],v[68:69],v[70:71]
v_pk_fma_f32 v[62:63],v[62:63],v[68:69],v[70:71]
CV v156,v56,v57
CV v157,v58,v59
CV v158,v60,v61
CV v159,v62,v63
buffer_load_dwordx4 v1,s[32:35],s45 offen offset:1024 lds
v_lshlrev_b32 v56,16,v160
v_and_b32 v57,s72,v160
v_lshlrev_b32 v58,16,v161
v_and_b32 v59,s72,v161
v_lshlrev_b32 v60,16,v162
v_and_b32 v61,s72,v162
v_lshlrev_b32 v62,16,v163
v_and_b32 v63,s72,v163
v_pk_fma_f32 v[56:57],v[56:57],v[64:65],v[66:67]
v_pk_fma_f32 v[58:59],v[58:59],v[64:65],v[66:67]
v_pk_fma_f32 v[60:61],v[60:61],v[64:65],v[66:67]
v_pk_fma_f32 v[62:63],v[62:63],v[64:65],v[66:67]
CV v160,v56,v57
CV v161,v58,v59
CV v162,v60,v61
CV v163,v62,v63
v_lshlrev_b32 v56,16,v164
v_and_b32 v57,s72,v164
v_lshlrev_b32 v58,16,v165
v_and_b32 v59,s72,v165
v_lshlrev_b32 v60,16,v166
v_and_b32 v61,s72,v166
v_lshlrev_b32 v62,16,v167
v_and_b32 v63,s72,v167
v_pk_fma_f32 v[56:57],v[56:57],v[68:69],v[70:71]
v_pk_fma_f32 v[58:59],v[58:59],v[68:69],v[70:71]
v_pk_fma_f32 v[60:61],v[60:61],v[68:69],v[70:71]
v_pk_fma_f32 v[62:63],v[62:63],v[68:69],v[70:71]
CV v164,v56,v57
CV v165,v58,v59
CV v166,v60,v61
CV v167,v62,v63
buffer_load_dwordx4 v1,s[32:35],s46 offen offset:2048 lds
v_lshlrev_b32 v56,16,v168
v_and_b32 v57,s72,v168
v_lshlrev_b32 v58,16,v169
v_and_b32 v59,s72,v169
v_lshlrev_b32 v60,16,v170
v_and_b32 v61,s72,v170
v_lshlrev_b32 v62,16,v171
v_and_b32 v63,s72,v171
v_pk_fma_f32 v[56:57],v[56:57],v[64:65],v[66:67]
v_pk_fma_f32 v[58:59],v[58:59],v[64:65],v[66:67]
v_pk_fma_f32 v[60:61],v[60:61],v[64:65],v[66:67]
v_pk_fma_f32 v[62:63],v[62:63],v[64:65],v[66:67]
CV v168,v56,v57
CV v169,v58,v59
CV v170,v60,v61
CV v171,v62,v63
v_lshlrev_b32 v56,16,v172
v_and_b32 v57,s72,v172
v_lshlrev_b32 v58,16,v173
v_and_b32 v59,s72,v173
v_lshlrev_b32 v60,16,v174
v_and_b32 v61,s72,v174
v_lshlrev_b32 v62,16,v175
v_and_b32 v63,s72,v175
v_pk_fma_f32 v[56:57],v[56:57],v[68:69],v[70:71]
v_pk_fma_f32 v[58:59],v[58:59],v[68:69],v[70:71]
v_pk_fma_f32 v[60:61],v[60:61],v[68:69],v[70:71]
v_pk_fma_f32 v[62:63],v[62:63],v[68:69],v[70:71]
CV v172,v56,v57
CV v173,v58,v59
CV v174,v60,v61
CV v175,v62,v63
buffer_load_dwordx4 v1,s[32:35],s47 offen offset:3072 lds
v_lshlrev_b32 v56,16,v176
v_and_b32 v57,s72,v176
v_lshlrev_b32 v58,16,v177
v_and_b32 v59,s72,v177
v_lshlrev_b32 v60,16,v178
v_and_b32 v61,s72,v178
v_lshlrev_b32 v62,16,v179
v_and_b32 v63,s72,v179
v_pk_fma_f32 v[56:57],v[56:57],v[64:65],v[66:67]
v_pk_fma_f32 v[58:59],v[58:59],v[64:65],v[66:67]
v_pk_fma_f32 v[60:61],v[60:61],v[64:65],v[66:67]
v_pk_fma_f32 v[62:63],v[62:63],v[64:65],v[66:67]
CV v176,v56,v57
CV v177,v58,v59
CV v178,v60,v61
CV v179,v62,v63
v_lshlrev_b32 v56,16,v180
v_and_b32 v57,s72,v180
v_lshlrev_b32 v58,16,v181
v_and_b32 v59,s72,v181
v_lshlrev_b32 v60,16,v182
v_and_b32 v61,s72,v182
v_lshlrev_b32 v62,16,v183
v_and_b32 v63,s72,v183
v_pk_fma_f32 v[56:57],v[56:57],v[68:69],v[70:71]
v_pk_fma_f32 v[58:59],v[58:59],v[68:69],v[70:71]
v_pk_fma_f32 v[60:61],v[60:61],v[68:69],v[70:71]
v_pk_fma_f32 v[62:63],v[62:63],v[68:69],v[70:71]
CV v180,v56,v57
CV v181,v58,v59
CV v182,v60,v61
CV v183,v62,v63
s_add_u32 m0,s66,4096
s_nop 0
buffer_load_dwordx4 v1,s[32:35],s48 offen offset:0 lds
v_lshlrev_b32 v56,16,v184
v_and_b32 v57,s72,v184
v_lshlrev_b32 v58,16,v185
v_and_b32 v59,s72,v185
v_lshlrev_b32 v60,16,v186
v_and_b32 v61,s72,v186
v_lshlrev_b32 v62,16,v187
v_and_b32 v63,s72,v187
v_pk_fma_f32 v[56:57],v[56:57],v[64:65],v[66:67]
v_pk_fma_f32 v[58:59],v[58:59],v[64:65],v[66:67]
v_pk_fma_f32 v[60:61],v[60:61],v[64:65],v[66:67]
v_pk_fma_f32 v[62:63],v[62:63],v[64:65],v[66:67]
CV v184,v56,v57
CV v185,v58,v59
CV v186,v60,v61
CV v187,v62,v63
v_lshlrev_b32 v56,16,v188
v_and_b32 v57,s72,v188
v_lshlrev_b32 v58,16,v189
v_and_b32 v59,s72,v189
v_lshlrev_b32 v60,16,v190
v_and_b32 v61,s72,v190
v_lshlrev_b32 v62,16,v191
v_and_b32 v63,s72,v191
v_pk_fma_f32 v[56:57],v[56:57],v[68:69],v[70:71]
v_pk_fma_f32 v[58:59],v[58:59],v[68:69],v[70:71]
v_pk_fma_f32 v[60:61],v[60:61],v[68:69],v[70:71]
v_pk_fma_f32 v[62:63],v[62:63],v[68:69],v[70:71]
CV v188,v56,v57
CV v189,v58,v59
CV v190,v60,v61
CV v191,v62,v63
buffer_load_dwordx4 v1,s[32:35],s49 offen offset:1024 lds
v_lshlrev_b32 v56,16,v192
v_and_b32 v57,s72,v192
v_lshlrev_b32 v58,16,v193
v_and_b32 v59,s72,v193
v_lshlrev_b32 v60,16,v194
v_and_b32 v61,s72,v194
v_lshlrev_b32 v62,16,v195
v_and_b32 v63,s72,v195
v_pk_fma_f32 v[56:57],v[56:57],v[64:65],v[66:67]
v_pk_fma_f32 v[58:59],v[58:59],v[64:65],v[66:67]
v_pk_fma_f32 v[60:61],v[60:61],v[64:65],v[66:67]
v_pk_fma_f32 v[62:63],v[62:63],v[64:65],v[66:67]
CV v192,v56,v57
CV v193,v58,v59
CV v194,v60,v61
CV v195,v62,v63
v_lshlrev_b32 v56,16,v196
v_and_b32 v57,s72,v196
v_lshlrev_b32 v58,16,v197
v_and_b32 v59,s72,v197
v_lshlrev_b32 v60,16,v198
v_and_b32 v61,s72,v198
v_lshlrev_b32 v62,16,v199
v_and_b32 v63,s72,v199
v_pk_fma_f32 v[56:57],v[56:57],v[68:69],v[70:71]
v_pk_fma_f32 v[58:59],v[58:59],v[68:69],v[70:71]
v_pk_fma_f32 v[60:61],v[60:61],v[68:69],v[70:71]
v_pk_fma_f32 v[62:63],v[62:63],v[68:69],v[70:71]
CV v196,v56,v57
CV v197,v58,v59
CV v198,v60,v61
CV v199,v62,v63
buffer_load_dwordx4 v1,s[32:35],s50 offen offset:2048 lds
v_lshlrev_b32 v56,16,v200
v_and_b32 v57,s72,v200
v_lshlrev_b32 v58,16,v201
v_and_b32 v59,s72,v201
v_lshlrev_b32 v60,16,v202
v_and_b32 v61,s72,v202
v_lshlrev_b32 v62,16,v203
v_and_b32 v63,s72,v203
v_pk_fma_f32 v[56:57],v[56:57],v[64:65],v[66:67]
v_pk_fma_f32 v[58:59],v[58:59],v[64:65],v[66:67]
v_pk_fma_f32 v[60:61],v[60:61],v[64:65],v[66:67]
v_pk_fma_f32 v[62:63],v[62:63],v[64:65],v[66:67]
CV v200,v56,v57
CV v201,v58,v59
CV v202,v60,v61
CV v203,v62,v63
v_lshlrev_b32 v56,16,v204
v_and_b32 v57,s72,v204
v_lshlrev_b32 v58,16,v205
v_and_b32 v59,s72,v205
v_lshlrev_b32 v60,16,v206
v_and_b32 v61,s72,v206
v_lshlrev_b32 v62,16,v207
v_and_b32 v63,s72,v207
v_pk_fma_f32 v[56:57],v[56:57],v[68:69],v[70:71]
v_pk_fma_f32 v[58:59],v[58:59],v[68:69],v[70:71]
v_pk_fma_f32 v[60:61],v[60:61],v[68:69],v[70:71]
v_pk_fma_f32 v[62:63],v[62:63],v[68:69],v[70:71]
CV v204,v56,v57
CV v205,v58,v59
CV v206,v60,v61
CV v207,v62,v63
buffer_load_dwordx4 v1,s[32:35],s51 offen offset:3072 lds
v_lshlrev_b32 v56,16,v208
v_and_b32 v57,s72,v208
v_lshlrev_b32 v58,16,v209
v_and_b32 v59,s72,v209
v_lshlrev_b32 v60,16,v210
v_and_b32 v61,s72,v210
v_lshlrev_b32 v62,16,v211
v_and_b32 v63,s72,v211
v_pk_fma_f32 v[56:57],v[56:57],v[64:65],v[66:67]
v_pk_fma_f32 v[58:59],v[58:59],v[64:65],v[66:67]
v_pk_fma_f32 v[60:61],v[60:61],v[64:65],v[66:67]
v_pk_fma_f32 v[62:63],v[62:63],v[64:65],v[66:67]
CV v208,v56,v57
CV v209,v58,v59
CV v210,v60,v61
CV v211,v62,v63
v_lshlrev_b32 v56,16,v212
v_and_b32 v57,s72,v212
v_lshlrev_b32 v58,16,v213
v_and_b32 v59,s72,v213
v_lshlrev_b32 v60,16,v214
v_and_b32 v61,s72,v214
v_lshlrev_b32 v62,16,v215
v_and_b32 v63,s72,v215
v_pk_fma_f32 v[56:57],v[56:57],v[68:69],v[70:71]
v_pk_fma_f32 v[58:59],v[58:59],v[68:69],v[70:71]
v_pk_fma_f32 v[60:61],v[60:61],v[68:69],v[70:71]
v_pk_fma_f32 v[62:63],v[62:63],v[68:69],v[70:71]
CV v212,v56,v57
CV v213,v58,v59
CV v214,v60,v61
CV v215,v62,v63
s_add_u32 m0,s66,8192
s_nop 0
buffer_load_dwordx4 v1,s[32:35],s52 offen offset:0 lds
v_add_u32 v1,2654208,v1
v_lshlrev_b32 v56,16,v216
v_and_b32 v57,s72,v216
v_lshlrev_b32 v58,16,v217
v_and_b32 v59,s72,v217
v_lshlrev_b32 v60,16,v218
v_and_b32 v61,s72,v218
v_lshlrev_b32 v62,16,v219
v_and_b32 v63,s72,v219
v_pk_fma_f32 v[56:57],v[56:57],v[64:65],v[66:67]
v_pk_fma_f32 v[58:59],v[58:59],v[64:65],v[66:67]
v_pk_fma_f32 v[60:61],v[60:61],v[64:65],v[66:67]
v_pk_fma_f32 v[62:63],v[62:63],v[64:65],v[66:67]
CV v216,v56,v57
CV v217,v58,v59
CV v218,v60,v61
CV v219,v62,v63
v_lshlrev_b32 v56,16,v220
v_and_b32 v57,s72,v220
v_lshlrev_b32 v58,16,v221
v_and_b32 v59,s72,v221
v_lshlrev_b32 v60,16,v222
v_and_b32 v61,s72,v222
v_lshlrev_b32 v62,16,v223
v_and_b32 v63,s72,v223
v_pk_fma_f32 v[56:57],v[56:57],v[68:69],v[70:71]
v_pk_fma_f32 v[58:59],v[58:59],v[68:69],v[70:71]
v_pk_fma_f32 v[60:61],v[60:61],v[68:69],v[70:71]
v_pk_fma_f32 v[62:63],v[62:63],v[68:69],v[70:71]
CV v220,v56,v57
CV v221,v58,v59
CV v222,v60,v61
CV v223,v62,v63
v_add_u32 v3,73728,v0
s_waitcnt vmcnt(18)
s_barrier
RT v[8:9],v0,0
RT v[10:11],v0,1024
RT v[12:13],v0,256
RT v[14:15],v0,1280
RT v[16:17],v0,2048
RT v[18:19],v0,3072
RT v[20:21],v0,2304
RT v[22:23],v0,3328
RT v[24:25],v0,4096
RT v[26:27],v0,5120
WL 6
MA v[32:35],v[8:11],v[80:83],0
RT v[28:29],v0,4352
MA v[40:43],v[8:11],v[84:87],0
RT v[30:31],v0,5376
MA v[36:39],v[12:15],v[80:83],0
RT v[8:9],v0,6144
MA v[44:47],v[12:15],v[84:87],0
RT v[10:11],v0,7168
WL 6
MA v[32:35],v[16:19],v[88:91],v[32:35]
RT v[12:13],v0,6400
MA v[40:43],v[16:19],v[92:95],v[40:43]
RT v[14:15],v0,7424
MA v[36:39],v[20:23],v[88:91],v[36:39]
RT v[16:17],v0,8192
MA v[44:47],v[20:23],v[92:95],v[44:47]
RT v[18:19],v0,9216
WL 6
MA v[32:35],v[24:27],v[96:99],v[32:35]
RT v[20:21],v0,8448
MA v[40:43],v[24:27],v[100:103],v[40:43]
RT v[22:23],v0,9472
MA v[36:39],v[28:31],v[96:99],v[36:39]
RT v[24:25],v0,10240
MA v[44:47],v[28:31],v[100:103],v[44:47]
RT v[26:27],v0,11264
WL 6
MA v[32:35],v[8:11],v[104:107],v[32:35]
RT v[28:29],v0,10496
MA v[40:43],v[8:11],v[108:111],v[40:43]
RT v[30:31],v0,11520
MA v[36:39],v[12:15],v[104:107],v[36:39]
RT v[8:9],v0,12288
MA v[44:47],v[12:15],v[108:111],v[44:47]
RT v[10:11],v0,13312
WL 6
MA v[32:35],v[16:19],v[112:115],v[32:35]
RT v[12:13],v0,12544
MA v[40:43],v[16:19],v[116:119],v[40:43]
RT v[14:15],v0,13568
MA v[36:39],v[20:23],v[112:115],v[36:39]
RT v[16:17],v0,14336
MA v[44:47],v[20:23],v[116:119],v[44:47]
RT v[18:19],v0,15360
WL 6
MA v[32:35],v[24:27],v[120:123],v[32:35]
RT v[20:21],v0,14592
MA v[40:43],v[24:27],v[124:127],v[40:43]
RT v[22:23],v0,15616
MA v[36:39],v[28:31],v[120:123],v[36:39]
RT v[24:25],v0,16384
MA v[44:47],v[28:31],v[124:127],v[44:47]
RT v[26:27],v0,17408
WL 6
MA v[32:35],v[8:11],v[128:131],v[32:35]
RT v[28:29],v0,16640
MA v[40:43],v[8:11],v[132:135],v[40:43]
RT v[30:31],v0,17664
MA v[36:39],v[12:15],v[128:131],v[36:39]
s_waitcnt vmcnt(9)
s_barrier
RT v[8:9],v0,36864
RT v[10:11],v0,37888
s_mov_b32 m0,147456
s_nop 0
MA v[44:47],v[12:15],v[132:135],v[44:47]
buffer_load_dword v7,s[24:27],s92 offen lds
s_add_u32 s92,s92,s93
WL 6
MA v[32:35],v[16:19],v[136:139],v[32:35]
RT v[12:13],v0,37120
MA v[40:43],v[16:19],v[140:143],v[40:43]
RT v[14:15],v0,38144
MA v[36:39],v[20:23],v[136:139],v[36:39]
RT v[16:17],v0,38912
MA v[44:47],v[20:23],v[140:143],v[44:47]
RT v[18:19],v0,39936
WL 6
MA v[32:35],v[24:27],v[144:147],v[32:35]
RT v[20:21],v0,39168
s_add_u32 m0,s66,36864
s_nop 0
MA v[40:43],v[24:27],v[148:151],v[40:43]
RT v[22:23],v0,40192
buffer_load_dwordx4 v1,s[32:35],s44 offen offset:0 lds
MA v[36:39],v[28:31],v[144:147],v[36:39]
RT v[24:25],v0,40960
MA v[44:47],v[28:31],v[148:151],v[44:47]
RT v[26:27],v0,41984
WL 6
MA v[32:35],v[8:11],v[152:155],v[32:35]
RT v[28:29],v0,41216
MA v[40:43],v[8:11],v[156:159],v[40:43]
RT v[30:31],v0,42240
MA v[36:39],v[12:15],v[152:155],v[36:39]
RT v[8:9],v0,43008
MA v[44:47],v[12:15],v[156:159],v[44:47]
RT v[10:11],v0,44032
WL 6
MA v[32:35],v[16:19],v[160:163],v[32:35]
RT v[12:13],v0,43264
RT v[14:15],v0,44288
MA v[40:43],v[16:19],v[164:167],v[40:43]
buffer_load_dwordx4 v1,s[32:35],s45 offen offset:1024 lds
MA v[36:39],v[20:23],v[160:163],v[36:39]
RT v[16:17],v0,45056
MA v[44:47],v[20:23],v[164:167],v[44:47]
RT v[18:19],v0,46080
WL 6
MA v[32:35],v[24:27],v[168:171],v[32:35]
RT v[20:21],v0,45312
MA v[40:43],v[24:27],v[172:175],v[40:43]
RT v[22:23],v0,46336
MA v[36:39],v[28:31],v[168:171],v[36:39]
RT v[24:25],v0,47104
MA v[44:47],v[28:31],v[172:175],v[44:47]
RT v[26:27],v0,48128
WL 6
MA v[32:35],v[8:11],v[176:179],v[32:35]
RT v[28:29],v0,47360
RT v[30:31],v0,48384
MA v[40:43],v[8:11],v[180:183],v[40:43]
buffer_load_dwordx4 v1,s[32:35],s46 offen offset:2048 lds
MA v[36:39],v[12:15],v[176:179],v[36:39]
RT v[8:9],v0,49152
MA v[44:47],v[12:15],v[180:183],v[44:47]
RT v[10:11],v0,50176
WL 6
MA v[32:35],v[16:19],v[184:187],v[32:35]
RT v[12:13],v0,49408
MA v[40:43],v[16:19],v[188:191],v[40:43]
RT v[14:15],v0,50432
MA v[36:39],v[20:23],v[184:187],v[36:39]
RT v[16:17],v0,51200
MA v[44:47],v[20:23],v[188:191],v[44:47]
RT v[18:19],v0,52224
WL 6
MA v[32:35],v[24:27],v[192:195],v[32:35]
RT v[20:21],v0,51456
RT v[22:23],v0,52480
MA v[40:43],v[24:27],v[196:199],v[40:43]
buffer_load_dwordx4 v1,s[32:35],s47 offen offset:3072 lds
MA v[36:39],v[28:31],v[192:195],v[36:39]
RT v[24:25],v0,53248
MA v[44:47],v[28:31],v[196:199],v[44:47]
RT v[26:27],v0,54272
WL 6
MA v[32:35],v[8:11],v[200:203],v[32:35]
RT v[28:29],v0,53504
MA v[40:43],v[8:11],v[204:207],v[40:43]
RT v[30:31],v0,54528
MA v[36:39],v[12:15],v[200:203],v[36:39]
RT v[8:9],v0,512
MA v[44:47],v[12:15],v[204:207],v[44:47]
RT v[10:11],v0,1536
WL 6
MA v[32:35],v[16:19],v[208:211],v[32:35]
RT v[12:13],v0,768
s_add_u32 m0,s66,40960
s_nop 0
MA v[40:43],v[16:19],v[212:215],v[40:43]
RT v[14:15],v0,1792
buffer_load_dwordx4 v1,s[32:35],s48 offen offset:0 lds
MA v[36:39],v[20:23],v[208:211],v[36:39]
RT v[16:17],v0,2560
MA v[44:47],v[20:23],v[212:215],v[44:47]
RT v[18:19],v0,3584
WL 6
MA v[32:35],v[24:27],v[216:219],v[32:35]
RT v[20:21],v0,2816
MA v[40:43],v[24:27],v[220:223],v[40:43]
RT v[22:23],v0,3840
MA v[36:39],v[28:31],v[216:219],v[36:39]
RT v[24:25],v0,4608
MA v[44:47],v[28:31],v[220:223],v[44:47]
RT v[26:27],v0,5632
WL 6
MA v[48:51],v[8:11],v[80:83],0
RT v[28:29],v0,4864
RT v[30:31],v0,5888
MA v[56:59],v[8:11],v[84:87],0
buffer_load_dwordx4 v1,s[32:35],s49 offen offset:1024 lds
MA v[52:55],v[12:15],v[80:83],0
RT v[8:9],v0,6656
MA v[60:63],v[12:15],v[84:87],0
RT v[10:11],v0,7680
WL 6
MA v[48:51],v[16:19],v[88:91],v[48:51]
RT v[12:13],v0,6912
MA v[56:59],v[16:19],v[92:95],v[56:59]
RT v[14:15],v0,7936
MA v[52:55],v[20:23],v[88:91],v[52:55]
RT v[16:17],v0,8704
v_mul_f32 v5,v32,v32
MA v[60:63],v[20:23],v[92:95],v[60:63]
RT v[18:19],v0,9728
WL 6
MA v[48:51],v[24:27],v[96:99],v[48:51]
RT v[20:21],v0,8960
RT v[22:23],v0,9984
MA v[56:59],v[24:27],v[100:103],v[56:59]
buffer_load_dwordx4 v1,s[32:35],s50 offen offset:2048 lds
MA v[52:55],v[28:31],v[96:99],v[52:55]
RT v[24:25],v0,10752
v_mul_f32 v6,v33,v33
MA v[60:63],v[28:31],v[100:103],v[60:63]
RT v[26:27],v0,11776
WL 6
MA v[48:51],v[8:11],v[104:107],v[48:51]
RT v[28:29],v0,11008
v_fmaak_f32 v5,v5,v4,0xc0135761
MA v[56:59],v[8:11],v[108:111],v[56:59]
RT v[30:31],v0,12032
v_fmaak_f32 v6,v6,v4,0xc0135761
MA v[52:55],v[12:15],v[104:107],v[52:55]
RT v[8:9],v0,12800
v_mul_f32 v5,v5,v32
MA v[60:63],v[12:15],v[108:111],v[60:63]
RT v[10:11],v0,13824
WL 6
MA v[48:51],v[16:19],v[112:115],v[48:51]
RT v[12:13],v0,13056
buffer_load_dwordx4 v1,s[32:35],s51 offen offset:3072 lds
MA v[56:59],v[16:19],v[116:119],v[56:59]
RT v[14:15],v0,14080
v_mul_f32 v6,v6,v33
v_exp_f32 v5,v5
MA v[52:55],v[20:23],v[112:115],v[52:55]
RT v[16:17],v0,14848
v_exp_f32 v6,v6
MA v[60:63],v[20:23],v[116:119],v[60:63]
RT v[18:19],v0,15872
WL 6
MA v[48:51],v[24:27],v[120:123],v[48:51]
RT v[20:21],v0,15104
v_add_f32 v5,1.0,v5
MA v[56:59],v[24:27],v[124:127],v[56:59]
RT v[22:23],v0,16128
v_add_f32 v6,1.0,v6
MA v[52:55],v[28:31],v[120:123],v[52:55]
RT v[24:25],v0,16896
v_rcp_f32 v5,v5
MA v[60:63],v[28:31],v[124:127],v[60:63]
RT v[26:27],v0,17920
v_rcp_f32 v6,v6
WL 6
MA v[48:51],v[8:11],v[128:131],v[48:51]
RT v[28:29],v0,17152
s_add_u32 m0,s66,45056
v_mul_f32 v32,v32,v5
MA v[56:59],v[8:11],v[132:135],v[56:59]
RT v[30:31],v0,18176
buffer_load_dwordx4 v1,s[32:35],s52 offen offset:0 lds
v_add_u32 v1,4292313216,v1
MA v[52:55],v[12:15],v[128:131],v[52:55]
RT v[8:9],v0,37376
v_mul_f32 v33,v33,v6
MA v[60:63],v[12:15],v[132:135],v[60:63]
RT v[10:11],v0,38400
v_mul_f32 v5,v34,v34
WL 6
MA v[48:51],v[16:19],v[136:139],v[48:51]
RT v[12:13],v0,37632
v_mul_f32 v6,v35,v35
MA v[56:59],v[16:19],v[140:143],v[56:59]
RT v[14:15],v0,38656
v_fmaak_f32 v5,v5,v4,0xc0135761
v_fmaak_f32 v6,v6,v4,0xc0135761
MA v[52:55],v[20:23],v[136:139],v[52:55]
RT v[16:17],v0,39424
v_mul_f32 v5,v5,v34
MA v[60:63],v[20:23],v[140:143],v[60:63]
RT v[18:19],v0,40448
v_mul_f32 v6,v6,v35
WL 6
MA v[48:51],v[24:27],v[144:147],v[48:51]
RT v[20:21],v0,39680
RT v[22:23],v0,40704
MA v[56:59],v[24:27],v[148:151],v[56:59]
v_exp_f32 v5,v5
MA v[52:55],v[28:31],v[144:147],v[52:55]
RT v[24:25],v0,41472
v_exp_f32 v6,v6
MA v[60:63],v[28:31],v[148:151],v[60:63]
RT v[26:27],v0,42496
v_add_f32 v5,1.0,v5
WL 6
MA v[48:51],v[8:11],v[152:155],v[48:51]
RT v[28:29],v0,41728
v_add_f32 v6,1.0,v6
MA v[56:59],v[8:11],v[156:159],v[56:59]
RT v[30:31],v0,42752
v_rcp_f32 v5,v5
MA v[52:55],v[12:15],v[152:155],v[52:55]
RT v[8:9],v0,43520
v_rcp_f32 v6,v6
MA v[60:63],v[12:15],v[156:159],v[60:63]
RT v[10:11],v0,44544
WL 6
MA v[48:51],v[16:19],v[160:163],v[48:51]
RT v[12:13],v0,43776
v_mul_f32 v34,v34,v5
MA v[56:59],v[16:19],v[164:167],v[56:59]
RT v[14:15],v0,44800
v_mul_f32 v35,v35,v6
MA v[52:55],v[20:23],v[160:163],v[52:55]
RT v[16:17],v0,45568
v_mul_f32 v5,v36,v36
MA v[60:63],v[20:23],v[164:167],v[60:63]
RT v[18:19],v0,46592
v_mul_f32 v6,v37,v37
WL 6
MA v[48:51],v[24:27],v[168:171],v[48:51]
RT v[20:21],v0,45824
v_fmaak_f32 v5,v5,v4,0xc0135761
MA v[56:59],v[24:27],v[172:175],v[56:59]
RT v[22:23],v0,46848
v_fmaak_f32 v6,v6,v4,0xc0135761
v_mul_f32 v5,v5,v36
MA v[52:55],v[28:31],v[168:171],v[52:55]
RT v[24:25],v0,47616
RT v[26:27],v0,48640
v_mul_f32 v6,v6,v37
MA v[60:63],v[28:31],v[172:175],v[60:63]
v_exp_f32 v5,v5
WL 6
MA v[48:51],v[8:11],v[176:179],v[48:51]
RT v[28:29],v0,47872
RT v[30:31],v0,48896
MA v[56:59],v[8:11],v[180:183],v[56:59]
v_exp_f32 v6,v6
MA v[52:55],v[12:15],v[176:179],v[52:55]
RT v[8:9],v0,49664
v_add_f32 v5,1.0,v5
MA v[60:63],v[12:15],v[180:183],v[60:63]
RT v[10:11],v0,50688
v_add_f32 v6,1.0,v6
WL 6
MA v[48:51],v[16:19],v[184:187],v[48:51]
RT v[12:13],v0,49920
RT v[14:15],v0,50944
MA v[56:59],v[16:19],v[188:191],v[56:59]
v_rcp_f32 v5,v5
MA v[52:55],v[20:23],v[184:187],v[52:55]
RT v[16:17],v0,51712
v_rcp_f32 v6,v6
MA v[60:63],v[20:23],v[188:191],v[60:63]
RT v[18:19],v0,52736
WL 6
MA v[48:51],v[24:27],v[192:195],v[48:51]
RT v[20:21],v0,51968
v_mul_f32 v36,v36,v5
MA v[56:59],v[24:27],v[196:199],v[56:59]
RT v[22:23],v0,52992
v_mul_f32 v37,v37,v6
v_mul_f32 v5,v38,v38
MA v[52:55],v[28:31],v[192:195],v[52:55]
RT v[24:25],v0,53760
v_mul_f32 v6,v39,v39
MA v[60:63],v[28:31],v[196:199],v[60:63]
RT v[26:27],v0,54784
v_fmaak_f32 v5,v5,v4,0xc0135761
WL 6
MA v[48:51],v[8:11],v[200:203],v[48:51]
RT v[28:29],v0,54016
v_fmaak_f32 v6,v6,v4,0xc0135761
MA v[56:59],v[8:11],v[204:207],v[56:59]
RT v[30:31],v0,55040
v_mul_f32 v5,v5,v38
v_mul_f32 v6,v6,v39
MA v[52:55],v[12:15],v[200:203],v[52:55]
s_waitcnt vmcnt(10)
s_barrier
RT v[8:9],v3,0
v_exp_f32 v5,v5
MA v[60:63],v[12:15],v[204:207],v[60:63]
RT v[10:11],v3,1024
WL 6
MA v[48:51],v[16:19],v[208:211],v[48:51]
RT v[12:13],v3,256
RT v[14:15],v3,1280
MA v[56:59],v[16:19],v[212:215],v[56:59]
v_exp_f32 v6,v6
MA v[52:55],v[20:23],v[208:211],v[52:55]
RT v[16:17],v3,2048
v_add_f32 v5,1.0,v5
v_add_f32 v6,1.0,v6
MA v[60:63],v[20:23],v[212:215],v[60:63]
RT v[18:19],v3,3072
v_rcp_f32 v5,v5
WL 6
MA v[48:51],v[24:27],v[216:219],v[48:51]
RT v[20:21],v3,2304
s_add_u32 m0,s65,0
v_rcp_f32 v6,v6
MA v[56:59],v[24:27],v[220:223],v[56:59]
RT v[22:23],v3,3328
buffer_load_dwordx4 v2,s[36:39],s53 offen offset:0 lds
MA v[52:55],v[28:31],v[216:219],v[52:55]
RT v[24:25],v3,4096
v_mul_f32 v38,v38,v5
MA v[60:63],v[28:31],v[220:223],v[60:63]
RT v[26:27],v3,5120
WL 6
MA v[64:67],v[8:11],v[80:83],0
RT v[28:29],v3,4352
v_mul_f32 v39,v39,v6
MA v[72:75],v[8:11],v[84:87],0
RT v[30:31],v3,5376
v_mul_f32 v5,v40,v40
v_mul_f32 v6,v41,v41
MA v[68:71],v[12:15],v[80:83],0
RT v[8:9],v3,6144
v_fmaak_f32 v5,v5,v4,0xc0135761
MA v[76:79],v[12:15],v[84:87],0
RT v[10:11],v3,7168
v_fmaak_f32 v6,v6,v4,0xc0135761
WL 6
MA v[64:67],v[16:19],v[88:91],v[64:67]
RT v[12:13],v3,6400
buffer_load_dwordx4 v2,s[36:39],s54 offen offset:1024 lds
MA v[72:75],v[16:19],v[92:95],v[72:75]
RT v[14:15],v3,7424
v_mul_f32 v5,v5,v40
v_mul_f32 v6,v6,v41
MA v[68:71],v[20:23],v[88:91],v[68:71]
RT v[16:17],v3,8192
v_exp_f32 v5,v5
MA v[76:79],v[20:23],v[92:95],v[76:79]
RT v[18:19],v3,9216
v_exp_f32 v6,v6
WL 6
MA v[64:67],v[24:27],v[96:99],v[64:67]
RT v[20:21],v3,8448
v_add_f32 v5,1.0,v5
MA v[72:75],v[24:27],v[100:103],v[72:75]
RT v[22:23],v3,9472
v_add_f32 v6,1.0,v6
MA v[68:71],v[28:31],v[96:99],v[68:71]
RT v[24:25],v3,10240
v_rcp_f32 v5,v5
MA v[76:79],v[28:31],v[100:103],v[76:79]
RT v[26:27],v3,11264
WL 6
MA v[64:67],v[8:11],v[104:107],v[64:67]
RT v[28:29],v3,10496
buffer_load_dwordx4 v2,s[36:39],s55 offen offset:2048 lds
MA v[72:75],v[8:11],v[108:111],v[72:75]
RT v[30:31],v3,11520
v_rcp_f32 v6,v6
MA v[68:71],v[12:15],v[104:107],v[68:71]
RT v[8:9],v3,12288
v_mul_f32 v40,v40,v5
MA v[76:79],v[12:15],v[108:111],v[76:79]
RT v[10:11],v3,13312
v_mul_f32 v41,v41,v6
WL 6
MA v[64:67],v[16:19],v[112:115],v[64:67]
RT v[12:13],v3,12544
v_mul_f32 v5,v42,v42
MA v[72:75],v[16:19],v[116:119],v[72:75]
RT v[14:15],v3,13568
v_mul_f32 v6,v43,v43
v_fmaak_f32 v5,v5,v4,0xc0135761
MA v[68:71],v[20:23],v[112:115],v[68:71]
RT v[16:17],v3,14336
v_fmaak_f32 v6,v6,v4,0xc0135761
MA v[76:79],v[20:23],v[116:119],v[76:79]
RT v[18:19],v3,15360
v_mul_f32 v5,v5,v42
WL 6
MA v[64:67],v[24:27],v[120:123],v[64:67]
RT v[20:21],v3,14592
buffer_load_dwordx4 v2,s[36:39],s56 offen offset:3072 lds
MA v[72:75],v[24:27],v[124:127],v[72:75]
RT v[22:23],v3,15616
v_mul_f32 v6,v6,v43
v_exp_f32 v5,v5
MA v[68:71],v[28:31],v[120:123],v[68:71]
RT v[24:25],v3,16384
v_exp_f32 v6,v6
MA v[76:79],v[28:31],v[124:127],v[76:79]
RT v[26:27],v3,17408
WL 6
MA v[64:67],v[8:11],v[128:131],v[64:67]
RT v[28:29],v3,16640
v_add_f32 v5,1.0,v5
MA v[72:75],v[8:11],v[132:135],v[72:75]
RT v[30:31],v3,17664
v_add_f32 v6,1.0,v6
MA v[68:71],v[12:15],v[128:131],v[68:71]
s_waitcnt vmcnt(4)
s_barrier
RT v[8:9],v3,36864
v_rcp_f32 v5,v5
MA v[76:79],v[12:15],v[132:135],v[76:79]
RT v[10:11],v3,37888
WL 6
MA v[64:67],v[16:19],v[136:139],v[64:67]
RT v[12:13],v3,37120
s_add_u32 m0,s65,4096
v_rcp_f32 v6,v6
MA v[72:75],v[16:19],v[140:143],v[72:75]
RT v[14:15],v3,38144
buffer_load_dwordx4 v2,s[36:39],s57 offen offset:0 lds
v_mul_f32 v42,v42,v5
MA v[68:71],v[20:23],v[136:139],v[68:71]
RT v[16:17],v3,38912
v_mul_f32 v43,v43,v6
MA v[76:79],v[20:23],v[140:143],v[76:79]
RT v[18:19],v3,39936
v_mul_f32 v5,v44,v44
WL 6
MA v[64:67],v[24:27],v[144:147],v[64:67]
RT v[20:21],v3,39168
v_mul_f32 v6,v45,v45
MA v[72:75],v[24:27],v[148:151],v[72:75]
RT v[22:23],v3,40192
v_fmaak_f32 v5,v5,v4,0xc0135761
MA v[68:71],v[28:31],v[144:147],v[68:71]
RT v[24:25],v3,40960
v_fmaak_f32 v6,v6,v4,0xc0135761
v_mul_f32 v5,v5,v44
MA v[76:79],v[28:31],v[148:151],v[76:79]
RT v[26:27],v3,41984
v_mul_f32 v6,v6,v45
WL 6
MA v[64:67],v[8:11],v[152:155],v[64:67]
RT v[28:29],v3,41216
buffer_load_dwordx4 v2,s[36:39],s58 offen offset:1024 lds
MA v[72:75],v[8:11],v[156:159],v[72:75]
RT v[30:31],v3,42240
v_exp_f32 v5,v5
MA v[68:71],v[12:15],v[152:155],v[68:71]
RT v[8:9],v3,43008
v_exp_f32 v6,v6
MA v[76:79],v[12:15],v[156:159],v[76:79]
RT v[10:11],v3,44032
v_add_f32 v5,1.0,v5
WL 6
MA v[64:67],v[16:19],v[160:163],v[64:67]
RT v[12:13],v3,43264
v_add_f32 v6,1.0,v6
MA v[72:75],v[16:19],v[164:167],v[72:75]
RT v[14:15],v3,44288
v_rcp_f32 v5,v5
MA v[68:71],v[20:23],v[160:163],v[68:71]
RT v[16:17],v3,45056
v_rcp_f32 v6,v6
MA v[76:79],v[20:23],v[164:167],v[76:79]
RT v[18:19],v3,46080
WL 6
MA v[64:67],v[24:27],v[168:171],v[64:67]
RT v[20:21],v3,45312
buffer_load_dwordx4 v2,s[36:39],s59 offen offset:2048 lds
MA v[72:75],v[24:27],v[172:175],v[72:75]
RT v[22:23],v3,46336
v_mul_f32 v44,v44,v5
v_mul_f32 v45,v45,v6
MA v[68:71],v[28:31],v[168:171],v[68:71]
RT v[24:25],v3,47104
v_mul_f32 v5,v46,v46
MA v[76:79],v[28:31],v[172:175],v[76:79]
RT v[26:27],v3,48128
v_mul_f32 v6,v47,v47
WL 6
MA v[64:67],v[8:11],v[176:179],v[64:67]
RT v[28:29],v3,47360
v_fmaak_f32 v5,v5,v4,0xc0135761
MA v[72:75],v[8:11],v[180:183],v[72:75]
RT v[30:31],v3,48384
v_fmaak_f32 v6,v6,v4,0xc0135761
MA v[68:71],v[12:15],v[176:179],v[68:71]
RT v[8:9],v3,49152
v_mul_f32 v5,v5,v46
v_mul_f32 v6,v6,v47
MA v[76:79],v[12:15],v[180:183],v[76:79]
RT v[10:11],v3,50176
v_exp_f32 v5,v5
WL 6
MA v[64:67],v[16:19],v[184:187],v[64:67]
RT v[12:13],v3,49408
buffer_load_dwordx4 v2,s[36:39],s60 offen offset:3072 lds
MA v[72:75],v[16:19],v[188:191],v[72:75]
RT v[14:15],v3,50432
v_exp_f32 v6,v6
MA v[68:71],v[20:23],v[184:187],v[68:71]
RT v[16:17],v3,51200
v_add_f32 v5,1.0,v5
MA v[76:79],v[20:23],v[188:191],v[76:79]
RT v[18:19],v3,52224
WL 6
MA v[64:67],v[24:27],v[192:195],v[64:67]
RT v[20:21],v3,51456
v_add_f32 v6,1.0,v6
MA v[72:75],v[24:27],v[196:199],v[72:75]
RT v[22:23],v3,52480
v_rcp_f32 v5,v5
MA v[68:71],v[28:31],v[192:195],v[68:71]
RT v[24:25],v3,53248
v_rcp_f32 v6,v6
MA v[76:79],v[28:31],v[196:199],v[76:79]
RT v[26:27],v3,54272
WL 6
MA v[64:67],v[8:11],v[200:203],v[64:67]
RT v[28:29],v3,53504
RT v[30:31],v3,54528
s_add_u32 m0,s65,8192
v_mul_f32 v46,v46,v5
MA v[72:75],v[8:11],v[204:207],v[72:75]
buffer_load_dwordx4 v2,s[36:39],s61 offen offset:0 lds
v_add_u32 v2,36864,v2
v_mul_f32 v47,v47,v6
MA v[68:71],v[12:15],v[200:203],v[68:71]
RT v[8:9],v3,512
v_mul_f32 v5,v48,v48
v_mul_f32 v6,v49,v49
MA v[76:79],v[12:15],v[204:207],v[76:79]
RT v[10:11],v3,1536
v_fmaak_f32 v5,v5,v4,0xc0135761
WL 6
MA v[64:67],v[16:19],v[208:211],v[64:67]
RT v[12:13],v3,768
s_mov_b32 m0,147456
s_nop 0
buffer_load_dword v7,s[24:27],s92 offen lds
MA v[72:75],v[16:19],v[212:215],v[72:75]
RT v[14:15],v3,1792
s_add_u32 s92,s92,s93
v_fmaak_f32 v6,v6,v4,0xc0135761
v_mul_f32 v5,v5,v48
MA v[68:71],v[20:23],v[208:211],v[68:71]
RT v[16:17],v3,2560
RT v[18:19],v3,3584
v_mul_f32 v6,v6,v49
MA v[76:79],v[20:23],v[212:215],v[76:79]
v_exp_f32 v5,v5
WL 6
MA v[64:67],v[24:27],v[216:219],v[64:67]
RT v[20:21],v3,2816
RT v[22:23],v3,3840
MA v[72:75],v[24:27],v[220:223],v[72:75]
v_exp_f32 v6,v6
MA v[68:71],v[28:31],v[216:219],v[68:71]
RT v[24:25],v3,4608
v_add_f32 v5,1.0,v5
v_add_f32 v6,1.0,v6
v_rcp_f32 v5,v5
v_rcp_f32 v6,v6
MA v[76:79],v[28:31],v[220:223],v[76:79]
RT v[26:27],v3,5632
v_mul_f32 v48,v48,v5
v_mul_f32 v49,v49,v6
v_mul_f32 v5,v50,v50
v_mul_f32 v6,v51,v51
s_nop 3
v_mul_f32 v32,v32,v64
v_mul_f32 v40,v40,v72
v_mul_f32 v33,v33,v65
v_mul_f32 v41,v41,v73
CV v32,v32,v33
CV v40,v40,v41
v_mul_f32 v34,v34,v66
v_mul_f32 v42,v42,v74
v_mul_f32 v35,v35,v67
v_mul_f32 v43,v43,v75
CV v33,v34,v35
CV v41,v42,v43
WL 6
MA v[64:67],v[8:11],v[80:83],0
RT v[28:29],v3,4864
s_add_u32 m0,s65,36864
v_fmaak_f32 v5,v5,v4,0xc0135761
MA v[72:75],v[8:11],v[84:87],0
RT v[30:31],v3,5888
buffer_load_dwordx4 v1,s[28:31],s44 offen offset:0 lds
v_fmaak_f32 v6,v6,v4,0xc0135761
v_mul_f32 v36,v36,v68
v_mul_f32 v44,v44,v76
v_mul_f32 v37,v37,v69
v_mul_f32 v45,v45,v77
CV v34,v36,v37
CV v42,v44,v45
v_mul_f32 v38,v38,v70
v_mul_f32 v46,v46,v78
v_mul_f32 v39,v39,v71
v_mul_f32 v47,v47,v79
CV v35,v38,v39
CV v43,v46,v47
s_nop 0
MA v[68:71],v[12:15],v[80:83],0
RT v[8:9],v3,6656
v_mul_f32 v5,v5,v50
MA v[76:79],v[12:15],v[84:87],0
RT v[10:11],v3,7680
WL 6
MA v[64:67],v[16:19],v[88:91],v[64:67]
RT v[12:13],v3,6912
MA v[72:75],v[16:19],v[92:95],v[72:75]
RT v[14:15],v3,7936
v_mul_f32 v6,v6,v51
MA v[68:71],v[20:23],v[88:91],v[68:71]
RT v[16:17],v3,8704
MA v[76:79],v[20:23],v[92:95],v[76:79]
RT v[18:19],v3,9728
WL 6
MA v[64:67],v[24:27],v[96:99],v[64:67]
RT v[20:21],v3,8960
RT v[22:23],v3,9984
MA v[72:75],v[24:27],v[100:103],v[72:75]
buffer_load_dwordx4 v1,s[28:31],s45 offen offset:1024 lds
MA v[68:71],v[28:31],v[96:99],v[68:71]
RT v[24:25],v3,10752
v_exp_f32 v5,v5
MA v[76:79],v[28:31],v[100:103],v[76:79]
RT v[26:27],v3,11776
v_exp_f32 v6,v6
WL 6
MA v[64:67],v[8:11],v[104:107],v[64:67]
RT v[28:29],v3,11008
v_add_f32 v5,1.0,v5
MA v[72:75],v[8:11],v[108:111],v[72:75]
RT v[30:31],v3,12032
v_add_f32 v6,1.0,v6
MA v[68:71],v[12:15],v[104:107],v[68:71]
RT v[8:9],v3,12800
v_rcp_f32 v5,v5
MA v[76:79],v[12:15],v[108:111],v[76:79]
RT v[10:11],v3,13824
WL 6
MA v[64:67],v[16:19],v[112:115],v[64:67]
RT v[12:13],v3,13056
buffer_load_dwordx4 v1,s[28:31],s46 offen offset:2048 lds
MA v[72:75],v[16:19],v[116:119],v[72:75]
RT v[14:15],v3,14080
v_rcp_f32 v6,v6
MA v[68:71],v[20:23],v[112:115],v[68:71]
RT v[16:17],v3,14848
v_mul_f32 v50,v50,v5
MA v[76:79],v[20:23],v[116:119],v[76:79]
RT v[18:19],v3,15872
v_mul_f32 v51,v51,v6
WL 6
MA v[64:67],v[24:27],v[120:123],v[64:67]
RT v[20:21],v3,15104
v_mul_f32 v5,v52,v52
MA v[72:75],v[24:27],v[124:127],v[72:75]
RT v[22:23],v3,16128
v_mul_f32 v6,v53,v53
v_fmaak_f32 v5,v5,v4,0xc0135761
MA v[68:71],v[28:31],v[120:123],v[68:71]
RT v[24:25],v3,16896
v_fmaak_f32 v6,v6,v4,0xc0135761
MA v[76:79],v[28:31],v[124:127],v[76:79]
RT v[26:27],v3,17920
v_mul_f32 v5,v5,v52
WL 6
MA v[64:67],v[8:11],v[128:131],v[64:67]
RT v[28:29],v3,17152
buffer_load_dwordx4 v1,s[28:31],s47 offen offset:3072 lds
MA v[72:75],v[8:11],v[132:135],v[72:75]
RT v[30:31],v3,18176
v_mul_f32 v6,v6,v53
v_exp_f32 v5,v5
MA v[68:71],v[12:15],v[128:131],v[68:71]
RT v[8:9],v3,37376
v_exp_f32 v6,v6
MA v[76:79],v[12:15],v[132:135],v[76:79]
RT v[10:11],v3,38400
WL 6
MA v[64:67],v[16:19],v[136:139],v[64:67]
RT v[12:13],v3,37632
v_add_f32 v5,1.0,v5
MA v[72:75],v[16:19],v[140:143],v[72:75]
RT v[14:15],v3,38656
v_add_f32 v6,1.0,v6
MA v[68:71],v[20:23],v[136:139],v[68:71]
RT v[16:17],v3,39424
v_rcp_f32 v5,v5
MA v[76:79],v[20:23],v[140:143],v[76:79]
RT v[18:19],v3,40448
v_rcp_f32 v6,v6
WL 6
MA v[64:67],v[24:27],v[144:147],v[64:67]
RT v[20:21],v3,39680
s_add_u32 m0,s65,40960
v_mul_f32 v52,v52,v5
MA v[72:75],v[24:27],v[148:151],v[72:75]
RT v[22:23],v3,40704
buffer_load_dwordx4 v1,s[28:31],s48 offen offset:0 lds
MA v[68:71],v[28:31],v[144:147],v[68:71]
RT v[24:25],v3,41472
v_mul_f32 v53,v53,v6
v_mul_f32 v5,v54,v54
MA v[76:79],v[28:31],v[148:151],v[76:79]
RT v[26:27],v3,42496
v_mul_f32 v6,v55,v55
WL 6
MA v[64:67],v[8:11],v[152:155],v[64:67]
RT v[28:29],v3,41728
v_fmaak_f32 v5,v5,v4,0xc0135761
MA v[72:75],v[8:11],v[156:159],v[72:75]
RT v[30:31],v3,42752
v_fmaak_f32 v6,v6,v4,0xc0135761
MA v[68:71],v[12:15],v[152:155],v[68:71]
RT v[8:9],v3,43520
v_mul_f32 v5,v5,v54
MA v[76:79],v[12:15],v[156:159],v[76:79]
RT v[10:11],v3,44544
v_mul_f32 v6,v6,v55
WL 6
MA v[64:67],v[16:19],v[160:163],v[64:67]
RT v[12:13],v3,43776
RT v[14:15],v3,44800
buffer_load_dwordx4 v1,s[28:31],s49 offen offset:1024 lds
MA v[72:75],v[16:19],v[164:167],v[72:75]
v_exp_f32 v5,v5
v_exp_f32 v6,v6
MA v[68:71],v[20:23],v[160:163],v[68:71]
RT v[16:17],v3,45568
v_add_f32 v5,1.0,v5
MA v[76:79],v[20:23],v[164:167],v[76:79]
RT v[18:19],v3,46592
WL 6
MA v[64:67],v[24:27],v[168:171],v[64:67]
RT v[20:21],v3,45824
v_add_f32 v6,1.0,v6
MA v[72:75],v[24:27],v[172:175],v[72:75]
RT v[22:23],v3,46848
v_rcp_f32 v5,v5
MA v[68:71],v[28:31],v[168:171],v[68:71]
RT v[24:25],v3,47616
v_rcp_f32 v6,v6
MA v[76:79],v[28:31],v[172:175],v[76:79]
RT v[26:27],v3,48640
WL 6
MA v[64:67],v[8:11],v[176:179],v[64:67]
RT v[28:29],v3,47872
buffer_load_dwordx4 v1,s[28:31],s50 offen offset:2048 lds
MA v[72:75],v[8:11],v[180:183],v[72:75]
RT v[30:31],v3,48896
v_mul_f32 v54,v54,v5
v_mul_f32 v55,v55,v6
MA v[68:71],v[12:15],v[176:179],v[68:71]
RT v[8:9],v3,49664
v_mul_f32 v5,v56,v56
v_mul_f32 v6,v57,v57
MA v[76:79],v[12:15],v[180:183],v[76:79]
RT v[10:11],v3,50688
v_fmaak_f32 v5,v5,v4,0xc0135761
WL 6
MA v[64:67],v[16:19],v[184:187],v[64:67]
RT v[12:13],v3,49920
v_fmaak_f32 v6,v6,v4,0xc0135761
MA v[72:75],v[16:19],v[188:191],v[72:75]
RT v[14:15],v3,50944
v_mul_f32 v5,v5,v56
MA v[68:71],v[20:23],v[184:187],v[68:71]
RT v[16:17],v3,51712
RT v[18:19],v3,52736
v_mul_f32 v6,v6,v57
MA v[76:79],v[20:23],v[188:191],v[76:79]
v_exp_f32 v5,v5
WL 6
MA v[64:67],v[24:27],v[192:195],v[64:67]
RT v[20:21],v3,51968
buffer_load_dwordx4 v1,s[28:31],s51 offen offset:3072 lds
MA v[72:75],v[24:27],v[196:199],v[72:75]
RT v[22:23],v3,52992
v_exp_f32 v6,v6
MA v[68:71],v[28:31],v[192:195],v[68:71]
RT v[24:25],v3,53760
v_add_f32 v5,1.0,v5
MA v[76:79],v[28:31],v[196:199],v[76:79]
RT v[26:27],v3,54784
v_add_f32 v6,1.0,v6
WL 6
MA v[64:67],v[8:11],v[200:203],v[64:67]
RT v[28:29],v3,54016
v_rcp_f32 v5,v5
MA v[72:75],v[8:11],v[204:207],v[72:75]
RT v[30:31],v3,55040
v_rcp_f32 v6,v6
MA v[68:71],v[12:15],v[200:203],v[68:71]
s_waitcnt vmcnt(9)
s_barrier
RT v[8:9],v0,0
v_mul_f32 v56,v56,v5
MA v[76:79],v[12:15],v[204:207],v[76:79]
RT v[10:11],v0,9216
WL 6
MA v[64:67],v[16:19],v[208:211],v[64:67]
RT v[12:13],v0,256
s_add_u32 m0,s65,45056
v_mul_f32 v57,v57,v6
buffer_load_dwordx4 v1,s[28:31],s52 offen offset:0 lds
MA v[72:75],v[16:19],v[212:215],v[72:75]
RT v[14:15],v0,9472
v_add_u32 v1,2654208,v1
v_mul_f32 v5,v58,v58
v_mul_f32 v6,v59,v59
MA v[68:71],v[20:23],v[208:211],v[68:71]
RT v[16:17],v0,512
v_fmaak_f32 v5,v5,v4,0xc0135761
MA v[76:79],v[20:23],v[212:215],v[76:79]
RT v[18:19],v0,9728
v_fmaak_f32 v6,v6,v4,0xc0135761
WL 6
MA v[64:67],v[24:27],v[216:219],v[64:67]
RT v[20:21],v0,768
v_mul_f32 v5,v5,v58
MA v[72:75],v[24:27],v[220:223],v[72:75]
RT v[22:23],v0,9984
v_mul_f32 v6,v6,v59
MA v[68:71],v[28:31],v[216:219],v[68:71]
RT v[24:25],v0,1024
v_exp_f32 v5,v5
MA v[76:79],v[28:31],v[220:223],v[76:79]
RT v[26:27],v0,10240
v_exp_f32 v6,v6
WL 6
MA a[0:3],v[8:11],v[32:35],0
RT v[28:29],v0,1280
s_add_u32 m0,s66,0
v_add_f32 v5,1.0,v5
MA a[4:7],v[8:11],v[40:43],0
RT v[30:31],v0,10496
buffer_load_dwordx4 v1,s[28:31],s44 offen offset:0 lds
MA a[8:11],v[12:15],v[32:35],0
RT v[8:9],v0,1536
RT v[10:11],v0,10752
v_add_f32 v6,1.0,v6
MA a[12:15],v[12:15],v[40:43],0
v_rcp_f32 v5,v5
WL 6
MA a[16:19],v[16:19],v[32:35],0
RT v[12:13],v0,1792
RT v[14:15],v0,11008
MA a[20:23],v[16:19],v[40:43],0
v_rcp_f32 v6,v6
MA a[24:27],v[20:23],v[32:35],0
RT v[16:17],v0,2048
v_mul_f32 v58,v58,v5
MA a[28:31],v[20:23],v[40:43],0
RT v[18:19],v0,11264
v_mul_f32 v59,v59,v6
WL 6
MA a[32:35],v[24:27],v[32:35],0
RT v[20:21],v0,2304
buffer_load_dwordx4 v1,s[28:31],s45 offen offset:1024 lds
MA a[36:39],v[24:27],v[40:43],0
RT v[22:23],v0,11520
v_mul_f32 v5,v60,v60
v_mul_f32 v6,v61,v61
v_fmaak_f32 v5,v5,v4,0xc0135761
MA a[40:43],v[28:31],v[32:35],0
RT v[24:25],v0,2560
v_fmaak_f32 v6,v6,v4,0xc0135761
MA a[44:47],v[28:31],v[40:43],0
RT v[26:27],v0,11776
v_mul_f32 v5,v5,v60
WL 6
MA a[48:51],v[8:11],v[32:35],0
RT v[28:29],v0,2816
v_mul_f32 v6,v6,v61
MA a[52:55],v[8:11],v[40:43],0
RT v[30:31],v0,12032
v_exp_f32 v5,v5
MA a[56:59],v[12:15],v[32:35],0
RT v[8:9],v0,3072
v_exp_f32 v6,v6
MA a[60:63],v[12:15],v[40:43],0
RT v[10:11],v0,12288
WL 6
MA a[64:67],v[16:19],v[32:35],0
RT v[12:13],v0,3328
buffer_load_dwordx4 v1,s[28:31],s46 offen offset:2048 lds
MA a[68:71],v[16:19],v[40:43],0
RT v[14:15],v0,12544
v_add_f32 v5,1.0,v5
v_add_f32 v6,1.0,v6
MA a[72:75],v[20:23],v[32:35],0
RT v[16:17],v0,3584
v_rcp_f32 v5,v5
MA a[76:79],v[20:23],v[40:43],0
RT v[18:19],v0,12800
v_rcp_f32 v6,v6
WL 6
MA a[80:83],v[24:27],v[32:35],0
RT v[20:21],v0,3840
v_mul_f32 v60,v60,v5
MA a[84:87],v[24:27],v[40:43],0
RT v[22:23],v0,13056
v_mul_f32 v61,v61,v6
MA a[88:91],v[28:31],v[32:35],0
RT v[24:25],v0,4096
v_mul_f32 v5,v62,v62
MA a[92:95],v[28:31],v[40:43],0
RT v[26:27],v0,13312
v_mul_f32 v6,v63,v63
WL 6
MA a[96:99],v[8:11],v[32:35],0
RT v[28:29],v0,4352
buffer_load_dwordx4 v1,s[28:31],s47 offen offset:3072 lds
MA a[100:103],v[8:11],v[40:43],0
RT v[30:31],v0,13568
v_fmaak_f32 v5,v5,v4,0xc0135761
v_fmaak_f32 v6,v6,v4,0xc0135761
MA a[104:107],v[12:15],v[32:35],0
RT v[8:9],v0,4608
v_mul_f32 v5,v5,v62
MA a[108:111],v[12:15],v[40:43],0
RT v[10:11],v0,13824
v_mul_f32 v6,v6,v63
WL 6
MA a[112:115],v[16:19],v[32:35],0
RT v[12:13],v0,4864
v_exp_f32 v5,v5
MA a[116:119],v[16:19],v[40:43],0
RT v[14:15],v0,14080
v_exp_f32 v6,v6
MA a[120:123],v[20:23],v[32:35],0
RT v[16:17],v0,5120
v_add_f32 v5,1.0,v5
MA a[124:127],v[20:23],v[40:43],0
RT v[18:19],v0,14336
WL 6
MA a[128:131],v[24:27],v[32:35],0
RT v[20:21],v0,5376
RT v[22:23],v0,14592
s_add_u32 m0,s66,4096
v_add_f32 v6,1.0,v6
MA a[132:135],v[24:27],v[40:43],0
buffer_load_dwordx4 v1,s[28:31],s48 offen offset:0 lds
v_rcp_f32 v5,v5
MA a[136:139],v[28:31],v[32:35],0
RT v[24:25],v0,5632
v_rcp_f32 v6,v6
MA a[140:143],v[28:31],v[40:43],0
RT v[26:27],v0,14848
WL 6
MA a[144:147],v[8:11],v[32:35],0
RT v[28:29],v0,5888
v_mul_f32 v62,v62,v5
MA a[148:151],v[8:11],v[40:43],0
RT v[30:31],v0,15104
v_mul_f32 v63,v63,v6
MA a[152:155],v[12:15],v[32:35],0
RT v[8:9],v0,6144
v_mul_f32 v48,v48,v64
MA a[156:159],v[12:15],v[40:43],0
RT v[10:11],v0,15360
WL 6
MA a[160:163],v[16:19],v[32:35],0
RT v[12:13],v0,6400
buffer_load_dwordx4 v1,s[28:31],s49 offen offset:1024 lds
MA a[164:167],v[16:19],v[40:43],0
RT v[14:15],v0,15616
v_mul_f32 v49,v49,v65
MA a[168:171],v[20:23],v[32:35],0
RT v[16:17],v0,6656
CV v64,v48,v49
MA a[172:175],v[20:23],v[40:43],0
RT v[18:19],v0,15872
v_mul_f32 v50,v50,v66
WL 6
MA a[176:179],v[24:27],v[32:35],0
RT v[20:21],v0,6912
v_mul_f32 v51,v51,v67
MA a[180:183],v[24:27],v[40:43],0
RT v[22:23],v0,16128
CV v65,v50,v51
MA a[184:187],v[28:31],v[32:35],0
RT v[24:25],v0,7168
v_mul_f32 v52,v52,v68
MA a[188:191],v[28:31],v[40:43],0
RT v[26:27],v0,16384
WL 6
MA a[192:195],v[8:11],v[32:35],0
RT v[28:29],v0,7424
buffer_load_dwordx4 v1,s[28:31],s50 offen offset:2048 lds
MA a[196:199],v[8:11],v[40:43],0
RT v[30:31],v0,16640
v_mul_f32 v53,v53,v69
MA a[200:203],v[12:15],v[32:35],0
RT v[8:9],v0,7680
CV v66,v52,v53
MA a[204:207],v[12:15],v[40:43],0
RT v[10:11],v0,16896
v_mul_f32 v54,v54,v70
WL 6
MA a[208:211],v[16:19],v[32:35],0
RT v[12:13],v0,7936
v_mul_f32 v55,v55,v71
MA a[212:215],v[16:19],v[40:43],0
RT v[14:15],v0,17152
CV v67,v54,v55
MA a[216:219],v[20:23],v[32:35],0
RT v[16:17],v0,8192
v_mul_f32 v56,v56,v72
MA a[220:223],v[20:23],v[40:43],0
RT v[18:19],v0,17408
WL 6
MA a[224:227],v[24:27],v[32:35],0
RT v[20:21],v0,8448
buffer_load_dwordx4 v1,s[28:31],s51 offen offset:3072 lds
MA a[228:231],v[24:27],v[40:43],0
RT v[22:23],v0,17664
v_mul_f32 v57,v57,v73
CV v72,v56,v57
MA a[232:235],v[28:31],v[32:35],0
RT v[24:25],v0,8704
v_mul_f32 v58,v58,v74
MA a[236:239],v[28:31],v[40:43],0
RT v[26:27],v0,17920
WL 6
MA a[240:243],v[8:11],v[32:35],0
RT v[28:29],v0,8960
v_mul_f32 v59,v59,v75
MA a[244:247],v[8:11],v[40:43],0
RT v[30:31],v0,18176
CV v73,v58,v59
MA a[248:251],v[12:15],v[32:35],0
s_waitcnt vmcnt(8)
s_barrier
RT v[8:9],v0,36864
v_mul_f32 v60,v60,v76
MA a[252:255],v[12:15],v[40:43],0
RT v[10:11],v0,37888
v_mul_f32 v61,v61,v77
WL 6
MA v[224:227],v[16:19],v[32:35],0
RT v[12:13],v0,37120
s_add_u32 m0,s66,8192
CV v74,v60,v61
MA v[228:231],v[16:19],v[40:43],0
RT v[14:15],v0,38144
buffer_load_dwordx4 v1,s[28:31],s52 offen offset:0 lds
v_add_u32 v1,4292313088,v1
MA v[232:235],v[20:23],v[32:35],0
RT v[16:17],v0,38912
v_mul_f32 v62,v62,v78
MA v[236:239],v[20:23],v[40:43],0
RT v[18:19],v0,39936
v_mul_f32 v63,v63,v79
WL 6
MA v[240:243],v[24:27],v[32:35],0
RT v[20:21],v0,39168
MA v[244:247],v[24:27],v[40:43],0
RT v[22:23],v0,40192
CV v75,v62,v63
MA v[248:251],v[28:31],v[32:35],0
RT v[24:25],v0,40960
MA v[252:255],v[28:31],v[40:43],0
RT v[26:27],v0,41984
L_mlp_loop:
WL 6
MA v[32:35],v[8:11],v[80:83],0
RT v[28:29],v0,41216
MA v[40:43],v[8:11],v[84:87],0
RT v[30:31],v0,42240
MA v[36:39],v[12:15],v[80:83],0
RT v[8:9],v0,43008
MA v[44:47],v[12:15],v[84:87],0
RT v[10:11],v0,44032
WL 6
MA v[32:35],v[16:19],v[88:91],v[32:35]
RT v[12:13],v0,43264
s_add_u32 m0,s66,36864
s_nop 0
MA v[40:43],v[16:19],v[92:95],v[40:43]
RT v[14:15],v0,44288
buffer_load_dwordx4 v2,s[36:39],s53 offen offset:0 lds
MA v[36:39],v[20:23],v[88:91],v[36:39]
RT v[16:17],v0,45056
MA v[44:47],v[20:23],v[92:95],v[44:47]
RT v[18:19],v0,46080
WL 6
MA v[32:35],v[24:27],v[96:99],v[32:35]
RT v[20:21],v0,45312
MA v[40:43],v[24:27],v[100:103],v[40:43]
RT v[22:23],v0,46336
MA v[36:39],v[28:31],v[96:99],v[36:39]
RT v[24:25],v0,47104
MA v[44:47],v[28:31],v[100:103],v[44:47]
RT v[26:27],v0,48128
WL 6
MA v[32:35],v[8:11],v[104:107],v[32:35]
RT v[28:29],v0,47360
RT v[30:31],v0,48384
MA v[40:43],v[8:11],v[108:111],v[40:43]
buffer_load_dwordx4 v2,s[36:39],s54 offen offset:1024 lds
MA v[36:39],v[12:15],v[104:107],v[36:39]
RT v[8:9],v0,49152
MA v[44:47],v[12:15],v[108:111],v[44:47]
RT v[10:11],v0,50176
WL 6
MA v[32:35],v[16:19],v[112:115],v[32:35]
RT v[12:13],v0,49408
MA v[40:43],v[16:19],v[116:119],v[40:43]
RT v[14:15],v0,50432
MA v[36:39],v[20:23],v[112:115],v[36:39]
RT v[16:17],v0,51200
MA v[44:47],v[20:23],v[116:119],v[44:47]
RT v[18:19],v0,52224
WL 6
MA v[32:35],v[24:27],v[120:123],v[32:35]
RT v[20:21],v0,51456
RT v[22:23],v0,52480
MA v[40:43],v[24:27],v[124:127],v[40:43]
buffer_load_dwordx4 v2,s[36:39],s55 offen offset:2048 lds
MA v[36:39],v[28:31],v[120:123],v[36:39]
RT v[24:25],v0,53248
MA v[44:47],v[28:31],v[124:127],v[44:47]
RT v[26:27],v0,54272
WL 6
MA v[32:35],v[8:11],v[128:131],v[32:35]
RT v[28:29],v0,53504
MA v[40:43],v[8:11],v[132:135],v[40:43]
RT v[30:31],v0,54528
MA v[36:39],v[12:15],v[128:131],v[36:39]
s_waitcnt vmcnt(3)
s_barrier
RT v[8:9],v3,0
MA v[44:47],v[12:15],v[132:135],v[44:47]
RT v[10:11],v3,1024
WL 6
MA v[32:35],v[16:19],v[136:139],v[32:35]
RT v[12:13],v3,256
RT v[14:15],v3,1280
MA v[40:43],v[16:19],v[140:143],v[40:43]
buffer_load_dwordx4 v2,s[36:39],s56 offen offset:3072 lds
MA v[36:39],v[20:23],v[136:139],v[36:39]
RT v[16:17],v3,2048
MA v[44:47],v[20:23],v[140:143],v[44:47]
RT v[18:19],v3,3072
WL 6
MA v[32:35],v[24:27],v[144:147],v[32:35]
RT v[20:21],v3,2304
MA v[40:43],v[24:27],v[148:151],v[40:43]
RT v[22:23],v3,3328
MA v[36:39],v[28:31],v[144:147],v[36:39]
RT v[24:25],v3,4096
MA v[44:47],v[28:31],v[148:151],v[44:47]
RT v[26:27],v3,5120
WL 6
MA v[32:35],v[8:11],v[152:155],v[32:35]
RT v[28:29],v3,4352
s_add_u32 m0,s66,40960
s_nop 0
MA v[40:43],v[8:11],v[156:159],v[40:43]
RT v[30:31],v3,5376
buffer_load_dwordx4 v2,s[36:39],s57 offen offset:0 lds
MA v[36:39],v[12:15],v[152:155],v[36:39]
RT v[8:9],v3,6144
MA v[44:47],v[12:15],v[156:159],v[44:47]
RT v[10:11],v3,7168
WL 6
MA v[32:35],v[16:19],v[160:163],v[32:35]
RT v[12:13],v3,6400
MA v[40:43],v[16:19],v[164:167],v[40:43]
RT v[14:15],v3,7424
MA v[36:39],v[20:23],v[160:163],v[36:39]
RT v[16:17],v3,8192
MA v[44:47],v[20:23],v[164:167],v[44:47]
RT v[18:19],v3,9216
WL 6
MA v[32:35],v[24:27],v[168:171],v[32:35]
RT v[20:21],v3,8448
RT v[22:23],v3,9472
MA v[40:43],v[24:27],v[172:175],v[40:43]
buffer_load_dwordx4 v2,s[36:39],s58 offen offset:1024 lds
MA v[36:39],v[28:31],v[168:171],v[36:39]
RT v[24:25],v3,10240
MA v[44:47],v[28:31],v[172:175],v[44:47]
RT v[26:27],v3,11264
WL 6
MA v[32:35],v[8:11],v[176:179],v[32:35]
RT v[28:29],v3,10496
MA v[40:43],v[8:11],v[180:183],v[40:43]
RT v[30:31],v3,11520
MA v[36:39],v[12:15],v[176:179],v[36:39]
RT v[8:9],v3,12288
MA v[44:47],v[12:15],v[180:183],v[44:47]
RT v[10:11],v3,13312
WL 6
MA v[32:35],v[16:19],v[184:187],v[32:35]
RT v[12:13],v3,12544
RT v[14:15],v3,13568
MA v[40:43],v[16:19],v[188:191],v[40:43]
buffer_load_dwordx4 v2,s[36:39],s59 offen offset:2048 lds
MA v[36:39],v[20:23],v[184:187],v[36:39]
RT v[16:17],v3,14336
MA v[44:47],v[20:23],v[188:191],v[44:47]
RT v[18:19],v3,15360
WL 6
MA v[32:35],v[24:27],v[192:195],v[32:35]
RT v[20:21],v3,14592
MA v[40:43],v[24:27],v[196:199],v[40:43]
RT v[22:23],v3,15616
MA v[36:39],v[28:31],v[192:195],v[36:39]
RT v[24:25],v3,16384
MA v[44:47],v[28:31],v[196:199],v[44:47]
RT v[26:27],v3,17408
WL 6
MA v[32:35],v[8:11],v[200:203],v[32:35]
RT v[28:29],v3,16640
RT v[30:31],v3,17664
MA v[40:43],v[8:11],v[204:207],v[40:43]
buffer_load_dwordx4 v2,s[36:39],s60 offen offset:3072 lds
MA v[36:39],v[12:15],v[200:203],v[36:39]
RT v[8:9],v0,37376
MA v[44:47],v[12:15],v[204:207],v[44:47]
RT v[10:11],v0,38400
WL 6
MA v[32:35],v[16:19],v[208:211],v[32:35]
RT v[12:13],v0,37632
MA v[40:43],v[16:19],v[212:215],v[40:43]
RT v[14:15],v0,38656
MA v[36:39],v[20:23],v[208:211],v[36:39]
RT v[16:17],v0,39424
MA v[44:47],v[20:23],v[212:215],v[44:47]
RT v[18:19],v0,40448
WL 6
MA v[32:35],v[24:27],v[216:219],v[32:35]
RT v[20:21],v0,39680
s_add_u32 m0,s66,45056
s_nop 0
MA v[40:43],v[24:27],v[220:223],v[40:43]
RT v[22:23],v0,40704
buffer_load_dwordx4 v2,s[36:39],s61 offen offset:0 lds
v_add_u32 v2,36864,v2
MA v[36:39],v[28:31],v[216:219],v[36:39]
RT v[24:25],v0,41472
MA v[44:47],v[28:31],v[220:223],v[44:47]
RT v[26:27],v0,42496
WL 6
MA v[48:51],v[8:11],v[80:83],0
RT v[28:29],v0,41728
s_add_u32 m0,s65,0
s_nop 0
MA v[56:59],v[8:11],v[84:87],0
RT v[30:31],v0,42752
buffer_load_dwordx4 v1,s[32:35],s44 offen offset:0 lds
MA v[52:55],v[12:15],v[80:83],0
RT v[8:9],v0,43520
MA v[60:63],v[12:15],v[84:87],0
RT v[10:11],v0,44544
WL 6
MA v[48:51],v[16:19],v[88:91],v[48:51]
RT v[12:13],v0,43776
MA v[56:59],v[16:19],v[92:95],v[56:59]
RT v[14:15],v0,44800
MA v[52:55],v[20:23],v[88:91],v[52:55]
RT v[16:17],v0,45568
v_mul_f32 v5,v32,v32
MA v[60:63],v[20:23],v[92:95],v[60:63]
RT v[18:19],v0,46592
WL 6
MA v[48:51],v[24:27],v[96:99],v[48:51]
RT v[20:21],v0,45824
RT v[22:23],v0,46848
MA v[56:59],v[24:27],v[100:103],v[56:59]
buffer_load_dwordx4 v1,s[32:35],s45 offen offset:1024 lds
MA v[52:55],v[28:31],v[96:99],v[52:55]
RT v[24:25],v0,47616
v_mul_f32 v6,v33,v33
MA v[60:63],v[28:31],v[100:103],v[60:63]
RT v[26:27],v0,48640
WL 6
MA v[48:51],v[8:11],v[104:107],v[48:51]
RT v[28:29],v0,47872
v_fmaak_f32 v5,v5,v4,0xc0135761
MA v[56:59],v[8:11],v[108:111],v[56:59]
RT v[30:31],v0,48896
v_fmaak_f32 v6,v6,v4,0xc0135761
MA v[52:55],v[12:15],v[104:107],v[52:55]
RT v[8:9],v0,49664
v_mul_f32 v5,v5,v32
MA v[60:63],v[12:15],v[108:111],v[60:63]
RT v[10:11],v0,50688
WL 6
MA v[48:51],v[16:19],v[112:115],v[48:51]
RT v[12:13],v0,49920
buffer_load_dwordx4 v1,s[32:35],s46 offen offset:2048 lds
MA v[56:59],v[16:19],v[116:119],v[56:59]
RT v[14:15],v0,50944
v_mul_f32 v6,v6,v33
MA v[52:55],v[20:23],v[112:115],v[52:55]
RT v[16:17],v0,51712
v_exp_f32 v5,v5
MA v[60:63],v[20:23],v[116:119],v[60:63]
RT v[18:19],v0,52736
WL 6
MA v[48:51],v[24:27],v[120:123],v[48:51]
RT v[20:21],v0,51968
RT v[22:23],v0,52992
MA v[56:59],v[24:27],v[124:127],v[56:59]
v_exp_f32 v6,v6
MA v[52:55],v[28:31],v[120:123],v[52:55]
RT v[24:25],v0,53760
v_add_f32 v5,1.0,v5
MA v[60:63],v[28:31],v[124:127],v[60:63]
RT v[26:27],v0,54784
WL 6
MA v[48:51],v[8:11],v[128:131],v[48:51]
RT v[28:29],v0,54016
buffer_load_dwordx4 v1,s[32:35],s47 offen offset:3072 lds
MA v[56:59],v[8:11],v[132:135],v[56:59]
RT v[30:31],v0,55040
v_add_f32 v6,1.0,v6
v_rcp_f32 v5,v5
MA v[52:55],v[12:15],v[128:131],v[52:55]
RT v[8:9],v3,512
v_rcp_f32 v6,v6
MA v[60:63],v[12:15],v[132:135],v[60:63]
RT v[10:11],v3,1536
WL 6
MA v[48:51],v[16:19],v[136:139],v[48:51]
RT v[12:13],v3,768
v_mul_f32 v32,v32,v5
MA v[56:59],v[16:19],v[140:143],v[56:59]
RT v[14:15],v3,1792
v_mul_f32 v33,v33,v6
MA v[52:55],v[20:23],v[136:139],v[52:55]
RT v[16:17],v3,2560
v_mul_f32 v5,v34,v34
MA v[60:63],v[20:23],v[140:143],v[60:63]
RT v[18:19],v3,3584
WL 6
MA v[48:51],v[24:27],v[144:147],v[48:51]
RT v[20:21],v3,2816
s_add_u32 m0,s65,4096
v_mul_f32 v6,v35,v35
MA v[56:59],v[24:27],v[148:151],v[56:59]
RT v[22:23],v3,3840
buffer_load_dwordx4 v1,s[32:35],s48 offen offset:0 lds
v_fmaak_f32 v5,v5,v4,0xc0135761
MA v[52:55],v[28:31],v[144:147],v[52:55]
RT v[24:25],v3,4608
v_fmaak_f32 v6,v6,v4,0xc0135761
MA v[60:63],v[28:31],v[148:151],v[60:63]
RT v[26:27],v3,5632
WL 6
MA v[48:51],v[8:11],v[152:155],v[48:51]
RT v[28:29],v3,4864
v_mul_f32 v5,v5,v34
MA v[56:59],v[8:11],v[156:159],v[56:59]
RT v[30:31],v3,5888
v_mul_f32 v6,v6,v35
MA v[52:55],v[12:15],v[152:155],v[52:55]
RT v[8:9],v3,6656
v_exp_f32 v5,v5
MA v[60:63],v[12:15],v[156:159],v[60:63]
RT v[10:11],v3,7680
WL 6
MA v[48:51],v[16:19],v[160:163],v[48:51]
RT v[12:13],v3,6912
buffer_load_dwordx4 v1,s[32:35],s49 offen offset:1024 lds
MA v[56:59],v[16:19],v[164:167],v[56:59]
RT v[14:15],v3,7936
v_exp_f32 v6,v6
MA v[52:55],v[20:23],v[160:163],v[52:55]
RT v[16:17],v3,8704
v_add_f32 v5,1.0,v5
MA v[60:63],v[20:23],v[164:167],v[60:63]
RT v[18:19],v3,9728
v_add_f32 v6,1.0,v6
WL 6
MA v[48:51],v[24:27],v[168:171],v[48:51]
RT v[20:21],v3,8960
RT v[22:23],v3,9984
MA v[56:59],v[24:27],v[172:175],v[56:59]
v_rcp_f32 v5,v5
MA v[52:55],v[28:31],v[168:171],v[52:55]
RT v[24:25],v3,10752
v_rcp_f32 v6,v6
MA v[60:63],v[28:31],v[172:175],v[60:63]
RT v[26:27],v3,11776
WL 6
MA v[48:51],v[8:11],v[176:179],v[48:51]
RT v[28:29],v3,11008
buffer_load_dwordx4 v1,s[32:35],s50 offen offset:2048 lds
MA v[56:59],v[8:11],v[180:183],v[56:59]
RT v[30:31],v3,12032
v_mul_f32 v34,v34,v5
MA v[52:55],v[12:15],v[176:179],v[52:55]
RT v[8:9],v3,12800
v_mul_f32 v35,v35,v6
MA v[60:63],v[12:15],v[180:183],v[60:63]
RT v[10:11],v3,13824
v_mul_f32 v5,v36,v36
WL 6
MA v[48:51],v[16:19],v[184:187],v[48:51]
RT v[12:13],v3,13056
v_mul_f32 v6,v37,v37
MA v[56:59],v[16:19],v[188:191],v[56:59]
RT v[14:15],v3,14080
v_fmaak_f32 v5,v5,v4,0xc0135761
MA v[52:55],v[20:23],v[184:187],v[52:55]
RT v[16:17],v3,14848
v_fmaak_f32 v6,v6,v4,0xc0135761
MA v[60:63],v[20:23],v[188:191],v[60:63]
RT v[18:19],v3,15872
v_mul_f32 v5,v5,v36
WL 6
MA v[48:51],v[24:27],v[192:195],v[48:51]
RT v[20:21],v3,15104
buffer_load_dwordx4 v1,s[32:35],s51 offen offset:3072 lds
MA v[56:59],v[24:27],v[196:199],v[56:59]
RT v[22:23],v3,16128
v_mul_f32 v6,v6,v37
MA v[52:55],v[28:31],v[192:195],v[52:55]
RT v[24:25],v3,16896
v_exp_f32 v5,v5
MA v[60:63],v[28:31],v[196:199],v[60:63]
RT v[26:27],v3,17920
WL 6
MA v[48:51],v[8:11],v[200:203],v[48:51]
RT v[28:29],v3,17152
RT v[30:31],v3,18176
MA v[56:59],v[8:11],v[204:207],v[56:59]
v_exp_f32 v6,v6
MA v[52:55],v[12:15],v[200:203],v[52:55]
s_waitcnt vmcnt(8)
s_barrier
RT v[8:9],v3,36864
v_add_f32 v5,1.0,v5
MA v[60:63],v[12:15],v[204:207],v[60:63]
RT v[10:11],v3,46080
v_add_f32 v6,1.0,v6
WL 6
MA v[48:51],v[16:19],v[208:211],v[48:51]
RT v[12:13],v3,37120
s_add_u32 m0,s65,8192
v_rcp_f32 v5,v5
MA v[56:59],v[16:19],v[212:215],v[56:59]
RT v[14:15],v3,46336
buffer_load_dwordx4 v1,s[32:35],s52 offen offset:0 lds
v_add_u32 v1,2654208,v1
MA v[52:55],v[20:23],v[208:211],v[52:55]
RT v[16:17],v3,37376
v_rcp_f32 v6,v6
MA v[60:63],v[20:23],v[212:215],v[60:63]
RT v[18:19],v3,46592
WL 6
MA v[48:51],v[24:27],v[216:219],v[48:51]
RT v[20:21],v3,37632
s_add_u32 m0,s65,36864
v_mul_f32 v36,v36,v5
MA v[56:59],v[24:27],v[220:223],v[56:59]
RT v[22:23],v3,46848
buffer_load_dwordx4 v1,s[32:35],s44 offen offset:0 lds
MA v[52:55],v[28:31],v[216:219],v[52:55]
RT v[24:25],v3,37888
v_mul_f32 v37,v37,v6
MA v[60:63],v[28:31],v[220:223],v[60:63]
RT v[26:27],v3,47104
v_mul_f32 v5,v38,v38
WL 6
MA a[0:3],v[8:11],v[64:67],a[0:3]
RT v[28:29],v3,38144
v_mul_f32 v6,v39,v39
MA a[4:7],v[8:11],v[72:75],a[4:7]
RT v[30:31],v3,47360
v_fmaak_f32 v5,v5,v4,0xc0135761
MA a[8:11],v[12:15],v[64:67],a[8:11]
RT v[8:9],v3,38400
v_fmaak_f32 v6,v6,v4,0xc0135761
MA a[12:15],v[12:15],v[72:75],a[12:15]
RT v[10:11],v3,47616
v_mul_f32 v5,v5,v38
WL 6
MA a[16:19],v[16:19],v[64:67],a[16:19]
RT v[12:13],v3,38656
buffer_load_dwordx4 v1,s[32:35],s45 offen offset:1024 lds
MA a[20:23],v[16:19],v[72:75],a[20:23]
RT v[14:15],v3,47872
v_mul_f32 v6,v6,v39
v_exp_f32 v5,v5
MA a[24:27],v[20:23],v[64:67],a[24:27]
RT v[16:17],v3,38912
MA a[28:31],v[20:23],v[72:75],a[28:31]
RT v[18:19],v3,48128
WL 6
MA a[32:35],v[24:27],v[64:67],a[32:35]
RT v[20:21],v3,39168
RT v[22:23],v3,48384
MA a[36:39],v[24:27],v[72:75],a[36:39]
v_exp_f32 v6,v6
MA a[40:43],v[28:31],v[64:67],a[40:43]
RT v[24:25],v3,39424
v_add_f32 v5,1.0,v5
MA a[44:47],v[28:31],v[72:75],a[44:47]
RT v[26:27],v3,48640
v_add_f32 v6,1.0,v6
WL 6
MA a[48:51],v[8:11],v[64:67],a[48:51]
RT v[28:29],v3,39680
buffer_load_dwordx4 v1,s[32:35],s46 offen offset:2048 lds
MA a[52:55],v[8:11],v[72:75],a[52:55]
RT v[30:31],v3,48896
v_rcp_f32 v5,v5
MA a[56:59],v[12:15],v[64:67],a[56:59]
RT v[8:9],v3,39936
v_rcp_f32 v6,v6
MA a[60:63],v[12:15],v[72:75],a[60:63]
RT v[10:11],v3,49152
WL 6
MA a[64:67],v[16:19],v[64:67],a[64:67]
RT v[12:13],v3,40192
v_mul_f32 v38,v38,v5
MA a[68:71],v[16:19],v[72:75],a[68:71]
RT v[14:15],v3,49408
v_mul_f32 v39,v39,v6
MA a[72:75],v[20:23],v[64:67],a[72:75]
RT v[16:17],v3,40448
v_mul_f32 v5,v40,v40
MA a[76:79],v[20:23],v[72:75],a[76:79]
RT v[18:19],v3,49664
WL 6
MA a[80:83],v[24:27],v[64:67],a[80:83]
RT v[20:21],v3,40704
buffer_load_dwordx4 v1,s[32:35],s47 offen offset:3072 lds
MA a[84:87],v[24:27],v[72:75],a[84:87]
RT v[22:23],v3,49920
v_mul_f32 v6,v41,v41
v_fmaak_f32 v5,v5,v4,0xc0135761
MA a[88:91],v[28:31],v[64:67],a[88:91]
RT v[24:25],v3,40960
v_fmaak_f32 v6,v6,v4,0xc0135761
MA a[92:95],v[28:31],v[72:75],a[92:95]
RT v[26:27],v3,50176
v_mul_f32 v5,v5,v40
WL 6
MA a[96:99],v[8:11],v[64:67],a[96:99]
RT v[28:29],v3,41216
v_mul_f32 v6,v6,v41
MA a[100:103],v[8:11],v[72:75],a[100:103]
RT v[30:31],v3,50432
v_exp_f32 v5,v5
MA a[104:107],v[12:15],v[64:67],a[104:107]
RT v[8:9],v3,41472
v_exp_f32 v6,v6
MA a[108:111],v[12:15],v[72:75],a[108:111]
RT v[10:11],v3,50688
WL 6
MA a[112:115],v[16:19],v[64:67],a[112:115]
RT v[12:13],v3,41728
s_add_u32 m0,s65,40960
v_add_f32 v5,1.0,v5
MA a[116:119],v[16:19],v[72:75],a[116:119]
RT v[14:15],v3,50944
buffer_load_dwordx4 v1,s[32:35],s48 offen offset:0 lds
MA a[120:123],v[20:23],v[64:67],a[120:123]
RT v[16:17],v3,41984
v_add_f32 v6,1.0,v6
MA a[124:127],v[20:23],v[72:75],a[124:127]
RT v[18:19],v3,51200
WL 6
MA a[128:131],v[24:27],v[64:67],a[128:131]
RT v[20:21],v3,42240
RT v[22:23],v3,51456
MA a[132:135],v[24:27],v[72:75],a[132:135]
v_rcp_f32 v5,v5
MA a[136:139],v[28:31],v[64:67],a[136:139]
RT v[24:25],v3,42496
v_rcp_f32 v6,v6
MA a[140:143],v[28:31],v[72:75],a[140:143]
RT v[26:27],v3,51712
WL 6
MA a[144:147],v[8:11],v[64:67],a[144:147]
RT v[28:29],v3,42752
buffer_load_dwordx4 v1,s[32:35],s49 offen offset:1024 lds
MA a[148:151],v[8:11],v[72:75],a[148:151]
RT v[30:31],v3,51968
v_mul_f32 v40,v40,v5
v_mul_f32 v41,v41,v6
MA a[152:155],v[12:15],v[64:67],a[152:155]
RT v[8:9],v3,43008
v_mul_f32 v5,v42,v42
MA a[156:159],v[12:15],v[72:75],a[156:159]
RT v[10:11],v3,52224
v_mul_f32 v6,v43,v43
WL 6
MA a[160:163],v[16:19],v[64:67],a[160:163]
RT v[12:13],v3,43264
v_fmaak_f32 v5,v5,v4,0xc0135761
MA a[164:167],v[16:19],v[72:75],a[164:167]
RT v[14:15],v3,52480
v_fmaak_f32 v6,v6,v4,0xc0135761
MA a[168:171],v[20:23],v[64:67],a[168:171]
RT v[16:17],v3,43520
v_mul_f32 v5,v5,v42
MA a[172:175],v[20:23],v[72:75],a[172:175]
RT v[18:19],v3,52736
WL 6
MA a[176:179],v[24:27],v[64:67],a[176:179]
RT v[20:21],v3,43776
buffer_load_dwordx4 v1,s[32:35],s50 offen offset:2048 lds
MA a[180:183],v[24:27],v[72:75],a[180:183]
RT v[22:23],v3,52992
v_mul_f32 v6,v6,v43
v_exp_f32 v5,v5
MA a[184:187],v[28:31],v[64:67],a[184:187]
RT v[24:25],v3,44032
v_exp_f32 v6,v6
MA a[188:191],v[28:31],v[72:75],a[188:191]
RT v[26:27],v3,53248
WL 6
MA a[192:195],v[8:11],v[64:67],a[192:195]
RT v[28:29],v3,44288
v_add_f32 v5,1.0,v5
MA a[196:199],v[8:11],v[72:75],a[196:199]
RT v[30:31],v3,53504
v_add_f32 v6,1.0,v6
MA a[200:203],v[12:15],v[64:67],a[200:203]
RT v[8:9],v3,44544
v_rcp_f32 v5,v5
MA a[204:207],v[12:15],v[72:75],a[204:207]
RT v[10:11],v3,53760
WL 6
MA a[208:211],v[16:19],v[64:67],a[208:211]
RT v[12:13],v3,44800
RT v[14:15],v3,54016
MA a[212:215],v[16:19],v[72:75],a[212:215]
buffer_load_dwordx4 v1,s[32:35],s51 offen offset:3072 lds
MA a[216:219],v[20:23],v[64:67],a[216:219]
RT v[16:17],v3,45056
v_rcp_f32 v6,v6
MA a[220:223],v[20:23],v[72:75],a[220:223]
RT v[18:19],v3,54272
WL 6
MA a[224:227],v[24:27],v[64:67],a[224:227]
RT v[20:21],v3,45312
v_mul_f32 v42,v42,v5
MA a[228:231],v[24:27],v[72:75],a[228:231]
RT v[22:23],v3,54528
v_mul_f32 v43,v43,v6
MA a[232:235],v[28:31],v[64:67],a[232:235]
RT v[24:25],v3,45568
v_mul_f32 v5,v44,v44
MA a[236:239],v[28:31],v[72:75],a[236:239]
RT v[26:27],v3,54784
v_mul_f32 v6,v45,v45
WL 6
MA a[240:243],v[8:11],v[64:67],a[240:243]
RT v[28:29],v3,45824
RT v[30:31],v3,55040
s_add_u32 m0,s65,45056
v_fmaak_f32 v5,v5,v4,0xc0135761
MA a[244:247],v[8:11],v[72:75],a[244:247]
buffer_load_dwordx4 v1,s[32:35],s52 offen offset:0 lds
v_add_u32 v1,4292313216,v1
v_fmaak_f32 v6,v6,v4,0xc0135761
MA a[248:251],v[12:15],v[64:67],a[248:251]
s_waitcnt vmcnt(9)
s_barrier
RT v[8:9],v0,0
v_mul_f32 v5,v5,v44
MA a[252:255],v[12:15],v[72:75],a[252:255]
RT v[10:11],v0,1024
v_mul_f32 v6,v6,v45
WL 6
MA v[224:227],v[16:19],v[64:67],v[224:227]
RT v[12:13],v0,256
s_add_u32 m0,s66,0
v_exp_f32 v5,v5
MA v[228:231],v[16:19],v[72:75],v[228:231]
RT v[14:15],v0,1280
buffer_load_dwordx4 v2,s[36:39],s53 offen offset:0 lds
MA v[232:235],v[20:23],v[64:67],v[232:235]
RT v[16:17],v0,2048
v_exp_f32 v6,v6
MA v[236:239],v[20:23],v[72:75],v[236:239]
RT v[18:19],v0,3072
WL 6
MA v[240:243],v[24:27],v[64:67],v[240:243]
RT v[20:21],v0,2304
buffer_load_dwordx4 v2,s[36:39],s54 offen offset:1024 lds
MA v[244:247],v[24:27],v[72:75],v[244:247]
RT v[22:23],v0,3328
v_add_f32 v5,1.0,v5
MA v[248:251],v[28:31],v[64:67],v[248:251]
RT v[24:25],v0,4096
RT v[26:27],v0,5120
v_add_f32 v6,1.0,v6
MA v[252:255],v[28:31],v[72:75],v[252:255]
v_rcp_f32 v5,v5
WL 6
MA v[64:67],v[8:11],v[80:83],0
RT v[28:29],v0,4352
buffer_load_dwordx4 v2,s[36:39],s55 offen offset:2048 lds
MA v[72:75],v[8:11],v[84:87],0
RT v[30:31],v0,5376
v_rcp_f32 v6,v6
MA v[68:71],v[12:15],v[80:83],0
RT v[8:9],v0,6144
v_mul_f32 v44,v44,v5
MA v[76:79],v[12:15],v[84:87],0
RT v[10:11],v0,7168
WL 6
MA v[64:67],v[16:19],v[88:91],v[64:67]
RT v[12:13],v0,6400
buffer_load_dwordx4 v2,s[36:39],s56 offen offset:3072 lds
MA v[72:75],v[16:19],v[92:95],v[72:75]
RT v[14:15],v0,7424
v_mul_f32 v45,v45,v6
MA v[68:71],v[20:23],v[88:91],v[68:71]
RT v[16:17],v0,8192
v_mul_f32 v5,v46,v46
MA v[76:79],v[20:23],v[92:95],v[76:79]
RT v[18:19],v0,9216
v_mul_f32 v6,v47,v47
WL 6
MA v[64:67],v[24:27],v[96:99],v[64:67]
RT v[20:21],v0,8448
s_add_u32 m0,s66,4096
v_fmaak_f32 v5,v5,v4,0xc0135761
MA v[72:75],v[24:27],v[100:103],v[72:75]
RT v[22:23],v0,9472
buffer_load_dwordx4 v2,s[36:39],s57 offen offset:0 lds
v_fmaak_f32 v6,v6,v4,0xc0135761
MA v[68:71],v[28:31],v[96:99],v[68:71]
RT v[24:25],v0,10240
v_mul_f32 v5,v5,v46
MA v[76:79],v[28:31],v[100:103],v[76:79]
RT v[26:27],v0,11264
v_mul_f32 v6,v6,v47
WL 6
MA v[64:67],v[8:11],v[104:107],v[64:67]
RT v[28:29],v0,10496
buffer_load_dwordx4 v2,s[36:39],s58 offen offset:1024 lds
MA v[72:75],v[8:11],v[108:111],v[72:75]
RT v[30:31],v0,11520
v_exp_f32 v5,v5
MA v[68:71],v[12:15],v[104:107],v[68:71]
RT v[8:9],v0,12288
v_exp_f32 v6,v6
MA v[76:79],v[12:15],v[108:111],v[76:79]
RT v[10:11],v0,13312
WL 6
MA v[64:67],v[16:19],v[112:115],v[64:67]
RT v[12:13],v0,12544
buffer_load_dwordx4 v2,s[36:39],s59 offen offset:2048 lds
MA v[72:75],v[16:19],v[116:119],v[72:75]
RT v[14:15],v0,13568
v_add_f32 v5,1.0,v5
MA v[68:71],v[20:23],v[112:115],v[68:71]
RT v[16:17],v0,14336
RT v[18:19],v0,15360
v_add_f32 v6,1.0,v6
MA v[76:79],v[20:23],v[116:119],v[76:79]
v_rcp_f32 v5,v5
WL 6
MA v[64:67],v[24:27],v[120:123],v[64:67]
RT v[20:21],v0,14592
buffer_load_dwordx4 v2,s[36:39],s60 offen offset:3072 lds
MA v[72:75],v[24:27],v[124:127],v[72:75]
RT v[22:23],v0,15616
v_rcp_f32 v6,v6
MA v[68:71],v[28:31],v[120:123],v[68:71]
RT v[24:25],v0,16384
v_mul_f32 v46,v46,v5
MA v[76:79],v[28:31],v[124:127],v[76:79]
RT v[26:27],v0,17408
WL 6
MA v[64:67],v[8:11],v[128:131],v[64:67]
RT v[28:29],v0,16640
s_add_u32 m0,s66,8192
v_mul_f32 v47,v47,v6
MA v[72:75],v[8:11],v[132:135],v[72:75]
RT v[30:31],v0,17664
buffer_load_dwordx4 v2,s[36:39],s61 offen offset:0 lds
v_add_u32 v2,36864,v2
MA v[68:71],v[12:15],v[128:131],v[68:71]
s_waitcnt vmcnt(9)
s_barrier
RT v[8:9],v0,36864
v_mul_f32 v5,v48,v48
MA v[76:79],v[12:15],v[132:135],v[76:79]
RT v[10:11],v0,37888
v_mul_f32 v6,v49,v49
WL 6
MA v[64:67],v[16:19],v[136:139],v[64:67]
RT v[12:13],v0,37120
s_mov_b32 m0,147456
s_nop 0
buffer_load_dword v7,s[24:27],s92 offen lds
MA v[72:75],v[16:19],v[140:143],v[72:75]
RT v[14:15],v0,38144
s_add_u32 s92,s92,s93
v_fmaak_f32 v5,v5,v4,0xc0135761
v_fmaak_f32 v6,v6,v4,0xc0135761
MA v[68:71],v[20:23],v[136:139],v[68:71]
RT v[16:17],v0,38912
v_mul_f32 v5,v5,v48
MA v[76:79],v[20:23],v[140:143],v[76:79]
RT v[18:19],v0,39936
v_mul_f32 v6,v6,v49
WL 6
MA v[64:67],v[24:27],v[144:147],v[64:67]
RT v[20:21],v0,39168
RT v[22:23],v0,40192
MA v[72:75],v[24:27],v[148:151],v[72:75]
v_exp_f32 v5,v5
MA v[68:71],v[28:31],v[144:147],v[68:71]
RT v[24:25],v0,40960
v_exp_f32 v6,v6
MA v[76:79],v[28:31],v[148:151],v[76:79]
RT v[26:27],v0,41984
WL 6
MA v[64:67],v[8:11],v[152:155],v[64:67]
RT v[28:29],v0,41216
v_add_f32 v5,1.0,v5
MA v[72:75],v[8:11],v[156:159],v[72:75]
RT v[30:31],v0,42240
v_add_f32 v6,1.0,v6
MA v[68:71],v[12:15],v[152:155],v[68:71]
RT v[8:9],v0,43008
v_rcp_f32 v5,v5
MA v[76:79],v[12:15],v[156:159],v[76:79]
RT v[10:11],v0,44032
WL 6
MA v[64:67],v[16:19],v[160:163],v[64:67]
RT v[12:13],v0,43264
RT v[14:15],v0,44288
MA v[72:75],v[16:19],v[164:167],v[72:75]
v_rcp_f32 v6,v6
MA v[68:71],v[20:23],v[160:163],v[68:71]
RT v[16:17],v0,45056
v_mul_f32 v48,v48,v5
MA v[76:79],v[20:23],v[164:167],v[76:79]
RT v[18:19],v0,46080
WL 6
MA v[64:67],v[24:27],v[168:171],v[64:67]
RT v[20:21],v0,45312
v_mul_f32 v49,v49,v6
MA v[72:75],v[24:27],v[172:175],v[72:75]
RT v[22:23],v0,46336
v_mul_f32 v5,v50,v50
MA v[68:71],v[28:31],v[168:171],v[68:71]
RT v[24:25],v0,47104
v_mul_f32 v6,v51,v51
MA v[76:79],v[28:31],v[172:175],v[76:79]
RT v[26:27],v0,48128
v_fmaak_f32 v5,v5,v4,0xc0135761
WL 6
MA v[64:67],v[8:11],v[176:179],v[64:67]
RT v[28:29],v0,47360
v_fmaak_f32 v6,v6,v4,0xc0135761
MA v[72:75],v[8:11],v[180:183],v[72:75]
RT v[30:31],v0,48384
v_mul_f32 v5,v5,v50
MA v[68:71],v[12:15],v[176:179],v[68:71]
RT v[8:9],v0,49152
v_mul_f32 v6,v6,v51
MA v[76:79],v[12:15],v[180:183],v[76:79]
RT v[10:11],v0,50176
WL 6
MA v[64:67],v[16:19],v[184:187],v[64:67]
RT v[12:13],v0,49408
RT v[14:15],v0,50432
MA v[72:75],v[16:19],v[188:191],v[72:75]
v_exp_f32 v5,v5
MA v[68:71],v[20:23],v[184:187],v[68:71]
RT v[16:17],v0,51200
v_exp_f32 v6,v6
MA v[76:79],v[20:23],v[188:191],v[76:79]
RT v[18:19],v0,52224
WL 6
MA v[64:67],v[24:27],v[192:195],v[64:67]
RT v[20:21],v0,51456
v_add_f32 v5,1.0,v5
MA v[72:75],v[24:27],v[196:199],v[72:75]
RT v[22:23],v0,52480
v_add_f32 v6,1.0,v6
MA v[68:71],v[28:31],v[192:195],v[68:71]
RT v[24:25],v0,53248
v_rcp_f32 v5,v5
MA v[76:79],v[28:31],v[196:199],v[76:79]
RT v[26:27],v0,54272
WL 6
MA v[64:67],v[8:11],v[200:203],v[64:67]
RT v[28:29],v0,53504
RT v[30:31],v0,54528
MA v[72:75],v[8:11],v[204:207],v[72:75]
v_rcp_f32 v6,v6
MA v[68:71],v[12:15],v[200:203],v[68:71]
RT v[8:9],v0,512
v_mul_f32 v50,v50,v5
MA v[76:79],v[12:15],v[204:207],v[76:79]
RT v[10:11],v0,1536
v_mul_f32 v51,v51,v6
WL 6
MA v[64:67],v[16:19],v[208:211],v[64:67]
RT v[12:13],v0,768
v_mul_f32 v5,v52,v52
MA v[72:75],v[16:19],v[212:215],v[72:75]
RT v[14:15],v0,1792
v_mul_f32 v6,v53,v53
MA v[68:71],v[20:23],v[208:211],v[68:71]
RT v[16:17],v0,2560
v_fmaak_f32 v5,v5,v4,0xc0135761
MA v[76:79],v[20:23],v[212:215],v[76:79]
RT v[18:19],v0,3584
WL 6
MA v[64:67],v[24:27],v[216:219],v[64:67]
RT v[20:21],v0,2816
v_fmaak_f32 v6,v6,v4,0xc0135761
MA v[72:75],v[24:27],v[220:223],v[72:75]
RT v[22:23],v0,3840
v_mul_f32 v5,v5,v52
MA v[68:71],v[28:31],v[216:219],v[68:71]
RT v[24:25],v0,4608
RT v[26:27],v0,5632
v_mul_f32 v6,v6,v53
v_exp_f32 v5,v5
MA v[76:79],v[28:31],v[220:223],v[76:79]
v_exp_f32 v6,v6
v_add_f32 v5,1.0,v5
v_add_f32 v6,1.0,v6
s_nop 3
v_mul_f32 v32,v32,v64
v_mul_f32 v40,v40,v72
v_mul_f32 v33,v33,v65
v_mul_f32 v41,v41,v73
CV v32,v32,v33
CV v40,v40,v41
v_mul_f32 v34,v34,v66
v_mul_f32 v42,v42,v74
v_mul_f32 v35,v35,v67
v_mul_f32 v43,v43,v75
CV v33,v34,v35
CV v41,v42,v43
WL 6
MA v[64:67],v[8:11],v[80:83],0
RT v[28:29],v0,4864
RT v[30:31],v0,5888
MA v[72:75],v[8:11],v[84:87],0
v_rcp_f32 v5,v5
v_mul_f32 v36,v36,v68
v_mul_f32 v44,v44,v76
v_mul_f32 v37,v37,v69
v_mul_f32 v45,v45,v77
CV v34,v36,v37
CV v42,v44,v45
v_mul_f32 v38,v38,v70
v_mul_f32 v46,v46,v78
v_mul_f32 v39,v39,v71
v_mul_f32 v47,v47,v79
CV v35,v38,v39
CV v43,v46,v47
s_nop 0
MA v[68:71],v[12:15],v[80:83],0
RT v[8:9],v0,6656
MA v[76:79],v[12:15],v[84:87],0
RT v[10:11],v0,7680
WL 6
MA v[64:67],v[16:19],v[88:91],v[64:67]
RT v[12:13],v0,6912
s_add_u32 s65,s65,s67
s_cmp_eq_u32 s68,8
s_cbranch_scc1 L_last
L_last_back:
MA v[72:75],v[16:19],v[92:95],v[72:75]
RT v[14:15],v0,7936
s_add_u32 m0,s65,36864
s_nop 0
buffer_load_dwordx4 v1,s[28:31],s44 offen offset:0 lds
MA v[68:71],v[20:23],v[88:91],v[68:71]
RT v[16:17],v0,8704
MA v[76:79],v[20:23],v[92:95],v[76:79]
RT v[18:19],v0,9728
WL 6
MA v[64:67],v[24:27],v[96:99],v[64:67]
RT v[20:21],v0,8960
RT v[22:23],v0,9984
MA v[72:75],v[24:27],v[100:103],v[72:75]
v_rcp_f32 v6,v6
MA v[68:71],v[28:31],v[96:99],v[68:71]
RT v[24:25],v0,10752
v_mul_f32 v52,v52,v5
MA v[76:79],v[28:31],v[100:103],v[76:79]
RT v[26:27],v0,11776
v_mul_f32 v53,v53,v6
WL 6
MA v[64:67],v[8:11],v[104:107],v[64:67]
RT v[28:29],v0,11008
buffer_load_dwordx4 v1,s[28:31],s45 offen offset:1024 lds
MA v[72:75],v[8:11],v[108:111],v[72:75]
RT v[30:31],v0,12032
v_mul_f32 v5,v54,v54
v_mul_f32 v6,v55,v55
MA v[68:71],v[12:15],v[104:107],v[68:71]
RT v[8:9],v0,12800
v_fmaak_f32 v5,v5,v4,0xc0135761
MA v[76:79],v[12:15],v[108:111],v[76:79]
RT v[10:11],v0,13824
v_fmaak_f32 v6,v6,v4,0xc0135761
WL 6
MA v[64:67],v[16:19],v[112:115],v[64:67]
RT v[12:13],v0,13056
v_mul_f32 v5,v5,v54
MA v[72:75],v[16:19],v[116:119],v[72:75]
RT v[14:15],v0,14080
v_mul_f32 v6,v6,v55
MA v[68:71],v[20:23],v[112:115],v[68:71]
RT v[16:17],v0,14848
v_exp_f32 v5,v5
MA v[76:79],v[20:23],v[116:119],v[76:79]
RT v[18:19],v0,15872
WL 6
MA v[64:67],v[24:27],v[120:123],v[64:67]
RT v[20:21],v0,15104
buffer_load_dwordx4 v1,s[28:31],s46 offen offset:2048 lds
MA v[72:75],v[24:27],v[124:127],v[72:75]
RT v[22:23],v0,16128
v_exp_f32 v6,v6
MA v[68:71],v[28:31],v[120:123],v[68:71]
RT v[24:25],v0,16896
v_add_f32 v5,1.0,v5
MA v[76:79],v[28:31],v[124:127],v[76:79]
RT v[26:27],v0,17920
WL 6
MA v[64:67],v[8:11],v[128:131],v[64:67]
RT v[28:29],v0,17152
v_add_f32 v6,1.0,v6
MA v[72:75],v[8:11],v[132:135],v[72:75]
RT v[30:31],v0,18176
v_rcp_f32 v5,v5
MA v[68:71],v[12:15],v[128:131],v[68:71]
RT v[8:9],v0,37376
v_rcp_f32 v6,v6
MA v[76:79],v[12:15],v[132:135],v[76:79]
RT v[10:11],v0,38400
WL 6
MA v[64:67],v[16:19],v[136:139],v[64:67]
RT v[12:13],v0,37632
buffer_load_dwordx4 v1,s[28:31],s47 offen offset:3072 lds
MA v[72:75],v[16:19],v[140:143],v[72:75]
RT v[14:15],v0,38656
v_mul_f32 v54,v54,v5
MA v[68:71],v[20:23],v[136:139],v[68:71]
RT v[16:17],v0,39424
v_mul_f32 v55,v55,v6
MA v[76:79],v[20:23],v[140:143],v[76:79]
RT v[18:19],v0,40448
WL 6
MA v[64:67],v[24:27],v[144:147],v[64:67]
RT v[20:21],v0,39680
v_mul_f32 v5,v56,v56
MA v[72:75],v[24:27],v[148:151],v[72:75]
RT v[22:23],v0,40704
v_mul_f32 v6,v57,v57
MA v[68:71],v[28:31],v[144:147],v[68:71]
RT v[24:25],v0,41472
v_fmaak_f32 v5,v5,v4,0xc0135761
MA v[76:79],v[28:31],v[148:151],v[76:79]
RT v[26:27],v0,42496
v_fmaak_f32 v6,v6,v4,0xc0135761
WL 6
MA v[64:67],v[8:11],v[152:155],v[64:67]
RT v[28:29],v0,41728
s_add_u32 m0,s65,40960
v_mul_f32 v5,v5,v56
MA v[72:75],v[8:11],v[156:159],v[72:75]
RT v[30:31],v0,42752
buffer_load_dwordx4 v1,s[28:31],s48 offen offset:0 lds
v_mul_f32 v6,v6,v57
MA v[68:71],v[12:15],v[152:155],v[68:71]
RT v[8:9],v0,43520
v_exp_f32 v5,v5
MA v[76:79],v[12:15],v[156:159],v[76:79]
RT v[10:11],v0,44544
WL 6
MA v[64:67],v[16:19],v[160:163],v[64:67]
RT v[12:13],v0,43776
RT v[14:15],v0,44800
MA v[72:75],v[16:19],v[164:167],v[72:75]
v_exp_f32 v6,v6
MA v[68:71],v[20:23],v[160:163],v[68:71]
RT v[16:17],v0,45568
v_add_f32 v5,1.0,v5
MA v[76:79],v[20:23],v[164:167],v[76:79]
RT v[18:19],v0,46592
v_add_f32 v6,1.0,v6
WL 6
MA v[64:67],v[24:27],v[168:171],v[64:67]
RT v[20:21],v0,45824
buffer_load_dwordx4 v1,s[28:31],s49 offen offset:1024 lds
MA v[72:75],v[24:27],v[172:175],v[72:75]
RT v[22:23],v0,46848
v_rcp_f32 v5,v5
MA v[68:71],v[28:31],v[168:171],v[68:71]
RT v[24:25],v0,47616
v_rcp_f32 v6,v6
MA v[76:79],v[28:31],v[172:175],v[76:79]
RT v[26:27],v0,48640
WL 6
MA v[64:67],v[8:11],v[176:179],v[64:67]
RT v[28:29],v0,47872
v_mul_f32 v56,v56,v5
MA v[72:75],v[8:11],v[180:183],v[72:75]
RT v[30:31],v0,48896
v_mul_f32 v57,v57,v6
MA v[68:71],v[12:15],v[176:179],v[68:71]
RT v[8:9],v0,49664
v_mul_f32 v5,v58,v58
MA v[76:79],v[12:15],v[180:183],v[76:79]
RT v[10:11],v0,50688
WL 6
MA v[64:67],v[16:19],v[184:187],v[64:67]
RT v[12:13],v0,49920
buffer_load_dwordx4 v1,s[28:31],s50 offen offset:2048 lds
MA v[72:75],v[16:19],v[188:191],v[72:75]
RT v[14:15],v0,50944
v_mul_f32 v6,v59,v59
v_fmaak_f32 v5,v5,v4,0xc0135761
MA v[68:71],v[20:23],v[184:187],v[68:71]
RT v[16:17],v0,51712
v_fmaak_f32 v6,v6,v4,0xc0135761
MA v[76:79],v[20:23],v[188:191],v[76:79]
RT v[18:19],v0,52736
v_mul_f32 v5,v5,v58
WL 6
MA v[64:67],v[24:27],v[192:195],v[64:67]
RT v[20:21],v0,51968
MA v[72:75],v[24:27],v[196:199],v[72:75]
RT v[22:23],v0,52992
v_mul_f32 v6,v6,v59
MA v[68:71],v[28:31],v[192:195],v[68:71]
RT v[24:25],v0,53760
v_exp_f32 v5,v5
MA v[76:79],v[28:31],v[196:199],v[76:79]
RT v[26:27],v0,54784
WL 6
MA v[64:67],v[8:11],v[200:203],v[64:67]
RT v[28:29],v0,54016
buffer_load_dwordx4 v1,s[28:31],s51 offen offset:3072 lds
MA v[72:75],v[8:11],v[204:207],v[72:75]
RT v[30:31],v0,55040
v_exp_f32 v6,v6
MA v[68:71],v[12:15],v[200:203],v[68:71]
s_waitcnt vmcnt(9)
s_barrier
RT v[8:9],v3,0
v_add_f32 v5,1.0,v5
MA v[76:79],v[12:15],v[204:207],v[76:79]
RT v[10:11],v3,9216
v_add_f32 v6,1.0,v6
WL 6
MA v[64:67],v[16:19],v[208:211],v[64:67]
RT v[12:13],v3,256
RT v[14:15],v3,9472
MA v[72:75],v[16:19],v[212:215],v[72:75]
v_rcp_f32 v5,v5
MA v[68:71],v[20:23],v[208:211],v[68:71]
RT v[16:17],v3,512
v_rcp_f32 v6,v6
MA v[76:79],v[20:23],v[212:215],v[76:79]
RT v[18:19],v3,9728
WL 6
MA v[64:67],v[24:27],v[216:219],v[64:67]
RT v[20:21],v3,768
RT v[22:23],v3,9984
s_add_u32 m0,s65,45056
v_mul_f32 v58,v58,v5
MA v[72:75],v[24:27],v[220:223],v[72:75]
buffer_load_dwordx4 v1,s[28:31],s52 offen offset:0 lds
v_add_u32 v1,2654208,v1
v_mul_f32 v59,v59,v6
MA v[68:71],v[28:31],v[216:219],v[68:71]
RT v[24:25],v3,1024
v_mul_f32 v5,v60,v60
MA v[76:79],v[28:31],v[220:223],v[76:79]
RT v[26:27],v3,10240
WL 6
MA a[0:3],v[8:11],v[32:35],a[0:3]
RT v[28:29],v3,1280
v_mul_f32 v6,v61,v61
MA a[4:7],v[8:11],v[40:43],a[4:7]
RT v[30:31],v3,10496
v_fmaak_f32 v5,v5,v4,0xc0135761
MA a[8:11],v[12:15],v[32:35],a[8:11]
RT v[8:9],v3,1536
v_fmaak_f32 v6,v6,v4,0xc0135761
MA a[12:15],v[12:15],v[40:43],a[12:15]
RT v[10:11],v3,10752
v_mul_f32 v5,v5,v60
WL 6
MA a[16:19],v[16:19],v[32:35],a[16:19]
RT v[12:13],v3,1792
s_sub_u32 s66,s66,s67
s_add_u32 m0,s66,0
v_mul_f32 v6,v6,v61
MA a[20:23],v[16:19],v[40:43],a[20:23]
RT v[14:15],v3,11008
buffer_load_dwordx4 v1,s[28:31],s44 offen offset:0 lds
v_exp_f32 v5,v5
MA a[24:27],v[20:23],v[32:35],a[24:27]
RT v[16:17],v3,2048
v_exp_f32 v6,v6
MA a[28:31],v[20:23],v[40:43],a[28:31]
RT v[18:19],v3,11264
WL 6
MA a[32:35],v[24:27],v[32:35],a[32:35]
RT v[20:21],v3,2304
v_add_f32 v5,1.0,v5
MA a[36:39],v[24:27],v[40:43],a[36:39]
RT v[22:23],v3,11520
v_add_f32 v6,1.0,v6
MA a[40:43],v[28:31],v[32:35],a[40:43]
RT v[24:25],v3,2560
MA a[44:47],v[28:31],v[40:43],a[44:47]
RT v[26:27],v3,11776
WL 6
MA a[48:51],v[8:11],v[32:35],a[48:51]
RT v[28:29],v3,2816
buffer_load_dwordx4 v1,s[28:31],s45 offen offset:1024 lds
MA a[52:55],v[8:11],v[40:43],a[52:55]
RT v[30:31],v3,12032
v_rcp_f32 v5,v5
MA a[56:59],v[12:15],v[32:35],a[56:59]
RT v[8:9],v3,3072
v_rcp_f32 v6,v6
MA a[60:63],v[12:15],v[40:43],a[60:63]
RT v[10:11],v3,12288
WL 6
MA a[64:67],v[16:19],v[32:35],a[64:67]
RT v[12:13],v3,3328
v_mul_f32 v60,v60,v5
MA a[68:71],v[16:19],v[40:43],a[68:71]
RT v[14:15],v3,12544
v_mul_f32 v61,v61,v6
MA a[72:75],v[20:23],v[32:35],a[72:75]
RT v[16:17],v3,3584
v_mul_f32 v5,v62,v62
MA a[76:79],v[20:23],v[40:43],a[76:79]
RT v[18:19],v3,12800
v_mul_f32 v6,v63,v63
WL 6
MA a[80:83],v[24:27],v[32:35],a[80:83]
RT v[20:21],v3,3840
buffer_load_dwordx4 v1,s[28:31],s46 offen offset:2048 lds
MA a[84:87],v[24:27],v[40:43],a[84:87]
RT v[22:23],v3,13056
v_fmaak_f32 v5,v5,v4,0xc0135761
v_fmaak_f32 v6,v6,v4,0xc0135761
MA a[88:91],v[28:31],v[32:35],a[88:91]
RT v[24:25],v3,4096
v_mul_f32 v5,v5,v62
MA a[92:95],v[28:31],v[40:43],a[92:95]
RT v[26:27],v3,13312
v_mul_f32 v6,v6,v63
WL 6
MA a[96:99],v[8:11],v[32:35],a[96:99]
RT v[28:29],v3,4352
v_exp_f32 v5,v5
MA a[100:103],v[8:11],v[40:43],a[100:103]
RT v[30:31],v3,13568
v_add_u32 v0,s67,v0
MA a[104:107],v[12:15],v[32:35],a[104:107]
RT v[8:9],v3,4608
v_exp_f32 v6,v6
MA a[108:111],v[12:15],v[40:43],a[108:111]
RT v[10:11],v3,13824
WL 6
MA a[112:115],v[16:19],v[32:35],a[112:115]
RT v[12:13],v3,4864
buffer_load_dwordx4 v1,s[28:31],s47 offen offset:3072 lds
MA a[116:119],v[16:19],v[40:43],a[116:119]
RT v[14:15],v3,14080
v_add_f32 v5,1.0,v5
MA a[120:123],v[20:23],v[32:35],a[120:123]
RT v[16:17],v3,5120
RT v[18:19],v3,14336
v_add_f32 v6,1.0,v6
MA a[124:127],v[20:23],v[40:43],a[124:127]
v_rcp_f32 v5,v5
WL 6
MA a[128:131],v[24:27],v[32:35],a[128:131]
RT v[20:21],v3,5376
RT v[22:23],v3,14592
MA a[132:135],v[24:27],v[40:43],a[132:135]
v_rcp_f32 v6,v6
MA a[136:139],v[28:31],v[32:35],a[136:139]
RT v[24:25],v3,5632
v_mul_f32 v62,v62,v5
MA a[140:143],v[28:31],v[40:43],a[140:143]
RT v[26:27],v3,14848
WL 6
MA a[144:147],v[8:11],v[32:35],a[144:147]
RT v[28:29],v3,5888
s_add_u32 m0,s66,4096
v_mul_f32 v63,v63,v6
MA a[148:151],v[8:11],v[40:43],a[148:151]
RT v[30:31],v3,15104
buffer_load_dwordx4 v1,s[28:31],s48 offen offset:0 lds
MA a[152:155],v[12:15],v[32:35],a[152:155]
RT v[8:9],v3,6144
v_mul_f32 v48,v48,v64
MA a[156:159],v[12:15],v[40:43],a[156:159]
RT v[10:11],v3,15360
WL 6
MA a[160:163],v[16:19],v[32:35],a[160:163]
RT v[12:13],v3,6400
v_mul_f32 v49,v49,v65
MA a[164:167],v[16:19],v[40:43],a[164:167]
RT v[14:15],v3,15616
CV v64,v48,v49
MA a[168:171],v[20:23],v[32:35],a[168:171]
RT v[16:17],v3,6656
v_mul_f32 v50,v50,v66
MA a[172:175],v[20:23],v[40:43],a[172:175]
RT v[18:19],v3,15872
WL 6
MA a[176:179],v[24:27],v[32:35],a[176:179]
RT v[20:21],v3,6912
buffer_load_dwordx4 v1,s[28:31],s49 offen offset:1024 lds
MA a[180:183],v[24:27],v[40:43],a[180:183]
RT v[22:23],v3,16128
v_mul_f32 v51,v51,v67
MA a[184:187],v[28:31],v[32:35],a[184:187]
RT v[24:25],v3,7168
CV v65,v50,v51
MA a[188:191],v[28:31],v[40:43],a[188:191]
RT v[26:27],v3,16384
v_mul_f32 v52,v52,v68
WL 6
MA a[192:195],v[8:11],v[32:35],a[192:195]
RT v[28:29],v3,7424
v_mul_f32 v53,v53,v69
MA a[196:199],v[8:11],v[40:43],a[196:199]
RT v[30:31],v3,16640
CV v66,v52,v53
MA a[200:203],v[12:15],v[32:35],a[200:203]
RT v[8:9],v3,7680
v_mul_f32 v54,v54,v70
MA a[204:207],v[12:15],v[40:43],a[204:207]
RT v[10:11],v3,16896
WL 6
MA a[208:211],v[16:19],v[32:35],a[208:211]
RT v[12:13],v3,7936
buffer_load_dwordx4 v1,s[28:31],s50 offen offset:2048 lds
MA a[212:215],v[16:19],v[40:43],a[212:215]
RT v[14:15],v3,17152
v_mul_f32 v55,v55,v71
CV v67,v54,v55
MA a[216:219],v[20:23],v[32:35],a[216:219]
RT v[16:17],v3,8192
v_mul_f32 v56,v56,v72
MA a[220:223],v[20:23],v[40:43],a[220:223]
RT v[18:19],v3,17408
WL 6
MA a[224:227],v[24:27],v[32:35],a[224:227]
RT v[20:21],v3,8448
v_mul_f32 v57,v57,v73
MA a[228:231],v[24:27],v[40:43],a[228:231]
RT v[22:23],v3,17664
CV v72,v56,v57
MA a[232:235],v[28:31],v[32:35],a[232:235]
RT v[24:25],v3,8704
v_mul_f32 v58,v58,v74
MA a[236:239],v[28:31],v[40:43],a[236:239]
RT v[26:27],v3,17920
WL 6
MA a[240:243],v[8:11],v[32:35],a[240:243]
RT v[28:29],v3,8960
buffer_load_dwordx4 v1,s[28:31],s51 offen offset:3072 lds
MA a[244:247],v[8:11],v[40:43],a[244:247]
RT v[30:31],v3,18176
v_mul_f32 v59,v59,v75
CV v73,v58,v59
MA a[248:251],v[12:15],v[32:35],a[248:251]
s_waitcnt vmcnt(8)
s_barrier
RT v[8:9],v0,36864
v_mul_f32 v60,v60,v76
MA a[252:255],v[12:15],v[40:43],a[252:255]
RT v[10:11],v0,37888
v_mul_f32 v61,v61,v77
WL 6
MA v[224:227],v[16:19],v[32:35],v[224:227]
RT v[12:13],v0,37120
CV v74,v60,v61
MA v[228:231],v[16:19],v[40:43],v[228:231]
RT v[14:15],v0,38144
v_mul_f32 v62,v62,v78
MA v[232:235],v[20:23],v[32:35],v[232:235]
RT v[16:17],v0,38912
v_mul_f32 v63,v63,v79
MA v[236:239],v[20:23],v[40:43],v[236:239]
RT v[18:19],v0,39936
WL 6
MA v[240:243],v[24:27],v[32:35],v[240:243]
RT v[20:21],v0,39168
s_add_u32 m0,s66,8192
CV v75,v62,v63
buffer_load_dwordx4 v1,s[28:31],s52 offen offset:0 lds
MA v[244:247],v[24:27],v[40:43],v[244:247]
RT v[22:23],v0,40192
v_add_u32 v1,4292313088,v1
v_subrev_u32 v3,s67,v3
s_sub_u32 s67,0,s67
MA v[248:251],v[28:31],v[32:35],v[248:251]
RT v[24:25],v0,40960
MA v[252:255],v[28:31],v[40:43],v[252:255]
RT v[26:27],v0,41984
s_add_u32 s68,s68,1
s_cmp_lt_u32 s68,9
s_cbranch_scc1 L_mlp_loop
WL 0
v_mbcnt_lo_u32_b32 v5,-1,0
v_mbcnt_hi_u32_b32 v5,-1,v5
v_lshlrev_b32 v5,4,v5
RT v[8:9],v0,36864
RT v[10:11],v0,46080
RT v[12:13],v0,37120
RT v[14:15],v0,46336
RT v[16:17],v0,37376
RT v[18:19],v0,46592
RT v[20:21],v0,37632
RT v[22:23],v0,46848
RT v[24:25],v0,37888
RT v[26:27],v0,47104
WL 6
MA a[0:3],v[8:11],v[64:67],a[0:3]
RT v[28:29],v0,38144
MA a[4:7],v[8:11],v[72:75],a[4:7]
RT v[30:31],v0,47360
MA a[8:11],v[12:15],v[64:67],a[8:11]
RT v[8:9],v0,38400
MA a[12:15],v[12:15],v[72:75],a[12:15]
RT v[10:11],v0,47616
WL 6
MA a[16:19],v[16:19],v[64:67],a[16:19]
RT v[12:13],v0,38656
MA a[20:23],v[16:19],v[72:75],a[20:23]
RT v[14:15],v0,47872
MA a[24:27],v[20:23],v[64:67],a[24:27]
RT v[16:17],v0,38912
v_accvgpr_read_b32 v32,a0
MA a[28:31],v[20:23],v[72:75],a[28:31]
RT v[18:19],v0,48128
WL 6
MA a[32:35],v[24:27],v[64:67],a[32:35]
RT v[20:21],v0,39168
v_accvgpr_read_b32 v33,a1
MA a[36:39],v[24:27],v[72:75],a[36:39]
RT v[22:23],v0,48384
v_accvgpr_read_b32 v34,a2
MA a[40:43],v[28:31],v[64:67],a[40:43]
RT v[24:25],v0,39424
v_accvgpr_read_b32 v35,a3
MA a[44:47],v[28:31],v[72:75],a[44:47]
RT v[26:27],v0,48640
WL 6
MA a[48:51],v[8:11],v[64:67],a[48:51]
RT v[28:29],v0,39680
v_accvgpr_read_b32 v36,a4
v_accvgpr_read_b32 v37,a5
v_accvgpr_read_b32 v38,a6
v_accvgpr_read_b32 v39,a7
CV v40,v32,v33
MA a[52:55],v[8:11],v[72:75],a[52:55]
RT v[30:31],v0,48896
CV v41,v34,v35
CV v42,v36,v37
CV v43,v38,v39
s_add_u32 s88,s87,0
buffer_store_dwordx4 v[40:43],v5,s[40:43],s88 offen offset:0 sc1
MA a[56:59],v[12:15],v[64:67],a[56:59]
RT v[8:9],v0,39936
v_accvgpr_read_b32 v48,a8
v_accvgpr_read_b32 v49,a9
v_accvgpr_read_b32 v50,a10
v_accvgpr_read_b32 v51,a11
v_accvgpr_read_b32 v52,a12
v_accvgpr_read_b32 v53,a13
v_accvgpr_read_b32 v54,a14
MA a[60:63],v[12:15],v[72:75],a[60:63]
RT v[10:11],v0,49152
v_accvgpr_read_b32 v55,a15
CV v56,v48,v49
CV v57,v50,v51
CV v58,v52,v53
CV v59,v54,v55
buffer_store_dwordx4 v[56:59],v5,s[40:43],s88 offen offset:1024 sc1
WL 6
MA a[64:67],v[16:19],v[64:67],a[64:67]
RT v[12:13],v0,40192
v_accvgpr_read_b32 v32,a16
v_accvgpr_read_b32 v33,a17
v_accvgpr_read_b32 v34,a18
v_accvgpr_read_b32 v35,a19
v_accvgpr_read_b32 v36,a20
v_accvgpr_read_b32 v37,a21
v_accvgpr_read_b32 v38,a22
MA a[68:71],v[16:19],v[72:75],a[68:71]
RT v[14:15],v0,49408
v_accvgpr_read_b32 v39,a23
CV v40,v32,v33
CV v41,v34,v35
CV v42,v36,v37
CV v43,v38,v39
buffer_store_dwordx4 v[40:43],v5,s[40:43],s88 offen offset:2048 sc1
MA a[72:75],v[20:23],v[64:67],a[72:75]
RT v[16:17],v0,40448
v_accvgpr_read_b32 v48,a24
v_accvgpr_read_b32 v49,a25
v_accvgpr_read_b32 v50,a26
v_accvgpr_read_b32 v51,a27
v_accvgpr_read_b32 v52,a28
v_accvgpr_read_b32 v53,a29
v_accvgpr_read_b32 v54,a30
MA a[76:79],v[20:23],v[72:75],a[76:79]
RT v[18:19],v0,49664
v_accvgpr_read_b32 v55,a31
CV v56,v48,v49
CV v57,v50,v51
CV v58,v52,v53
CV v59,v54,v55
buffer_store_dwordx4 v[56:59],v5,s[40:43],s88 offen offset:3072 sc1
WL 6
MA a[80:83],v[24:27],v[64:67],a[80:83]
RT v[20:21],v0,40704
v_accvgpr_read_b32 v32,a32
v_accvgpr_read_b32 v33,a33
v_accvgpr_read_b32 v34,a34
v_accvgpr_read_b32 v35,a35
v_accvgpr_read_b32 v36,a36
v_accvgpr_read_b32 v37,a37
v_accvgpr_read_b32 v38,a38
MA a[84:87],v[24:27],v[72:75],a[84:87]
RT v[22:23],v0,49920
v_accvgpr_read_b32 v39,a39
CV v40,v32,v33
CV v41,v34,v35
CV v42,v36,v37
CV v43,v38,v39
s_add_u32 s88,s87,4096
buffer_store_dwordx4 v[40:43],v5,s[40:43],s88 offen offset:0 sc1
MA a[88:91],v[28:31],v[64:67],a[88:91]
RT v[24:25],v0,40960
v_accvgpr_read_b32 v48,a40
v_accvgpr_read_b32 v49,a41
v_accvgpr_read_b32 v50,a42
v_accvgpr_read_b32 v51,a43
v_accvgpr_read_b32 v52,a44
v_accvgpr_read_b32 v53,a45
v_accvgpr_read_b32 v54,a46
MA a[92:95],v[28:31],v[72:75],a[92:95]
RT v[26:27],v0,50176
v_accvgpr_read_b32 v55,a47
CV v56,v48,v49
CV v57,v50,v51
CV v58,v52,v53
CV v59,v54,v55
buffer_store_dwordx4 v[56:59],v5,s[40:43],s88 offen offset:1024 sc1
WL 6
MA a[96:99],v[8:11],v[64:67],a[96:99]
RT v[28:29],v0,41216
v_accvgpr_read_b32 v32,a48
v_accvgpr_read_b32 v33,a49
v_accvgpr_read_b32 v34,a50
v_accvgpr_read_b32 v35,a51
v_accvgpr_read_b32 v36,a52
v_accvgpr_read_b32 v37,a53
v_accvgpr_read_b32 v38,a54
MA a[100:103],v[8:11],v[72:75],a[100:103]
RT v[30:31],v0,50432
v_accvgpr_read_b32 v39,a55
CV v40,v32,v33
CV v41,v34,v35
CV v42,v36,v37
CV v43,v38,v39
buffer_store_dwordx4 v[40:43],v5,s[40:43],s88 offen offset:2048 sc1
MA a[104:107],v[12:15],v[64:67],a[104:107]
RT v[8:9],v0,41472
v_accvgpr_read_b32 v48,a56
v_accvgpr_read_b32 v49,a57
v_accvgpr_read_b32 v50,a58
v_accvgpr_read_b32 v51,a59
v_accvgpr_read_b32 v52,a60
v_accvgpr_read_b32 v53,a61
v_accvgpr_read_b32 v54,a62
MA a[108:111],v[12:15],v[72:75],a[108:111]
RT v[10:11],v0,50688
v_accvgpr_read_b32 v55,a63
CV v56,v48,v49
CV v57,v50,v51
CV v58,v52,v53
CV v59,v54,v55
buffer_store_dwordx4 v[56:59],v5,s[40:43],s88 offen offset:3072 sc1
WL 6
MA a[112:115],v[16:19],v[64:67],a[112:115]
RT v[12:13],v0,41728
v_accvgpr_read_b32 v32,a64
v_accvgpr_read_b32 v33,a65
v_accvgpr_read_b32 v34,a66
v_accvgpr_read_b32 v35,a67
v_accvgpr_read_b32 v36,a68
v_accvgpr_read_b32 v37,a69
v_accvgpr_read_b32 v38,a70
MA a[116:119],v[16:19],v[72:75],a[116:119]
RT v[14:15],v0,50944
v_accvgpr_read_b32 v39,a71
CV v40,v32,v33
CV v41,v34,v35
CV v42,v36,v37
CV v43,v38,v39
s_add_u32 s88,s87,8192
buffer_store_dwordx4 v[40:43],v5,s[40:43],s88 offen offset:0 sc1
MA a[120:123],v[20:23],v[64:67],a[120:123]
RT v[16:17],v0,41984
v_accvgpr_read_b32 v48,a72
v_accvgpr_read_b32 v49,a73
v_accvgpr_read_b32 v50,a74
v_accvgpr_read_b32 v51,a75
v_accvgpr_read_b32 v52,a76
v_accvgpr_read_b32 v53,a77
v_accvgpr_read_b32 v54,a78
MA a[124:127],v[20:23],v[72:75],a[124:127]
RT v[18:19],v0,51200
v_accvgpr_read_b32 v55,a79
CV v56,v48,v49
CV v57,v50,v51
CV v58,v52,v53
CV v59,v54,v55
buffer_store_dwordx4 v[56:59],v5,s[40:43],s88 offen offset:1024 sc1
WL 6
MA a[128:131],v[24:27],v[64:67],a[128:131]
RT v[20:21],v0,42240
v_accvgpr_read_b32 v32,a80
v_accvgpr_read_b32 v33,a81
v_accvgpr_read_b32 v34,a82
v_accvgpr_read_b32 v35,a83
v_accvgpr_read_b32 v36,a84
v_accvgpr_read_b32 v37,a85
v_accvgpr_read_b32 v38,a86
MA a[132:135],v[24:27],v[72:75],a[132:135]
RT v[22:23],v0,51456
v_accvgpr_read_b32 v39,a87
CV v40,v32,v33
CV v41,v34,v35
CV v42,v36,v37
CV v43,v38,v39
buffer_store_dwordx4 v[40:43],v5,s[40:43],s88 offen offset:2048 sc1
MA a[136:139],v[28:31],v[64:67],a[136:139]
RT v[24:25],v0,42496
v_accvgpr_read_b32 v48,a88
v_accvgpr_read_b32 v49,a89
v_accvgpr_read_b32 v50,a90
v_accvgpr_read_b32 v51,a91
v_accvgpr_read_b32 v52,a92
v_accvgpr_read_b32 v53,a93
v_accvgpr_read_b32 v54,a94
MA a[140:143],v[28:31],v[72:75],a[140:143]
RT v[26:27],v0,51712
v_accvgpr_read_b32 v55,a95
CV v56,v48,v49
CV v57,v50,v51
CV v58,v52,v53
CV v59,v54,v55
buffer_store_dwordx4 v[56:59],v5,s[40:43],s88 offen offset:3072 sc1
WL 6
MA a[144:147],v[8:11],v[64:67],a[144:147]
RT v[28:29],v0,42752
v_accvgpr_read_b32 v32,a96
v_accvgpr_read_b32 v33,a97
v_accvgpr_read_b32 v34,a98
v_accvgpr_read_b32 v35,a99
v_accvgpr_read_b32 v36,a100
v_accvgpr_read_b32 v37,a101
v_accvgpr_read_b32 v38,a102
MA a[148:151],v[8:11],v[72:75],a[148:151]
RT v[30:31],v0,51968
v_accvgpr_read_b32 v39,a103
CV v40,v32,v33
CV v41,v34,v35
CV v42,v36,v37
CV v43,v38,v39
s_add_u32 s88,s87,12288
buffer_store_dwordx4 v[40:43],v5,s[40:43],s88 offen offset:0 sc1
MA a[152:155],v[12:15],v[64:67],a[152:155]
RT v[8:9],v0,43008
v_accvgpr_read_b32 v48,a104
v_accvgpr_read_b32 v49,a105
v_accvgpr_read_b32 v50,a106
v_accvgpr_read_b32 v51,a107
v_accvgpr_read_b32 v52,a108
v_accvgpr_read_b32 v53,a109
v_accvgpr_read_b32 v54,a110
MA a[156:159],v[12:15],v[72:75],a[156:159]
RT v[10:11],v0,52224
v_accvgpr_read_b32 v55,a111
CV v56,v48,v49
CV v57,v50,v51
CV v58,v52,v53
CV v59,v54,v55
buffer_store_dwordx4 v[56:59],v5,s[40:43],s88 offen offset:1024 sc1
WL 6
MA a[160:163],v[16:19],v[64:67],a[160:163]
RT v[12:13],v0,43264
v_accvgpr_read_b32 v32,a112
v_accvgpr_read_b32 v33,a113
v_accvgpr_read_b32 v34,a114
v_accvgpr_read_b32 v35,a115
v_accvgpr_read_b32 v36,a116
v_accvgpr_read_b32 v37,a117
v_accvgpr_read_b32 v38,a118
MA a[164:167],v[16:19],v[72:75],a[164:167]
RT v[14:15],v0,52480
v_accvgpr_read_b32 v39,a119
CV v40,v32,v33
CV v41,v34,v35
CV v42,v36,v37
CV v43,v38,v39
buffer_store_dwordx4 v[40:43],v5,s[40:43],s88 offen offset:2048 sc1
MA a[168:171],v[20:23],v[64:67],a[168:171]
RT v[16:17],v0,43520
v_accvgpr_read_b32 v48,a120
v_accvgpr_read_b32 v49,a121
v_accvgpr_read_b32 v50,a122
v_accvgpr_read_b32 v51,a123
v_accvgpr_read_b32 v52,a124
v_accvgpr_read_b32 v53,a125
v_accvgpr_read_b32 v54,a126
MA a[172:175],v[20:23],v[72:75],a[172:175]
RT v[18:19],v0,52736
v_accvgpr_read_b32 v55,a127
CV v56,v48,v49
CV v57,v50,v51
CV v58,v52,v53
CV v59,v54,v55
buffer_store_dwordx4 v[56:59],v5,s[40:43],s88 offen offset:3072 sc1
WL 6
MA a[176:179],v[24:27],v[64:67],a[176:179]
RT v[20:21],v0,43776
v_accvgpr_read_b32 v32,a128
v_accvgpr_read_b32 v33,a129
v_accvgpr_read_b32 v34,a130
v_accvgpr_read_b32 v35,a131
v_accvgpr_read_b32 v36,a132
v_accvgpr_read_b32 v37,a133
v_accvgpr_read_b32 v38,a134
MA a[180:183],v[24:27],v[72:75],a[180:183]
RT v[22:23],v0,52992
v_accvgpr_read_b32 v39,a135
CV v40,v32,v33
CV v41,v34,v35
CV v42,v36,v37
CV v43,v38,v39
s_add_u32 s88,s87,16384
buffer_store_dwordx4 v[40:43],v5,s[40:43],s88 offen offset:0 sc1
MA a[184:187],v[28:31],v[64:67],a[184:187]
RT v[24:25],v0,44032
v_accvgpr_read_b32 v48,a136
v_accvgpr_read_b32 v49,a137
v_accvgpr_read_b32 v50,a138
v_accvgpr_read_b32 v51,a139
v_accvgpr_read_b32 v52,a140
v_accvgpr_read_b32 v53,a141
v_accvgpr_read_b32 v54,a142
MA a[188:191],v[28:31],v[72:75],a[188:191]
RT v[26:27],v0,53248
v_accvgpr_read_b32 v55,a143
CV v56,v48,v49
CV v57,v50,v51
CV v58,v52,v53
CV v59,v54,v55
buffer_store_dwordx4 v[56:59],v5,s[40:43],s88 offen offset:1024 sc1
WL 6
MA a[192:195],v[8:11],v[64:67],a[192:195]
RT v[28:29],v0,44288
v_accvgpr_read_b32 v32,a144
v_accvgpr_read_b32 v33,a145
v_accvgpr_read_b32 v34,a146
v_accvgpr_read_b32 v35,a147
v_accvgpr_read_b32 v36,a148
v_accvgpr_read_b32 v37,a149
v_accvgpr_read_b32 v38,a150
MA a[196:199],v[8:11],v[72:75],a[196:199]
RT v[30:31],v0,53504
v_accvgpr_read_b32 v39,a151
CV v40,v32,v33
CV v41,v34,v35
CV v42,v36,v37
CV v43,v38,v39
buffer_store_dwordx4 v[40:43],v5,s[40:43],s88 offen offset:2048 sc1
MA a[200:203],v[12:15],v[64:67],a[200:203]
RT v[8:9],v0,44544
v_accvgpr_read_b32 v48,a152
v_accvgpr_read_b32 v49,a153
v_accvgpr_read_b32 v50,a154
v_accvgpr_read_b32 v51,a155
v_accvgpr_read_b32 v52,a156
v_accvgpr_read_b32 v53,a157
v_accvgpr_read_b32 v54,a158
MA a[204:207],v[12:15],v[72:75],a[204:207]
RT v[10:11],v0,53760
v_accvgpr_read_b32 v55,a159
CV v56,v48,v49
CV v57,v50,v51
CV v58,v52,v53
CV v59,v54,v55
buffer_store_dwordx4 v[56:59],v5,s[40:43],s88 offen offset:3072 sc1
WL 6
MA a[208:211],v[16:19],v[64:67],a[208:211]
RT v[12:13],v0,44800
v_accvgpr_read_b32 v32,a160
v_accvgpr_read_b32 v33,a161
v_accvgpr_read_b32 v34,a162
v_accvgpr_read_b32 v35,a163
v_accvgpr_read_b32 v36,a164
v_accvgpr_read_b32 v37,a165
v_accvgpr_read_b32 v38,a166
MA a[212:215],v[16:19],v[72:75],a[212:215]
RT v[14:15],v0,54016
v_accvgpr_read_b32 v39,a167
CV v40,v32,v33
CV v41,v34,v35
CV v42,v36,v37
CV v43,v38,v39
s_add_u32 s88,s87,20480
buffer_store_dwordx4 v[40:43],v5,s[40:43],s88 offen offset:0 sc1
MA a[216:219],v[20:23],v[64:67],a[216:219]
RT v[16:17],v0,45056
v_accvgpr_read_b32 v48,a168
v_accvgpr_read_b32 v49,a169
v_accvgpr_read_b32 v50,a170
v_accvgpr_read_b32 v51,a171
v_accvgpr_read_b32 v52,a172
v_accvgpr_read_b32 v53,a173
v_accvgpr_read_b32 v54,a174
MA a[220:223],v[20:23],v[72:75],a[220:223]
RT v[18:19],v0,54272
v_accvgpr_read_b32 v55,a175
CV v56,v48,v49
CV v57,v50,v51
CV v58,v52,v53
CV v59,v54,v55
buffer_store_dwordx4 v[56:59],v5,s[40:43],s88 offen offset:1024 sc1
WL 6
MA a[224:227],v[24:27],v[64:67],a[224:227]
RT v[20:21],v0,45312
v_accvgpr_read_b32 v32,a176
v_accvgpr_read_b32 v33,a177
v_accvgpr_read_b32 v34,a178
v_accvgpr_read_b32 v35,a179
v_accvgpr_read_b32 v36,a180
v_accvgpr_read_b32 v37,a181
v_accvgpr_read_b32 v38,a182
MA a[228:231],v[24:27],v[72:75],a[228:231]
RT v[22:23],v0,54528
v_accvgpr_read_b32 v39,a183
CV v40,v32,v33
CV v41,v34,v35
CV v42,v36,v37
CV v43,v38,v39
buffer_store_dwordx4 v[40:43],v5,s[40:43],s88 offen offset:2048 sc1
MA a[232:235],v[28:31],v[64:67],a[232:235]
RT v[24:25],v0,45568
v_accvgpr_read_b32 v48,a184
v_accvgpr_read_b32 v49,a185
v_accvgpr_read_b32 v50,a186
v_accvgpr_read_b32 v51,a187
v_accvgpr_read_b32 v52,a188
v_accvgpr_read_b32 v53,a189
v_accvgpr_read_b32 v54,a190
MA a[236:239],v[28:31],v[72:75],a[236:239]
RT v[26:27],v0,54784
v_accvgpr_read_b32 v55,a191
CV v56,v48,v49
CV v57,v50,v51
CV v58,v52,v53
CV v59,v54,v55
buffer_store_dwordx4 v[56:59],v5,s[40:43],s88 offen offset:3072 sc1
WL 6
MA a[240:243],v[8:11],v[64:67],a[240:243]
RT v[28:29],v0,45824
v_accvgpr_read_b32 v32,a192
v_accvgpr_read_b32 v33,a193
v_accvgpr_read_b32 v34,a194
v_accvgpr_read_b32 v35,a195
v_accvgpr_read_b32 v36,a196
v_accvgpr_read_b32 v37,a197
v_accvgpr_read_b32 v38,a198
MA a[244:247],v[8:11],v[72:75],a[244:247]
RT v[30:31],v0,55040
v_accvgpr_read_b32 v39,a199
CV v40,v32,v33
CV v41,v34,v35
CV v42,v36,v37
CV v43,v38,v39
s_add_u32 s88,s87,24576
buffer_store_dwordx4 v[40:43],v5,s[40:43],s88 offen offset:0 sc1
MA a[248:251],v[12:15],v[64:67],a[248:251]
v_accvgpr_read_b32 v48,a200
v_accvgpr_read_b32 v49,a201
v_accvgpr_read_b32 v50,a202
v_accvgpr_read_b32 v51,a203
v_accvgpr_read_b32 v52,a204
v_accvgpr_read_b32 v53,a205
v_accvgpr_read_b32 v54,a206
MA a[252:255],v[12:15],v[72:75],a[252:255]
v_accvgpr_read_b32 v55,a207
CV v56,v48,v49
CV v57,v50,v51
CV v58,v52,v53
CV v59,v54,v55
buffer_store_dwordx4 v[56:59],v5,s[40:43],s88 offen offset:1024 sc1
WL 4
MA v[224:227],v[16:19],v[64:67],v[224:227]
v_accvgpr_read_b32 v32,a208
v_accvgpr_read_b32 v33,a209
v_accvgpr_read_b32 v34,a210
v_accvgpr_read_b32 v35,a211
v_accvgpr_read_b32 v36,a212
v_accvgpr_read_b32 v37,a213
v_accvgpr_read_b32 v38,a214
MA v[228:231],v[16:19],v[72:75],v[228:231]
v_accvgpr_read_b32 v39,a215
CV v40,v32,v33
CV v41,v34,v35
CV v42,v36,v37
CV v43,v38,v39
buffer_store_dwordx4 v[40:43],v5,s[40:43],s88 offen offset:2048 sc1
MA v[232:235],v[20:23],v[64:67],v[232:235]
v_accvgpr_read_b32 v48,a216
v_accvgpr_read_b32 v49,a217
v_accvgpr_read_b32 v50,a218
v_accvgpr_read_b32 v51,a219
v_accvgpr_read_b32 v52,a220
v_accvgpr_read_b32 v53,a221
v_accvgpr_read_b32 v54,a222
MA v[236:239],v[20:23],v[72:75],v[236:239]
v_accvgpr_read_b32 v55,a223
CV v56,v48,v49
CV v57,v50,v51
CV v58,v52,v53
CV v59,v54,v55
buffer_store_dwordx4 v[56:59],v5,s[40:43],s88 offen offset:3072 sc1
WL 0
MA v[240:243],v[24:27],v[64:67],v[240:243]
v_accvgpr_read_b32 v32,a224
v_accvgpr_read_b32 v33,a225
v_accvgpr_read_b32 v34,a226
v_accvgpr_read_b32 v35,a227
v_accvgpr_read_b32 v36,a228
v_accvgpr_read_b32 v37,a229
v_accvgpr_read_b32 v38,a230
MA v[244:247],v[24:27],v[72:75],v[244:247]
v_accvgpr_read_b32 v39,a231
CV v40,v32,v33
CV v41,v34,v35
CV v42,v36,v37
CV v43,v38,v39
s_add_u32 s88,s87,28672
buffer_store_dwordx4 v[40:43],v5,s[40:43],s88 offen offset:0 sc1
MA v[248:251],v[28:31],v[64:67],v[248:251]
v_accvgpr_read_b32 v48,a232
v_accvgpr_read_b32 v49,a233
v_accvgpr_read_b32 v50,a234
v_accvgpr_read_b32 v51,a235
v_accvgpr_read_b32 v52,a236
v_accvgpr_read_b32 v53,a237
v_accvgpr_read_b32 v54,a238
v_accvgpr_read_b32 v55,a239
CV v56,v48,v49
CV v57,v50,v51
CV v58,v52,v53
CV v59,v54,v55
buffer_store_dwordx4 v[56:59],v5,s[40:43],s88 offen offset:1024 sc1
v_accvgpr_read_b32 v32,a240
v_accvgpr_read_b32 v33,a241
v_accvgpr_read_b32 v34,a242
v_accvgpr_read_b32 v35,a243
v_accvgpr_read_b32 v36,a244
v_accvgpr_read_b32 v37,a245
v_accvgpr_read_b32 v38,a246
v_accvgpr_read_b32 v39,a247
CV v40,v32,v33
CV v41,v34,v35
CV v42,v36,v37
MA v[252:255],v[28:31],v[72:75],v[252:255]
CV v43,v38,v39
buffer_store_dwordx4 v[40:43],v5,s[40:43],s88 offen offset:2048 sc1
v_accvgpr_read_b32 v48,a248
v_accvgpr_read_b32 v49,a249
v_accvgpr_read_b32 v50,a250
v_accvgpr_read_b32 v51,a251
v_accvgpr_read_b32 v52,a252
v_accvgpr_read_b32 v53,a253
v_accvgpr_read_b32 v54,a254
v_accvgpr_read_b32 v55,a255
CV v56,v48,v49
CV v57,v50,v51
CV v58,v52,v53
CV v59,v54,v55
buffer_store_dwordx4 v[56:59],v5,s[40:43],s88 offen offset:3072 sc1
CV v40,v224,v225
CV v41,v226,v227
CV v42,v228,v229
CV v43,v230,v231
s_add_u32 s88,s87,32768
buffer_store_dwordx4 v[40:43],v5,s[40:43],s88 offen offset:0 sc1
s_nop 7
CV v56,v232,v233
CV v57,v234,v235
CV v58,v236,v237
CV v59,v238,v239
buffer_store_dwordx4 v[56:59],v5,s[40:43],s88 offen offset:1024 sc1
CV v40,v240,v241
CV v41,v242,v243
CV v42,v244,v245
CV v43,v246,v247
buffer_store_dwordx4 v[40:43],v5,s[40:43],s88 offen offset:2048 sc1
CV v56,v248,v249
CV v57,v250,v251
CV v58,v252,v253
CV v59,v254,v255
buffer_store_dwordx4 v[56:59],v5,s[40:43],s88 offen offset:3072 sc1
s_waitcnt vmcnt(36)
s_load_dwordx2 s[46:47],s[0:1],64
WL 0
s_mov_b32 s80,s46
s_mov_b32 s81,s47
s_mov_b32 s82,256
s_mov_b32 s83,0x20000
s_lshr_b32 s48,s2,4
s_sub_u32 s48,s48,7
s_cmp_lt_u32 s48,2
s_cbranch_scc0 L_m_publish
s_load_dwordx2 s[6:7],s[0:1],0
s_load_dwordx2 s[8:9],s[0:1],16
s_load_dwordx2 s[10:11],s[0:1],56
v_mbcnt_lo_u32_b32 v90,-1,0
v_mbcnt_hi_u32_b32 v90,-1,v90
v_add_u32 v100,s3,v90
v_min_u32 v100,1,v100
v_lshlrev_b32 v100,31,v100
v_mov_b32 v99,1
s_lshr_b32 s48,s2,4
s_cmp_ge_u32 s48,9
s_cselect_b32 s49,1,0
s_mul_i32 s50,s49,9
s_sub_u32 s59,s48,s50
s_bfe_u32 s50,s2,0x10003
s_xor_b32 s50,s50,1
s_or_b32 s49,s49,s50
s_and_b32 s58,s2,7
s_lshl_b32 s58,s58,1
s_add_u32 s58,s58,s49
v_and_b32 v10,31,v90
v_lshlrev_b32 v10,3,v10
v_lshrrev_b32 v11,5,v90
v_mul_u32_u24 v11,36864,v11
v_add_u32 v91,v10,v11
v_lshrrev_b32 v12,4,v90
v_lshlrev_b32 v12,5,v12
v_and_b32 v13,1,v90
v_lshl_add_u32 v12,v13,4,v12
s_lshl_b32 s48,s59,7
v_add_u32 v12,s48,v12
v_bfe_u32 v10,v90,3,1
v_bfe_u32 v11,v90,1,2
v_lshl_add_u32 v13,v10,3,v11
v_mul_u32_u24 v13,1152,v13
v_add_u32 v92,v13,v12
v_lshrrev_b32 v13,1,v11
v_lshl_add_u32 v13,v10,2,v13
v_mul_u32_u24 v13,18,v13
v_and_b32 v11,1,v11
v_add_u32 v13,v13,v11
v_mul_u32_u24 v13,1152,v13
v_add_u32 v93,v13,v12
s_and_b32 s52,s3,1
s_cmp_eq_u32 s52,1
s_cselect_b64 vcc,-1,0
v_cndmask_b32 v93,v92,v93,vcc
s_mul_i32 s65,s3,18432
v_lshrrev_b32 v10,5,v90
v_lshlrev_b32 v10,16,v10
v_and_b32 v11,15,v90
v_lshl_add_u32 v10,v11,5,v10
v_bfe_u32 v12,v90,4,1
v_lshl_add_u32 v94,v12,4,v10
v_lshlrev_b32 v10,7,v11
v_lshrrev_b32 v12,4,v90
v_lshl_add_u32 v95,v12,4,v10
v_lshlrev_b32 v96,4,v90
s_lshl_b32 s48,s58,7
s_lshl_b32 s49,s3,5
s_add_u32 s48,s48,s49
s_lshl_b32 s66,s48,5
s_add_u32 s66,s66,51380224
s_lshl_b32 s67,s48,7
s_add_u32 s67,s67,53477376
s_mul_i32 s69,s48,1152
s_lshl_b32 s49,s59,7
s_add_u32 s69,s69,s49
s_lshl_b32 s68,s58,2
s_add_u32 s68,s68,s3
s_mul_i32 s68,s68,36
s_lshl_b32 s49,s59,2
s_add_u32 s68,s68,s49
s_lshl_b32 s68,s68,10
s_add_u32 s68,s68,8388608
v_and_b32 v10,15,v90
v_mul_u32_u24 v10,1152,v10
v_lshrrev_b32 v11,4,v90
v_lshl_add_u32 v97,v11,3,v10
v_and_b32 v12,1,v11
v_lshl_add_u32 v10,v12,5,v10
v_lshrrev_b32 v11,1,v11
v_lshl_add_u32 v98,v11,4,v10
s_lshr_b32 s51,s3,1
s_mul_i32 s90,s51,18
s_mul_i32 s53,s52,324
s_add_u32 s90,s90,s53
s_mul_i32 s90,s90,1152
s_mul_i32 s53,s51,165888
s_add_u32 s54,s90,290304
s_add_u32 s55,s53,18432
s_cmp_eq_u32 s52,1
s_cselect_b32 s84,s55,s54
s_add_u32 s54,s90,294912
s_add_u32 s55,s53,59904
s_cmp_eq_u32 s52,1
s_cselect_b32 s85,s55,s54
s_add_u32 s54,s90,331776
s_add_u32 s55,s53,350208
s_cmp_eq_u32 s52,1
s_cselect_b32 s86,s55,s54
s_add_u32 s54,s90,336384
s_add_u32 s55,s53,391680
s_cmp_eq_u32 s52,1
s_cselect_b32 s87,s55,s54
s_mov_b32 s70,0x00003f80
s_mov_b32 s71,0x3f800000
WL 0
s_mov_b32 s28,s8
s_mov_b32 s29,s9
s_mov_b32 s30,663552
s_mov_b32 s31,0x20000
s_mov_b32 s20,s6
s_mov_b32 s21,s7
s_mov_b32 s22,2359296
s_mov_b32 s23,0x20000
s_mov_b32 s32,s10
s_mov_b32 s33,s11
s_mov_b32 s34,2359296
s_mov_b32 s35,0x20000
s_branch L_final
L_m_publish:
v_mbcnt_lo_u32_b32 v90,-1,0
v_mbcnt_hi_u32_b32 v90,-1,v90
v_add_u32 v100,s3,v90
v_min_u32 v100,1,v100
v_lshlrev_b32 v100,31,v100
v_mov_b32 v99,1
s_waitcnt vmcnt(0)
s_barrier
buffer_atomic_add v99,v100,s[80:83],0 offen offset:128 sc0
s_cmp_lg_u32 s3,0
s_cbranch_scc1 L_nolastarr_m
s_waitcnt vmcnt(0)
v_readfirstlane_b32 s48,v99
s_cmp_lg_u32 s48,255
s_cbranch_scc1 L_nolastarr_m
v_mov_b32 v102,1
s_mov_b32 s48,53739520
v_add_u32 v101,0,v90
v_lshlrev_b32 v101,10,v101
buffer_store_dword v102,v101,s[40:43],s48 offen sc1
v_add_u32 v101,64,v90
v_lshlrev_b32 v101,10,v101
buffer_store_dword v102,v101,s[40:43],s48 offen sc1
v_add_u32 v101,128,v90
v_lshlrev_b32 v101,10,v101
buffer_store_dword v102,v101,s[40:43],s48 offen sc1
v_add_u32 v101,192,v90
v_lshlrev_b32 v101,10,v101
buffer_store_dword v102,v101,s[40:43],s48 offen sc1
L_nolastarr_m:
s_waitcnt vmcnt(0)
s_endpgm
L_last:
s_mov_b32 s28,s36
s_mov_b32 s29,s37
s_mov_b32 s30,s38
s_mov_b32 s31,s39
s_mov_b32 s44,s53
s_mov_b32 s45,s54
s_mov_b32 s46,s55
s_mov_b32 s47,s56
s_mov_b32 s48,s57
s_mov_b32 s49,s58
s_mov_b32 s50,s59
s_mov_b32 s51,s60
s_mov_b32 s52,s61
v_mov_b32 v1,v2
s_branch L_last_back
L_role_a:
s_add_u32 m0,s69,0
s_mov_b32 s70,0
buffer_load_dwordx4 v27,s[20:23],s70 offen lds
v_and_b32 v9,7,v252
v_and_b32 v10,6,v9
v_lshrrev_b32 v11,4,v252
v_xor_b32 v10,v10,v11
v_lshlrev_b32 v9,7,v9
v_lshl_add_u32 v9,v10,4,v9
v_bfe_u32 v10,v252,3,1
v_mul_u32_u24 v10,9216,v10
v_add_u32 v9,v9,v10
v_add_u32 v78,s69,v9
v_xor_b32 v79,64,v78
s_add_u32 m0,s69,9216
s_mov_b32 s70,9216
buffer_load_dwordx4 v27,s[20:23],s70 offen lds
s_mov_b32 s24,s8
s_mov_b32 s25,s9
s_mov_b32 s26,1990656
s_mov_b32 s27,0x20000
s_add_u32 m0,s69,18432
s_mov_b32 s70,18432
buffer_load_dwordx4 v27,s[20:23],s70 offen lds
s_mov_b32 s40,s18
s_mov_b32 s41,s19
s_mov_b32 s42,54001664
s_mov_b32 s43,0x20000
s_add_u32 m0,s69,27648
s_mov_b32 s70,27648
buffer_load_dwordx4 v27,s[20:23],s70 offen lds
s_mov_b32 s80,s16
s_mov_b32 s81,s17
s_mov_b32 s82,256
s_mov_b32 s83,0x20000
s_add_u32 m0,s69,1024
s_mov_b32 s70,128
buffer_load_dwordx4 v27,s[20:23],s70 offen lds
s_mul_i32 s72,s64,144
s_mul_i32 s73,s64,144
s_add_u32 s73,s73,2160
s_add_u32 m0,s69,10240
s_mov_b32 s70,9344
buffer_load_dwordx4 v27,s[20:23],s70 offen lds
v_add_u32 v12,0,v252
v_mul_u32_u24 v13,4682,v12
v_lshrrev_b32 v13,16,v13
v_mul_u32_u24 v14,14,v13
v_sub_u32 v12,v12,v14
v_and_b32 v14,0x13,v13
v_bfe_u32 v15,v13,2,1
v_lshl_or_b32 v14,v15,3,v14
v_bfe_u32 v15,v13,3,1
v_lshl_or_b32 v14,v15,2,v14
v_mul_u32_u24 v14,3456,v14
v_lshl_add_u32 v14,v12,4,v14
v_add_u32 v15,s72,v14
v_add_u32 v14,s73,v14
v_cmp_gt_u32 vcc,9,v12
v_add_u32 v13,1152,v15
v_add_u32 v12,72,v14
v_cndmask_b32 v64,v14,v15,vcc
v_cndmask_b32 v0,v12,v13,vcc
s_add_u32 m0,s69,19456
s_mov_b32 s70,18560
buffer_load_dwordx4 v27,s[20:23],s70 offen lds
v_add_u32 v12,64,v252
v_mul_u32_u24 v13,4682,v12
v_lshrrev_b32 v13,16,v13
v_mul_u32_u24 v14,14,v13
v_sub_u32 v12,v12,v14
v_and_b32 v14,0x13,v13
v_bfe_u32 v15,v13,2,1
v_lshl_or_b32 v14,v15,3,v14
v_bfe_u32 v15,v13,3,1
v_lshl_or_b32 v14,v15,2,v14
v_mul_u32_u24 v14,3456,v14
v_lshl_add_u32 v14,v12,4,v14
v_add_u32 v15,s72,v14
v_add_u32 v14,s73,v14
v_cmp_gt_u32 vcc,9,v12
v_add_u32 v13,1152,v15
v_add_u32 v12,72,v14
v_cndmask_b32 v65,v14,v15,vcc
v_cndmask_b32 v1,v12,v13,vcc
s_add_u32 m0,s69,28672
s_mov_b32 s70,27776
buffer_load_dwordx4 v27,s[20:23],s70 offen lds
v_add_u32 v12,128,v252
v_mul_u32_u24 v13,4682,v12
v_lshrrev_b32 v13,16,v13
v_mul_u32_u24 v14,14,v13
v_sub_u32 v12,v12,v14
v_and_b32 v14,0x13,v13
v_bfe_u32 v15,v13,2,1
v_lshl_or_b32 v14,v15,3,v14
v_bfe_u32 v15,v13,3,1
v_lshl_or_b32 v14,v15,2,v14
v_mul_u32_u24 v14,3456,v14
v_lshl_add_u32 v14,v12,4,v14
v_add_u32 v15,s72,v14
v_add_u32 v14,s73,v14
v_cmp_gt_u32 vcc,9,v12
v_add_u32 v13,1152,v15
v_add_u32 v12,72,v14
v_cndmask_b32 v66,v14,v15,vcc
v_cndmask_b32 v2,v12,v13,vcc
s_add_u32 m0,s69,2048
s_mov_b32 s70,256
buffer_load_dwordx4 v27,s[20:23],s70 offen lds
v_add_u32 v12,192,v252
v_mul_u32_u24 v13,4682,v12
v_lshrrev_b32 v13,16,v13
v_mul_u32_u24 v14,14,v13
v_sub_u32 v12,v12,v14
v_and_b32 v14,0x13,v13
v_bfe_u32 v15,v13,2,1
v_lshl_or_b32 v14,v15,3,v14
v_bfe_u32 v15,v13,3,1
v_lshl_or_b32 v14,v15,2,v14
v_mul_u32_u24 v14,3456,v14
v_lshl_add_u32 v14,v12,4,v14
v_add_u32 v15,s72,v14
v_add_u32 v14,s73,v14
v_cmp_gt_u32 vcc,9,v12
v_add_u32 v13,1152,v15
v_add_u32 v12,72,v14
v_cndmask_b32 v67,v14,v15,vcc
v_cndmask_b32 v3,v12,v13,vcc
s_add_u32 m0,s69,11264
s_mov_b32 s70,9472
buffer_load_dwordx4 v27,s[20:23],s70 offen lds
v_add_u32 v12,256,v252
v_mul_u32_u24 v13,4682,v12
v_lshrrev_b32 v13,16,v13
v_mul_u32_u24 v14,14,v13
v_sub_u32 v12,v12,v14
v_and_b32 v14,0x13,v13
v_bfe_u32 v15,v13,2,1
v_lshl_or_b32 v14,v15,3,v14
v_bfe_u32 v15,v13,3,1
v_lshl_or_b32 v14,v15,2,v14
v_mul_u32_u24 v14,3456,v14
v_lshl_add_u32 v14,v12,4,v14
v_add_u32 v15,s72,v14
v_add_u32 v14,s73,v14
v_cmp_gt_u32 vcc,9,v12
v_add_u32 v13,1152,v15
v_add_u32 v12,72,v14
v_cndmask_b32 v68,v14,v15,vcc
v_cndmask_b32 v4,v12,v13,vcc
s_add_u32 m0,s69,20480
s_mov_b32 s70,18688
buffer_load_dwordx4 v27,s[20:23],s70 offen lds
s_add_u32 m0,s69,29696
s_mov_b32 s70,27904
buffer_load_dwordx4 v27,s[20:23],s70 offen lds
v_add_u32 v12,320,v252
v_mul_u32_u24 v13,4682,v12
v_lshrrev_b32 v13,16,v13
v_mul_u32_u24 v14,14,v13
v_sub_u32 v12,v12,v14
v_and_b32 v14,0x13,v13
v_bfe_u32 v15,v13,2,1
v_lshl_or_b32 v14,v15,3,v14
v_bfe_u32 v15,v13,3,1
v_lshl_or_b32 v14,v15,2,v14
v_mul_u32_u24 v14,3456,v14
v_lshl_add_u32 v14,v12,4,v14
v_add_u32 v15,s72,v14
v_add_u32 v14,s73,v14
v_cmp_gt_u32 vcc,9,v12
v_add_u32 v13,1152,v15
v_add_u32 v12,72,v14
v_cndmask_b32 v69,v14,v15,vcc
v_cndmask_b32 v5,v12,v13,vcc
s_add_u32 m0,s69,3072
s_mov_b32 s70,384
buffer_load_dwordx4 v27,s[20:23],s70 offen lds
v_add_u32 v12,384,v252
v_mul_u32_u24 v13,4682,v12
v_lshrrev_b32 v13,16,v13
v_mul_u32_u24 v14,14,v13
v_sub_u32 v12,v12,v14
v_and_b32 v14,0x13,v13
v_bfe_u32 v15,v13,2,1
v_lshl_or_b32 v14,v15,3,v14
v_bfe_u32 v15,v13,3,1
v_lshl_or_b32 v14,v15,2,v14
v_mul_u32_u24 v14,3456,v14
v_lshl_add_u32 v14,v12,4,v14
v_add_u32 v15,s72,v14
v_add_u32 v14,s73,v14
v_cmp_gt_u32 vcc,9,v12
v_add_u32 v13,1152,v15
v_add_u32 v12,72,v14
v_cndmask_b32 v70,v14,v15,vcc
v_cndmask_b32 v6,v12,v13,vcc
s_add_u32 m0,s69,12288
s_mov_b32 s70,9600
buffer_load_dwordx4 v27,s[20:23],s70 offen lds
s_mul_i32 s90,s3,7168
s_mul_i32 s91,s3,110592
s_add_u32 m0,s69,21504
s_mov_b32 s70,18816
buffer_load_dwordx4 v27,s[20:23],s70 offen lds
v_lshrrev_b32 v9,5,v252
v_lshlrev_b32 v9,4,v9
v_bfe_u32 v10,v252,2,3
v_add_u32 v9,v9,v10
v_mul_u32_u24 v9,224,v9
v_and_b32 v10,3,v252
v_lshl_add_u32 v72,v10,3,v9
v_bfe_u32 v10,v252,1,1
v_mul_u32_u24 v10,72,v10
v_add_u32 v10,32,v10
v_add_u32 v73,v9,v10
s_add_u32 m0,s69,30720
s_mov_b32 s70,28032
buffer_load_dwordx4 v27,s[20:23],s70 offen lds
s_lshl_b32 s74,s4,2
s_add_u32 s74,s74,s3
s_lshl_b32 s84,s64,18
s_lshl_b32 s75,s74,10
s_add_u32 s84,s84,s75
s_lshl_b32 s85,s64,15
s_lshl_b32 s75,s74,7
s_add_u32 s85,s85,s75
s_add_u32 s85,s85,4194304
s_mul_i32 s86,s64,327680
s_mul_i32 s75,s74,1280
s_add_u32 s86,s86,s75
s_add_u32 s86,s86,5242880
s_add_u32 m0,s69,4096
s_mov_b32 s70,512
buffer_load_dwordx4 v27,s[20:23],s70 offen lds
v_lshrrev_b32 v9,5,v252
v_lshlrev_b32 v9,9,v9
v_and_b32 v10,31,v252
v_lshl_add_u32 v234,v10,4,v9
s_add_u32 m0,s69,13312
s_mov_b32 s70,9728
buffer_load_dwordx4 v27,s[20:23],s70 offen lds
v_lshrrev_b32 v9,5,v252
v_lshlrev_b32 v9,14,v9
v_and_b32 v10,15,v252
v_lshl_add_u32 v9,v10,2,v9
v_bfe_u32 v10,v252,4,1
v_lshl_or_b32 v235,v10,31,v9
s_add_u32 m0,s69,22528
s_mov_b32 s70,18944
buffer_load_dwordx4 v27,s[20:23],s70 offen lds
v_and_b32 v9,15,v252
v_add_u32 v9,0,v9
v_lshlrev_b32 v10,6,v9
v_add_u32 v11,80768,v10
v_cmp_gt_u32 vcc,18,v9
s_nop 1
v_cndmask_b32 v10,v11,v10,vcc
v_mov_b32 v11,0x80000000
v_cmp_gt_u32 vcc,36,v9
s_nop 1
v_cndmask_b32 v10,v11,v10,vcc
v_lshrrev_b32 v9,4,v252
v_lshl_add_u32 v236,v9,4,v10
s_add_u32 m0,s69,31744
s_mov_b32 s70,28160
buffer_load_dwordx4 v27,s[20:23],s70 offen lds
v_and_b32 v9,15,v252
v_add_u32 v9,16,v9
v_lshlrev_b32 v10,6,v9
v_add_u32 v11,80768,v10
v_cmp_gt_u32 vcc,18,v9
s_nop 1
v_cndmask_b32 v10,v11,v10,vcc
v_mov_b32 v11,0x80000000
v_cmp_gt_u32 vcc,36,v9
s_nop 1
v_cndmask_b32 v10,v11,v10,vcc
v_lshrrev_b32 v9,4,v252
v_lshl_add_u32 v237,v9,4,v10
s_add_u32 m0,s69,5120
s_mov_b32 s70,640
buffer_load_dwordx4 v27,s[20:23],s70 offen lds
v_and_b32 v9,15,v252
v_add_u32 v9,32,v9
v_lshlrev_b32 v10,6,v9
v_add_u32 v11,80768,v10
v_cmp_gt_u32 vcc,18,v9
s_nop 1
v_cndmask_b32 v10,v11,v10,vcc
v_mov_b32 v11,0x80000000
v_cmp_gt_u32 vcc,36,v9
s_nop 1
v_cndmask_b32 v10,v11,v10,vcc
v_lshrrev_b32 v9,4,v252
v_lshl_add_u32 v238,v9,4,v10
s_add_u32 m0,s69,14336
s_mov_b32 s70,9856
buffer_load_dwordx4 v27,s[20:23],s70 offen lds
s_add_u32 m0,s69,23552
s_mov_b32 s70,19072
buffer_load_dwordx4 v27,s[20:23],s70 offen lds
v_bfe_u32 v9,v252,3,1
v_mul_u32_u24 v9,81920,v9
v_bfe_u32 v10,v252,2,1
v_add_u32 v10,18,v10
v_lshl_add_u32 v9,v10,6,v9
v_and_b32 v10,3,v252
v_lshl_add_u32 v9,v10,4,v9
v_mov_b32 v11,0x80000000
v_cmp_gt_u32 vcc,16,v252
s_nop 1
v_cndmask_b32 v239,v11,v9,vcc
s_add_u32 m0,s69,32768
s_mov_b32 s70,28288
buffer_load_dwordx4 v27,s[20:23],s70 offen lds
v_bfe_u32 v10,v252,2,1
v_cmp_eq_u32 vcc,0,v10
v_mov_b32 v9,0x3f803f80
v_mov_b32 v10,0
v_cndmask_b32 v240,v10,v9,vcc
v_cndmask_b32 v241,v10,v9,vcc
v_cndmask_b32 v242,v10,v9,vcc
v_cndmask_b32 v243,v10,v9,vcc
s_add_u32 m0,s69,6144
s_mov_b32 s70,768
buffer_load_dwordx4 v27,s[20:23],s70 offen lds
v_mov_b32 v254,1
v_mov_b32 v11,0x80000000
v_mov_b32 v10,0
v_cmp_eq_u32 vcc,0,v253
s_nop 1
v_cndmask_b32 v255,v11,v10,vcc
s_add_u32 m0,s69,15360
s_mov_b32 s70,9984
buffer_load_dwordx4 v27,s[20:23],s70 offen lds
s_add_u32 s6,s91,0
s_add_u32 s7,s91,442368
s_add_u32 s8,s91,884736
s_add_u32 s9,s91,1327104
s_lshr_b32 s11,s3,1
s_mul_i32 s10,s11,110592
s_add_u32 s10,s10,1769472
s_mul_i32 s11,s11,7168
s_and_b32 s74,s3,1
s_mul_i32 s75,s74,3072
s_add_u32 s11,s11,s75
s_add_u32 m0,s69,24576
s_mov_b32 s70,19200
buffer_load_dwordx4 v27,s[20:23],s70 offen lds
s_cmp_eq_u32 s74,1
s_cselect_b64 vcc,-1,0
v_cndmask_b32 v74,v64,v67,vcc
v_cndmask_b32 v75,v65,v68,vcc
v_cndmask_b32 v76,v66,v69,vcc
v_cndmask_b32 v77,v67,v70,vcc
s_add_u32 m0,s69,33792
s_mov_b32 s70,28416
buffer_load_dwordx4 v27,s[20:23],s70 offen lds
s_and_b32 s74,s3,1
s_cmp_eq_u32 s74,1
s_mul_i32 s75,s64,144
s_mov_b32 s76,0
s_cselect_b32 s76,2304,s76
s_add_u32 s75,s75,s76
s_add_u32 m0,s69,7168
s_mov_b32 s70,896
buffer_load_dwordx4 v27,s[20:23],s70 offen lds
s_and_b32 s74,s3,1
s_cmp_eq_u32 s74,1
s_mov_b32 s76,1152
s_cselect_b32 s76,72,s76
s_lshr_b32 s77,s3,1
s_mul_i32 s76,s76,s77
s_add_u32 s75,s75,s76
s_mul_i32 s76,s4,124416
s_add_u32 s92,s75,s76
s_add_u32 m0,s69,16384
s_mov_b32 s70,10112
buffer_load_dwordx4 v27,s[20:23],s70 offen lds
v_add_u32 v9,0,v252
v_lshrrev_b32 v10,1,v9
v_mul_u32_u24 v10,3456,v10
v_and_b32 v11,1,v9
v_lshl_add_u32 v10,v11,7,v10
v_mov_b32 v11,0x80000000
v_cmp_gt_u32 vcc,72,v9
s_nop 1
v_cndmask_b32 v44,v11,v10,vcc
s_add_u32 m0,s69,25600
s_mov_b32 s70,19328
buffer_load_dwordx4 v27,s[20:23],s70 offen lds
v_add_u32 v9,64,v252
v_lshrrev_b32 v10,1,v9
v_mul_u32_u24 v10,3456,v10
v_and_b32 v11,1,v9
v_lshl_add_u32 v10,v11,7,v10
v_mov_b32 v11,0x80000000
v_cmp_gt_u32 vcc,72,v9
s_nop 1
v_cndmask_b32 v45,v11,v10,vcc
s_add_u32 m0,s69,34816
s_mov_b32 s70,28544
buffer_load_dwordx4 v27,s[20:23],s70 offen lds
s_add_u32 m0,s69,8192
s_mov_b32 s70,1024
buffer_load_dwordx4 v27,s[20:23],s70 offen lds
s_add_u32 m0,s69,17408
s_mov_b32 s70,10240
buffer_load_dwordx4 v27,s[20:23],s70 offen lds
s_add_u32 m0,s69,26624
s_mov_b32 s70,19456
buffer_load_dwordx4 v27,s[20:23],s70 offen lds
s_add_u32 m0,s69,35840
s_mov_b32 s70,28672
buffer_load_dwordx4 v27,s[20:23],s70 offen lds
buffer_store_dwordx4 v[240:243],v239,s[40:43],s86 offen sc1
s_add_u32 s88,s86,163840
buffer_store_dwordx4 v[240:243],v239,s[40:43],s88 offen sc1
s_mov_b32 m0,147456
s_nop 0
buffer_load_dword v44,s[24:27],s92 offen lds
buffer_load_dword v45,s[24:27],s92 offen lds
v_mov_b32 v48,0
v_mov_b32 v49,0
v_mov_b32 v50,0
v_mov_b32 v51,0
v_mov_b32 v52,0
v_mov_b32 v53,0
v_mov_b32 v54,0
v_mov_b32 v55,0
v_mov_b32 v56,0
v_mov_b32 v57,0
v_mov_b32 v58,0
v_mov_b32 v59,0
v_mov_b32 v60,0
v_mov_b32 v61,0
v_mov_b32 v62,0
v_mov_b32 v63,0
s_mov_b32 s72,0x3f803f80
s_waitcnt vmcnt(36)
ds_read_b128 v[80:83],v78 offset:0
ds_read_b128 v[88:91],v79 offset:0
ds_read_b128 v[84:87],v78 offset:18432
ds_read_b128 v[92:95],v79 offset:18432
s_waitcnt vmcnt(32)
ds_read_b128 v[96:99],v78 offset:1024
ds_read_b128 v[104:107],v79 offset:1024
ds_read_b128 v[100:103],v78 offset:19456
ds_read_b128 v[108:111],v79 offset:19456
s_waitcnt vmcnt(28)
ds_read_b128 v[112:115],v78 offset:2048
ds_read_b128 v[120:123],v79 offset:2048
ds_read_b128 v[116:119],v78 offset:20480
ds_read_b128 v[124:127],v79 offset:20480
s_waitcnt vmcnt(24)
ds_read_b128 v[128:131],v78 offset:3072
ds_read_b128 v[136:139],v79 offset:3072
ds_read_b128 v[132:135],v78 offset:21504
ds_read_b128 v[140:143],v79 offset:21504
WL 15
v_dot2c_f32_bf16 v48,s72,v80
v_dot2c_f32_bf16 v49,s72,v81
v_dot2c_f32_bf16 v50,s72,v82
v_dot2c_f32_bf16 v51,s72,v83
v_dot2c_f32_bf16 v52,v80,v80
v_dot2c_f32_bf16 v53,v81,v81
v_dot2c_f32_bf16 v54,v82,v82
v_dot2c_f32_bf16 v55,v83,v83
WL 14
v_dot2c_f32_bf16 v48,s72,v88
v_dot2c_f32_bf16 v49,s72,v89
v_dot2c_f32_bf16 v50,s72,v90
v_dot2c_f32_bf16 v51,s72,v91
v_dot2c_f32_bf16 v52,v88,v88
v_dot2c_f32_bf16 v53,v89,v89
v_dot2c_f32_bf16 v54,v90,v90
v_dot2c_f32_bf16 v55,v91,v91
WL 13
v_dot2c_f32_bf16 v56,s72,v84
v_dot2c_f32_bf16 v57,s72,v85
v_dot2c_f32_bf16 v58,s72,v86
v_dot2c_f32_bf16 v59,s72,v87
v_dot2c_f32_bf16 v60,v84,v84
v_dot2c_f32_bf16 v61,v85,v85
v_dot2c_f32_bf16 v62,v86,v86
v_dot2c_f32_bf16 v63,v87,v87
WL 12
v_dot2c_f32_bf16 v56,s72,v92
v_dot2c_f32_bf16 v57,s72,v93
v_dot2c_f32_bf16 v58,s72,v94
v_dot2c_f32_bf16 v59,s72,v95
v_dot2c_f32_bf16 v60,v92,v92
v_dot2c_f32_bf16 v61,v93,v93
v_dot2c_f32_bf16 v62,v94,v94
v_dot2c_f32_bf16 v63,v95,v95
s_waitcnt vmcnt(20)
ds_read_b128 v[144:147],v78 offset:4096
ds_read_b128 v[152:155],v79 offset:4096
ds_read_b128 v[148:151],v78 offset:22528
ds_read_b128 v[156:159],v79 offset:22528
WL 15
v_dot2c_f32_bf16 v48,s72,v96
v_dot2c_f32_bf16 v49,s72,v97
v_dot2c_f32_bf16 v50,s72,v98
v_dot2c_f32_bf16 v51,s72,v99
v_dot2c_f32_bf16 v52,v96,v96
v_dot2c_f32_bf16 v53,v97,v97
v_dot2c_f32_bf16 v54,v98,v98
v_dot2c_f32_bf16 v55,v99,v99
WL 14
v_dot2c_f32_bf16 v48,s72,v104
v_dot2c_f32_bf16 v49,s72,v105
v_dot2c_f32_bf16 v50,s72,v106
v_dot2c_f32_bf16 v51,s72,v107
v_dot2c_f32_bf16 v52,v104,v104
v_dot2c_f32_bf16 v53,v105,v105
v_dot2c_f32_bf16 v54,v106,v106
v_dot2c_f32_bf16 v55,v107,v107
WL 13
v_dot2c_f32_bf16 v56,s72,v100
v_dot2c_f32_bf16 v57,s72,v101
v_dot2c_f32_bf16 v58,s72,v102
v_dot2c_f32_bf16 v59,s72,v103
v_dot2c_f32_bf16 v60,v100,v100
v_dot2c_f32_bf16 v61,v101,v101
v_dot2c_f32_bf16 v62,v102,v102
v_dot2c_f32_bf16 v63,v103,v103
WL 12
v_dot2c_f32_bf16 v56,s72,v108
v_dot2c_f32_bf16 v57,s72,v109
v_dot2c_f32_bf16 v58,s72,v110
v_dot2c_f32_bf16 v59,s72,v111
v_dot2c_f32_bf16 v60,v108,v108
v_dot2c_f32_bf16 v61,v109,v109
v_dot2c_f32_bf16 v62,v110,v110
v_dot2c_f32_bf16 v63,v111,v111
s_waitcnt vmcnt(16)
ds_read_b128 v[160:163],v78 offset:5120
ds_read_b128 v[168:171],v79 offset:5120
ds_read_b128 v[164:167],v78 offset:23552
ds_read_b128 v[172:175],v79 offset:23552
WL 15
v_dot2c_f32_bf16 v48,s72,v112
v_dot2c_f32_bf16 v49,s72,v113
v_dot2c_f32_bf16 v50,s72,v114
v_dot2c_f32_bf16 v51,s72,v115
v_dot2c_f32_bf16 v52,v112,v112
v_dot2c_f32_bf16 v53,v113,v113
v_dot2c_f32_bf16 v54,v114,v114
v_dot2c_f32_bf16 v55,v115,v115
WL 14
v_dot2c_f32_bf16 v48,s72,v120
v_dot2c_f32_bf16 v49,s72,v121
v_dot2c_f32_bf16 v50,s72,v122
v_dot2c_f32_bf16 v51,s72,v123
v_dot2c_f32_bf16 v52,v120,v120
v_dot2c_f32_bf16 v53,v121,v121
v_dot2c_f32_bf16 v54,v122,v122
v_dot2c_f32_bf16 v55,v123,v123
WL 13
v_dot2c_f32_bf16 v56,s72,v116
v_dot2c_f32_bf16 v57,s72,v117
v_dot2c_f32_bf16 v58,s72,v118
v_dot2c_f32_bf16 v59,s72,v119
v_dot2c_f32_bf16 v60,v116,v116
v_dot2c_f32_bf16 v61,v117,v117
v_dot2c_f32_bf16 v62,v118,v118
v_dot2c_f32_bf16 v63,v119,v119
WL 12
v_dot2c_f32_bf16 v56,s72,v124
v_dot2c_f32_bf16 v57,s72,v125
v_dot2c_f32_bf16 v58,s72,v126
v_dot2c_f32_bf16 v59,s72,v127
v_dot2c_f32_bf16 v60,v124,v124
v_dot2c_f32_bf16 v61,v125,v125
v_dot2c_f32_bf16 v62,v126,v126
v_dot2c_f32_bf16 v63,v127,v127
s_waitcnt vmcnt(12)
ds_read_b128 v[176:179],v78 offset:6144
ds_read_b128 v[184:187],v79 offset:6144
ds_read_b128 v[180:183],v78 offset:24576
ds_read_b128 v[188:191],v79 offset:24576
WL 15
v_dot2c_f32_bf16 v48,s72,v128
v_dot2c_f32_bf16 v49,s72,v129
v_dot2c_f32_bf16 v50,s72,v130
v_dot2c_f32_bf16 v51,s72,v131
v_dot2c_f32_bf16 v52,v128,v128
v_dot2c_f32_bf16 v53,v129,v129
v_dot2c_f32_bf16 v54,v130,v130
v_dot2c_f32_bf16 v55,v131,v131
WL 14
v_dot2c_f32_bf16 v48,s72,v136
v_dot2c_f32_bf16 v49,s72,v137
v_dot2c_f32_bf16 v50,s72,v138
v_dot2c_f32_bf16 v51,s72,v139
v_dot2c_f32_bf16 v52,v136,v136
v_dot2c_f32_bf16 v53,v137,v137
v_dot2c_f32_bf16 v54,v138,v138
v_dot2c_f32_bf16 v55,v139,v139
WL 13
v_dot2c_f32_bf16 v56,s72,v132
v_dot2c_f32_bf16 v57,s72,v133
v_dot2c_f32_bf16 v58,s72,v134
v_dot2c_f32_bf16 v59,s72,v135
v_dot2c_f32_bf16 v60,v132,v132
v_dot2c_f32_bf16 v61,v133,v133
v_dot2c_f32_bf16 v62,v134,v134
v_dot2c_f32_bf16 v63,v135,v135
WL 12
v_dot2c_f32_bf16 v56,s72,v140
v_dot2c_f32_bf16 v57,s72,v141
v_dot2c_f32_bf16 v58,s72,v142
v_dot2c_f32_bf16 v59,s72,v143
v_dot2c_f32_bf16 v60,v140,v140
v_dot2c_f32_bf16 v61,v141,v141
v_dot2c_f32_bf16 v62,v142,v142
v_dot2c_f32_bf16 v63,v143,v143
s_waitcnt vmcnt(8)
ds_read_b128 v[192:195],v78 offset:7168
ds_read_b128 v[200:203],v79 offset:7168
ds_read_b128 v[196:199],v78 offset:25600
ds_read_b128 v[204:207],v79 offset:25600
WL 15
v_dot2c_f32_bf16 v48,s72,v144
v_dot2c_f32_bf16 v49,s72,v145
v_dot2c_f32_bf16 v50,s72,v146
v_dot2c_f32_bf16 v51,s72,v147
v_dot2c_f32_bf16 v52,v144,v144
v_dot2c_f32_bf16 v53,v145,v145
v_dot2c_f32_bf16 v54,v146,v146
v_dot2c_f32_bf16 v55,v147,v147
WL 14
v_dot2c_f32_bf16 v48,s72,v152
v_dot2c_f32_bf16 v49,s72,v153
v_dot2c_f32_bf16 v50,s72,v154
v_dot2c_f32_bf16 v51,s72,v155
v_dot2c_f32_bf16 v52,v152,v152
v_dot2c_f32_bf16 v53,v153,v153
v_dot2c_f32_bf16 v54,v154,v154
v_dot2c_f32_bf16 v55,v155,v155
WL 13
v_dot2c_f32_bf16 v56,s72,v148
v_dot2c_f32_bf16 v57,s72,v149
v_dot2c_f32_bf16 v58,s72,v150
v_dot2c_f32_bf16 v59,s72,v151
v_dot2c_f32_bf16 v60,v148,v148
v_dot2c_f32_bf16 v61,v149,v149
v_dot2c_f32_bf16 v62,v150,v150
v_dot2c_f32_bf16 v63,v151,v151
WL 12
v_dot2c_f32_bf16 v56,s72,v156
v_dot2c_f32_bf16 v57,s72,v157
v_dot2c_f32_bf16 v58,s72,v158
v_dot2c_f32_bf16 v59,s72,v159
v_dot2c_f32_bf16 v60,v156,v156
v_dot2c_f32_bf16 v61,v157,v157
v_dot2c_f32_bf16 v62,v158,v158
v_dot2c_f32_bf16 v63,v159,v159
s_waitcnt vmcnt(4)
ds_read_b128 v[208:211],v78 offset:8192
ds_read_b128 v[216:219],v79 offset:8192
ds_read_b128 v[212:215],v78 offset:26624
ds_read_b128 v[220:223],v79 offset:26624
WL 15
v_dot2c_f32_bf16 v48,s72,v160
v_dot2c_f32_bf16 v49,s72,v161
v_dot2c_f32_bf16 v50,s72,v162
v_dot2c_f32_bf16 v51,s72,v163
v_dot2c_f32_bf16 v52,v160,v160
v_dot2c_f32_bf16 v53,v161,v161
v_dot2c_f32_bf16 v54,v162,v162
v_dot2c_f32_bf16 v55,v163,v163
WL 14
v_dot2c_f32_bf16 v48,s72,v168
v_dot2c_f32_bf16 v49,s72,v169
v_dot2c_f32_bf16 v50,s72,v170
v_dot2c_f32_bf16 v51,s72,v171
v_dot2c_f32_bf16 v52,v168,v168
v_dot2c_f32_bf16 v53,v169,v169
v_dot2c_f32_bf16 v54,v170,v170
v_dot2c_f32_bf16 v55,v171,v171
WL 13
v_dot2c_f32_bf16 v56,s72,v164
v_dot2c_f32_bf16 v57,s72,v165
v_dot2c_f32_bf16 v58,s72,v166
v_dot2c_f32_bf16 v59,s72,v167
v_dot2c_f32_bf16 v60,v164,v164
v_dot2c_f32_bf16 v61,v165,v165
v_dot2c_f32_bf16 v62,v166,v166
v_dot2c_f32_bf16 v63,v167,v167
WL 12
v_dot2c_f32_bf16 v56,s72,v172
v_dot2c_f32_bf16 v57,s72,v173
v_dot2c_f32_bf16 v58,s72,v174
v_dot2c_f32_bf16 v59,s72,v175
v_dot2c_f32_bf16 v60,v172,v172
v_dot2c_f32_bf16 v61,v173,v173
v_dot2c_f32_bf16 v62,v174,v174
v_dot2c_f32_bf16 v63,v175,v175
WL 0
s_barrier
s_add_u32 m0,s90,0
s_nop 0
buffer_load_dwordx4 v64,s[24:27],s6 offen lds
s_add_u32 m0,s90,1024
s_nop 0
buffer_load_dwordx4 v65,s[24:27],s6 offen lds
WL 11
v_dot2c_f32_bf16 v48,s72,v176
v_dot2c_f32_bf16 v49,s72,v177
v_dot2c_f32_bf16 v50,s72,v178
v_dot2c_f32_bf16 v51,s72,v179
v_dot2c_f32_bf16 v52,v176,v176
v_dot2c_f32_bf16 v53,v177,v177
v_dot2c_f32_bf16 v54,v178,v178
v_dot2c_f32_bf16 v55,v179,v179
WL 10
v_dot2c_f32_bf16 v48,s72,v184
v_dot2c_f32_bf16 v49,s72,v185
v_dot2c_f32_bf16 v50,s72,v186
v_dot2c_f32_bf16 v51,s72,v187
v_dot2c_f32_bf16 v52,v184,v184
v_dot2c_f32_bf16 v53,v185,v185
v_dot2c_f32_bf16 v54,v186,v186
v_dot2c_f32_bf16 v55,v187,v187
s_add_u32 m0,s90,2048
s_nop 0
buffer_load_dwordx4 v66,s[24:27],s6 offen lds
WL 9
v_dot2c_f32_bf16 v56,s72,v180
v_dot2c_f32_bf16 v57,s72,v181
v_dot2c_f32_bf16 v58,s72,v182
v_dot2c_f32_bf16 v59,s72,v183
v_dot2c_f32_bf16 v60,v180,v180
v_dot2c_f32_bf16 v61,v181,v181
v_dot2c_f32_bf16 v62,v182,v182
v_dot2c_f32_bf16 v63,v183,v183
WL 8
v_dot2c_f32_bf16 v56,s72,v188
v_dot2c_f32_bf16 v57,s72,v189
v_dot2c_f32_bf16 v58,s72,v190
v_dot2c_f32_bf16 v59,s72,v191
v_dot2c_f32_bf16 v60,v188,v188
v_dot2c_f32_bf16 v61,v189,v189
v_dot2c_f32_bf16 v62,v190,v190
v_dot2c_f32_bf16 v63,v191,v191
s_add_u32 m0,s90,3072
s_nop 0
buffer_load_dwordx4 v67,s[24:27],s6 offen lds
WL 7
v_dot2c_f32_bf16 v48,s72,v192
v_dot2c_f32_bf16 v49,s72,v193
v_dot2c_f32_bf16 v50,s72,v194
v_dot2c_f32_bf16 v51,s72,v195
v_dot2c_f32_bf16 v52,v192,v192
v_dot2c_f32_bf16 v53,v193,v193
v_dot2c_f32_bf16 v54,v194,v194
v_dot2c_f32_bf16 v55,v195,v195
WL 6
v_dot2c_f32_bf16 v48,s72,v200
v_dot2c_f32_bf16 v49,s72,v201
v_dot2c_f32_bf16 v50,s72,v202
v_dot2c_f32_bf16 v51,s72,v203
v_dot2c_f32_bf16 v52,v200,v200
v_dot2c_f32_bf16 v53,v201,v201
v_dot2c_f32_bf16 v54,v202,v202
v_dot2c_f32_bf16 v55,v203,v203
s_add_u32 m0,s90,4096
s_nop 0
buffer_load_dwordx4 v68,s[24:27],s6 offen lds
WL 5
v_dot2c_f32_bf16 v56,s72,v196
v_dot2c_f32_bf16 v57,s72,v197
v_dot2c_f32_bf16 v58,s72,v198
v_dot2c_f32_bf16 v59,s72,v199
v_dot2c_f32_bf16 v60,v196,v196
v_dot2c_f32_bf16 v61,v197,v197
v_dot2c_f32_bf16 v62,v198,v198
v_dot2c_f32_bf16 v63,v199,v199
WL 4
v_dot2c_f32_bf16 v56,s72,v204
v_dot2c_f32_bf16 v57,s72,v205
v_dot2c_f32_bf16 v58,s72,v206
v_dot2c_f32_bf16 v59,s72,v207
v_dot2c_f32_bf16 v60,v204,v204
v_dot2c_f32_bf16 v61,v205,v205
v_dot2c_f32_bf16 v62,v206,v206
v_dot2c_f32_bf16 v63,v207,v207
s_add_u32 m0,s90,5120
s_nop 0
buffer_load_dwordx4 v69,s[24:27],s6 offen lds
WL 3
v_dot2c_f32_bf16 v48,s72,v208
v_dot2c_f32_bf16 v49,s72,v209
v_dot2c_f32_bf16 v50,s72,v210
v_dot2c_f32_bf16 v51,s72,v211
v_dot2c_f32_bf16 v52,v208,v208
v_dot2c_f32_bf16 v53,v209,v209
v_dot2c_f32_bf16 v54,v210,v210
v_dot2c_f32_bf16 v55,v211,v211
WL 2
v_dot2c_f32_bf16 v48,s72,v216
v_dot2c_f32_bf16 v49,s72,v217
v_dot2c_f32_bf16 v50,s72,v218
v_dot2c_f32_bf16 v51,s72,v219
v_dot2c_f32_bf16 v52,v216,v216
v_dot2c_f32_bf16 v53,v217,v217
v_dot2c_f32_bf16 v54,v218,v218
v_dot2c_f32_bf16 v55,v219,v219
s_add_u32 m0,s90,6144
s_nop 0
buffer_load_dwordx4 v70,s[24:27],s6 offen lds
WL 1
v_dot2c_f32_bf16 v56,s72,v212
v_dot2c_f32_bf16 v57,s72,v213
v_dot2c_f32_bf16 v58,s72,v214
v_dot2c_f32_bf16 v59,s72,v215
v_dot2c_f32_bf16 v60,v212,v212
v_dot2c_f32_bf16 v61,v213,v213
v_dot2c_f32_bf16 v62,v214,v214
v_dot2c_f32_bf16 v63,v215,v215
WL 0
v_dot2c_f32_bf16 v56,s72,v220
v_dot2c_f32_bf16 v57,s72,v221
v_dot2c_f32_bf16 v58,s72,v222
v_dot2c_f32_bf16 v59,s72,v223
v_dot2c_f32_bf16 v60,v220,v220
v_dot2c_f32_bf16 v61,v221,v221
v_dot2c_f32_bf16 v62,v222,v222
v_dot2c_f32_bf16 v63,v223,v223
s_add_u32 m0,s90,28672
s_nop 0
buffer_load_dwordx4 v64,s[24:27],s7 offen lds
s_nop 2
v_add_f32 v48,v48,v49
v_add_f32 v50,v50,v51
v_add_f32 v52,v52,v53
v_add_f32 v54,v54,v55
v_add_f32 v56,v56,v57
v_add_f32 v58,v58,v59
v_add_f32 v60,v60,v61
v_add_f32 v62,v62,v63
v_add_f32 v32,v48,v50
v_add_f32 v34,v52,v54
v_add_f32 v33,v56,v58
v_add_f32 v35,v60,v62
v_mov_b32 v36,v32
v_mov_b32 v37,v33
v_mov_b32 v38,v34
v_mov_b32 v39,v35
s_nop 1
v_permlane32_swap_b32 v32,v36
v_permlane32_swap_b32 v33,v37
v_permlane32_swap_b32 v34,v38
v_permlane32_swap_b32 v35,v39
s_nop 1
v_add_f32 v32,v32,v36
v_add_f32 v33,v33,v37
v_add_f32 v34,v34,v38
v_add_f32 v35,v35,v39
v_mov_b32 v36,v32
v_mov_b32 v37,v33
v_mov_b32 v38,v34
v_mov_b32 v39,v35
s_nop 1
v_permlane16_swap_b32 v32,v36
v_permlane16_swap_b32 v33,v37
v_permlane16_swap_b32 v34,v38
v_permlane16_swap_b32 v35,v39
s_nop 1
v_add_f32 v32,v32,v36
v_add_f32 v33,v33,v37
v_add_f32 v34,v34,v38
v_add_f32 v35,v35,v39
s_mov_b32 s72,0x3ae38e39
s_mov_b32 s73,0x7f800000
s_mov_b32 s74,0x007fffff
v_mul_f32 v32,s72,v32
v_mul_f32 v34,s72,v34
v_fma_f32 v34,-v32,v32,v34
v_max_f32 v34,0,v34
v_add_f32 v34,0x3727c5ac,v34
v_rsq_f32 v34,v34
s_nop 0
v_and_b32 v42,s73,v34
v_lshrrev_b32 v40,16,v42
v_and_b32 v46,s74,v34
v_or_b32 v46,1.0,v46
v_mul_f32 v44,v32,v42
v_sub_f32 v44,0,v44
v_mul_f32 v224,0x3eae1a93,v46
v_mov_b32 v7,v46
v_mul_f32 v33,s72,v33
v_mul_f32 v35,s72,v35
v_fma_f32 v35,-v33,v33,v35
v_max_f32 v35,0,v35
v_add_f32 v35,0x3727c5ac,v35
v_rsq_f32 v35,v35
s_nop 0
v_and_b32 v43,s73,v35
v_lshrrev_b32 v41,16,v43
v_and_b32 v47,s74,v35
v_or_b32 v47,1.0,v47
v_mul_f32 v45,v33,v43
v_sub_f32 v45,0,v45
v_mul_f32 v225,0x3eae1a93,v47
v_mov_b32 v8,v47
v_lshrrev_b32 v48,4,v252
v_lshlrev_b32 v48,4,v48
v_add_u32 v49,0,v48
v_add_u32 v50,4,v48
v_add_u32 v51,8,v48
v_add_u32 v52,12,v48
ds_bpermute_b32 v226,v49,v46
ds_bpermute_b32 v227,v50,v46
ds_bpermute_b32 v228,v51,v46
ds_bpermute_b32 v229,v52,v46
ds_bpermute_b32 v230,v49,v47
ds_bpermute_b32 v231,v50,v47
ds_bpermute_b32 v232,v51,v47
ds_bpermute_b32 v233,v52,v47
s_add_u32 m0,s90,29696
s_nop 0
buffer_load_dwordx4 v65,s[24:27],s7 offen lds
v_dot2_f32_bf16 v56,v80,v40,v44
v_dot2_f32_bf16 v57,v80,v42,v44
v_dot2_f32_bf16 v58,v81,v40,v44
v_dot2_f32_bf16 v59,v81,v42,v44
v_dot2_f32_bf16 v60,v82,v40,v44
v_dot2_f32_bf16 v61,v82,v42,v44
v_dot2_f32_bf16 v62,v83,v40,v44
v_dot2_f32_bf16 v63,v83,v42,v44
CV v80,v56,v57
CV v81,v58,v59
CV v82,v60,v61
CV v83,v62,v63
v_dot2_f32_bf16 v56,v84,v41,v45
v_dot2_f32_bf16 v57,v84,v43,v45
v_dot2_f32_bf16 v58,v85,v41,v45
v_dot2_f32_bf16 v59,v85,v43,v45
v_dot2_f32_bf16 v60,v86,v41,v45
v_dot2_f32_bf16 v61,v86,v43,v45
v_dot2_f32_bf16 v62,v87,v41,v45
v_dot2_f32_bf16 v63,v87,v43,v45
CV v84,v56,v57
CV v85,v58,v59
CV v86,v60,v61
CV v87,v62,v63
v_dot2_f32_bf16 v56,v88,v40,v44
v_dot2_f32_bf16 v57,v88,v42,v44
v_dot2_f32_bf16 v58,v89,v40,v44
v_dot2_f32_bf16 v59,v89,v42,v44
v_dot2_f32_bf16 v60,v90,v40,v44
v_dot2_f32_bf16 v61,v90,v42,v44
v_dot2_f32_bf16 v62,v91,v40,v44
v_dot2_f32_bf16 v63,v91,v42,v44
CV v88,v56,v57
CV v89,v58,v59
CV v90,v60,v61
CV v91,v62,v63
v_dot2_f32_bf16 v56,v92,v41,v45
v_dot2_f32_bf16 v57,v92,v43,v45
v_dot2_f32_bf16 v58,v93,v41,v45
v_dot2_f32_bf16 v59,v93,v43,v45
v_dot2_f32_bf16 v60,v94,v41,v45
v_dot2_f32_bf16 v61,v94,v43,v45
v_dot2_f32_bf16 v62,v95,v41,v45
v_dot2_f32_bf16 v63,v95,v43,v45
CV v92,v56,v57
CV v93,v58,v59
CV v94,v60,v61
CV v95,v62,v63
s_add_u32 m0,s90,30720
s_nop 0
buffer_load_dwordx4 v66,s[24:27],s7 offen lds
v_dot2_f32_bf16 v56,v96,v40,v44
v_dot2_f32_bf16 v57,v96,v42,v44
v_dot2_f32_bf16 v58,v97,v40,v44
v_dot2_f32_bf16 v59,v97,v42,v44
v_dot2_f32_bf16 v60,v98,v40,v44
v_dot2_f32_bf16 v61,v98,v42,v44
v_dot2_f32_bf16 v62,v99,v40,v44
v_dot2_f32_bf16 v63,v99,v42,v44
CV v96,v56,v57
CV v97,v58,v59
CV v98,v60,v61
CV v99,v62,v63
v_dot2_f32_bf16 v56,v100,v41,v45
v_dot2_f32_bf16 v57,v100,v43,v45
v_dot2_f32_bf16 v58,v101,v41,v45
v_dot2_f32_bf16 v59,v101,v43,v45
v_dot2_f32_bf16 v60,v102,v41,v45
v_dot2_f32_bf16 v61,v102,v43,v45
v_dot2_f32_bf16 v62,v103,v41,v45
v_dot2_f32_bf16 v63,v103,v43,v45
CV v100,v56,v57
CV v101,v58,v59
CV v102,v60,v61
CV v103,v62,v63
v_dot2_f32_bf16 v56,v104,v40,v44
v_dot2_f32_bf16 v57,v104,v42,v44
v_dot2_f32_bf16 v58,v105,v40,v44
v_dot2_f32_bf16 v59,v105,v42,v44
v_dot2_f32_bf16 v60,v106,v40,v44
v_dot2_f32_bf16 v61,v106,v42,v44
v_dot2_f32_bf16 v62,v107,v40,v44
v_dot2_f32_bf16 v63,v107,v42,v44
CV v104,v56,v57
CV v105,v58,v59
CV v106,v60,v61
CV v107,v62,v63
v_dot2_f32_bf16 v56,v108,v41,v45
v_dot2_f32_bf16 v57,v108,v43,v45
v_dot2_f32_bf16 v58,v109,v41,v45
v_dot2_f32_bf16 v59,v109,v43,v45
v_dot2_f32_bf16 v60,v110,v41,v45
v_dot2_f32_bf16 v61,v110,v43,v45
v_dot2_f32_bf16 v62,v111,v41,v45
v_dot2_f32_bf16 v63,v111,v43,v45
CV v108,v56,v57
CV v109,v58,v59
CV v110,v60,v61
CV v111,v62,v63
s_add_u32 m0,s90,31744
s_nop 0
buffer_load_dwordx4 v67,s[24:27],s7 offen lds
v_dot2_f32_bf16 v56,v112,v40,v44
v_dot2_f32_bf16 v57,v112,v42,v44
v_dot2_f32_bf16 v58,v113,v40,v44
v_dot2_f32_bf16 v59,v113,v42,v44
v_dot2_f32_bf16 v60,v114,v40,v44
v_dot2_f32_bf16 v61,v114,v42,v44
v_dot2_f32_bf16 v62,v115,v40,v44
v_dot2_f32_bf16 v63,v115,v42,v44
CV v112,v56,v57
CV v113,v58,v59
CV v114,v60,v61
CV v115,v62,v63
v_dot2_f32_bf16 v56,v116,v41,v45
v_dot2_f32_bf16 v57,v116,v43,v45
v_dot2_f32_bf16 v58,v117,v41,v45
v_dot2_f32_bf16 v59,v117,v43,v45
v_dot2_f32_bf16 v60,v118,v41,v45
v_dot2_f32_bf16 v61,v118,v43,v45
v_dot2_f32_bf16 v62,v119,v41,v45
v_dot2_f32_bf16 v63,v119,v43,v45
CV v116,v56,v57
CV v117,v58,v59
CV v118,v60,v61
CV v119,v62,v63
v_dot2_f32_bf16 v56,v120,v40,v44
v_dot2_f32_bf16 v57,v120,v42,v44
v_dot2_f32_bf16 v58,v121,v40,v44
v_dot2_f32_bf16 v59,v121,v42,v44
v_dot2_f32_bf16 v60,v122,v40,v44
v_dot2_f32_bf16 v61,v122,v42,v44
v_dot2_f32_bf16 v62,v123,v40,v44
v_dot2_f32_bf16 v63,v123,v42,v44
CV v120,v56,v57
CV v121,v58,v59
CV v122,v60,v61
CV v123,v62,v63
v_dot2_f32_bf16 v56,v124,v41,v45
v_dot2_f32_bf16 v57,v124,v43,v45
v_dot2_f32_bf16 v58,v125,v41,v45
v_dot2_f32_bf16 v59,v125,v43,v45
v_dot2_f32_bf16 v60,v126,v41,v45
v_dot2_f32_bf16 v61,v126,v43,v45
v_dot2_f32_bf16 v62,v127,v41,v45
v_dot2_f32_bf16 v63,v127,v43,v45
CV v124,v56,v57
CV v125,v58,v59
CV v126,v60,v61
CV v127,v62,v63
s_add_u32 m0,s90,32768
s_nop 0
buffer_load_dwordx4 v68,s[24:27],s7 offen lds
v_dot2_f32_bf16 v56,v128,v40,v44
v_dot2_f32_bf16 v57,v128,v42,v44
v_dot2_f32_bf16 v58,v129,v40,v44
v_dot2_f32_bf16 v59,v129,v42,v44
v_dot2_f32_bf16 v60,v130,v40,v44
v_dot2_f32_bf16 v61,v130,v42,v44
v_dot2_f32_bf16 v62,v131,v40,v44
v_dot2_f32_bf16 v63,v131,v42,v44
CV v128,v56,v57
CV v129,v58,v59
CV v130,v60,v61
CV v131,v62,v63
v_dot2_f32_bf16 v56,v132,v41,v45
v_dot2_f32_bf16 v57,v132,v43,v45
v_dot2_f32_bf16 v58,v133,v41,v45
v_dot2_f32_bf16 v59,v133,v43,v45
v_dot2_f32_bf16 v60,v134,v41,v45
v_dot2_f32_bf16 v61,v134,v43,v45
v_dot2_f32_bf16 v62,v135,v41,v45
v_dot2_f32_bf16 v63,v135,v43,v45
CV v132,v56,v57
CV v133,v58,v59
CV v134,v60,v61
CV v135,v62,v63
v_dot2_f32_bf16 v56,v136,v40,v44
v_dot2_f32_bf16 v57,v136,v42,v44
v_dot2_f32_bf16 v58,v137,v40,v44
v_dot2_f32_bf16 v59,v137,v42,v44
v_dot2_f32_bf16 v60,v138,v40,v44
v_dot2_f32_bf16 v61,v138,v42,v44
v_dot2_f32_bf16 v62,v139,v40,v44
v_dot2_f32_bf16 v63,v139,v42,v44
CV v136,v56,v57
CV v137,v58,v59
CV v138,v60,v61
CV v139,v62,v63
v_dot2_f32_bf16 v56,v140,v41,v45
v_dot2_f32_bf16 v57,v140,v43,v45
v_dot2_f32_bf16 v58,v141,v41,v45
v_dot2_f32_bf16 v59,v141,v43,v45
v_dot2_f32_bf16 v60,v142,v41,v45
v_dot2_f32_bf16 v61,v142,v43,v45
v_dot2_f32_bf16 v62,v143,v41,v45
v_dot2_f32_bf16 v63,v143,v43,v45
CV v140,v56,v57
CV v141,v58,v59
CV v142,v60,v61
CV v143,v62,v63
s_add_u32 m0,s90,33792
s_nop 0
buffer_load_dwordx4 v69,s[24:27],s7 offen lds
v_dot2_f32_bf16 v56,v144,v40,v44
v_dot2_f32_bf16 v57,v144,v42,v44
v_dot2_f32_bf16 v58,v145,v40,v44
v_dot2_f32_bf16 v59,v145,v42,v44
v_dot2_f32_bf16 v60,v146,v40,v44
v_dot2_f32_bf16 v61,v146,v42,v44
v_dot2_f32_bf16 v62,v147,v40,v44
v_dot2_f32_bf16 v63,v147,v42,v44
CV v144,v56,v57
CV v145,v58,v59
CV v146,v60,v61
CV v147,v62,v63
v_dot2_f32_bf16 v56,v148,v41,v45
v_dot2_f32_bf16 v57,v148,v43,v45
v_dot2_f32_bf16 v58,v149,v41,v45
v_dot2_f32_bf16 v59,v149,v43,v45
v_dot2_f32_bf16 v60,v150,v41,v45
v_dot2_f32_bf16 v61,v150,v43,v45
v_dot2_f32_bf16 v62,v151,v41,v45
v_dot2_f32_bf16 v63,v151,v43,v45
CV v148,v56,v57
CV v149,v58,v59
CV v150,v60,v61
CV v151,v62,v63
v_dot2_f32_bf16 v56,v152,v40,v44
v_dot2_f32_bf16 v57,v152,v42,v44
v_dot2_f32_bf16 v58,v153,v40,v44
v_dot2_f32_bf16 v59,v153,v42,v44
v_dot2_f32_bf16 v60,v154,v40,v44
v_dot2_f32_bf16 v61,v154,v42,v44
v_dot2_f32_bf16 v62,v155,v40,v44
v_dot2_f32_bf16 v63,v155,v42,v44
CV v152,v56,v57
CV v153,v58,v59
CV v154,v60,v61
CV v155,v62,v63
v_dot2_f32_bf16 v56,v156,v41,v45
v_dot2_f32_bf16 v57,v156,v43,v45
v_dot2_f32_bf16 v58,v157,v41,v45
v_dot2_f32_bf16 v59,v157,v43,v45
v_dot2_f32_bf16 v60,v158,v41,v45
v_dot2_f32_bf16 v61,v158,v43,v45
v_dot2_f32_bf16 v62,v159,v41,v45
v_dot2_f32_bf16 v63,v159,v43,v45
CV v156,v56,v57
CV v157,v58,v59
CV v158,v60,v61
CV v159,v62,v63
s_add_u32 m0,s90,34816
s_nop 0
buffer_load_dwordx4 v70,s[24:27],s7 offen lds
v_dot2_f32_bf16 v56,v160,v40,v44
v_dot2_f32_bf16 v57,v160,v42,v44
v_dot2_f32_bf16 v58,v161,v40,v44
v_dot2_f32_bf16 v59,v161,v42,v44
v_dot2_f32_bf16 v60,v162,v40,v44
v_dot2_f32_bf16 v61,v162,v42,v44
v_dot2_f32_bf16 v62,v163,v40,v44
v_dot2_f32_bf16 v63,v163,v42,v44
CV v160,v56,v57
CV v161,v58,v59
CV v162,v60,v61
CV v163,v62,v63
v_dot2_f32_bf16 v56,v164,v41,v45
v_dot2_f32_bf16 v57,v164,v43,v45
v_dot2_f32_bf16 v58,v165,v41,v45
v_dot2_f32_bf16 v59,v165,v43,v45
v_dot2_f32_bf16 v60,v166,v41,v45
v_dot2_f32_bf16 v61,v166,v43,v45
v_dot2_f32_bf16 v62,v167,v41,v45
v_dot2_f32_bf16 v63,v167,v43,v45
CV v164,v56,v57
CV v165,v58,v59
CV v166,v60,v61
CV v167,v62,v63
v_dot2_f32_bf16 v56,v168,v40,v44
v_dot2_f32_bf16 v57,v168,v42,v44
v_dot2_f32_bf16 v58,v169,v40,v44
v_dot2_f32_bf16 v59,v169,v42,v44
v_dot2_f32_bf16 v60,v170,v40,v44
v_dot2_f32_bf16 v61,v170,v42,v44
v_dot2_f32_bf16 v62,v171,v40,v44
v_dot2_f32_bf16 v63,v171,v42,v44
CV v168,v56,v57
CV v169,v58,v59
CV v170,v60,v61
CV v171,v62,v63
v_dot2_f32_bf16 v56,v172,v41,v45
v_dot2_f32_bf16 v57,v172,v43,v45
v_dot2_f32_bf16 v58,v173,v41,v45
v_dot2_f32_bf16 v59,v173,v43,v45
v_dot2_f32_bf16 v60,v174,v41,v45
v_dot2_f32_bf16 v61,v174,v43,v45
v_dot2_f32_bf16 v62,v175,v41,v45
v_dot2_f32_bf16 v63,v175,v43,v45
CV v172,v56,v57
CV v173,v58,v59
CV v174,v60,v61
CV v175,v62,v63
v_dot2_f32_bf16 v56,v176,v40,v44
v_dot2_f32_bf16 v57,v176,v42,v44
v_dot2_f32_bf16 v58,v177,v40,v44
v_dot2_f32_bf16 v59,v177,v42,v44
v_dot2_f32_bf16 v60,v178,v40,v44
v_dot2_f32_bf16 v61,v178,v42,v44
v_dot2_f32_bf16 v62,v179,v40,v44
v_dot2_f32_bf16 v63,v179,v42,v44
CV v176,v56,v57
CV v177,v58,v59
CV v178,v60,v61
CV v179,v62,v63
v_dot2_f32_bf16 v56,v180,v41,v45
v_dot2_f32_bf16 v57,v180,v43,v45
v_dot2_f32_bf16 v58,v181,v41,v45
v_dot2_f32_bf16 v59,v181,v43,v45
v_dot2_f32_bf16 v60,v182,v41,v45
v_dot2_f32_bf16 v61,v182,v43,v45
v_dot2_f32_bf16 v62,v183,v41,v45
v_dot2_f32_bf16 v63,v183,v43,v45
CV v180,v56,v57
CV v181,v58,v59
CV v182,v60,v61
CV v183,v62,v63
v_dot2_f32_bf16 v56,v184,v40,v44
v_dot2_f32_bf16 v57,v184,v42,v44
v_dot2_f32_bf16 v58,v185,v40,v44
v_dot2_f32_bf16 v59,v185,v42,v44
v_dot2_f32_bf16 v60,v186,v40,v44
v_dot2_f32_bf16 v61,v186,v42,v44
v_dot2_f32_bf16 v62,v187,v40,v44
v_dot2_f32_bf16 v63,v187,v42,v44
CV v184,v56,v57
CV v185,v58,v59
CV v186,v60,v61
CV v187,v62,v63
v_dot2_f32_bf16 v56,v188,v41,v45
v_dot2_f32_bf16 v57,v188,v43,v45
v_dot2_f32_bf16 v58,v189,v41,v45
v_dot2_f32_bf16 v59,v189,v43,v45
v_dot2_f32_bf16 v60,v190,v41,v45
v_dot2_f32_bf16 v61,v190,v43,v45
v_dot2_f32_bf16 v62,v191,v41,v45
v_dot2_f32_bf16 v63,v191,v43,v45
CV v188,v56,v57
CV v189,v58,v59
CV v190,v60,v61
CV v191,v62,v63
v_dot2_f32_bf16 v56,v192,v40,v44
v_dot2_f32_bf16 v57,v192,v42,v44
v_dot2_f32_bf16 v58,v193,v40,v44
v_dot2_f32_bf16 v59,v193,v42,v44
v_dot2_f32_bf16 v60,v194,v40,v44
v_dot2_f32_bf16 v61,v194,v42,v44
v_dot2_f32_bf16 v62,v195,v40,v44
v_dot2_f32_bf16 v63,v195,v42,v44
CV v192,v56,v57
CV v193,v58,v59
CV v194,v60,v61
CV v195,v62,v63
v_dot2_f32_bf16 v56,v196,v41,v45
v_dot2_f32_bf16 v57,v196,v43,v45
v_dot2_f32_bf16 v58,v197,v41,v45
v_dot2_f32_bf16 v59,v197,v43,v45
v_dot2_f32_bf16 v60,v198,v41,v45
v_dot2_f32_bf16 v61,v198,v43,v45
v_dot2_f32_bf16 v62,v199,v41,v45
v_dot2_f32_bf16 v63,v199,v43,v45
CV v196,v56,v57
CV v197,v58,v59
CV v198,v60,v61
CV v199,v62,v63
v_dot2_f32_bf16 v56,v200,v40,v44
v_dot2_f32_bf16 v57,v200,v42,v44
v_dot2_f32_bf16 v58,v201,v40,v44
v_dot2_f32_bf16 v59,v201,v42,v44
v_dot2_f32_bf16 v60,v202,v40,v44
v_dot2_f32_bf16 v61,v202,v42,v44
v_dot2_f32_bf16 v62,v203,v40,v44
v_dot2_f32_bf16 v63,v203,v42,v44
CV v200,v56,v57
CV v201,v58,v59
CV v202,v60,v61
CV v203,v62,v63
v_dot2_f32_bf16 v56,v204,v41,v45
v_dot2_f32_bf16 v57,v204,v43,v45
v_dot2_f32_bf16 v58,v205,v41,v45
v_dot2_f32_bf16 v59,v205,v43,v45
v_dot2_f32_bf16 v60,v206,v41,v45
v_dot2_f32_bf16 v61,v206,v43,v45
v_dot2_f32_bf16 v62,v207,v41,v45
v_dot2_f32_bf16 v63,v207,v43,v45
CV v204,v56,v57
CV v205,v58,v59
CV v206,v60,v61
CV v207,v62,v63
v_dot2_f32_bf16 v56,v208,v40,v44
v_dot2_f32_bf16 v57,v208,v42,v44
v_dot2_f32_bf16 v58,v209,v40,v44
v_dot2_f32_bf16 v59,v209,v42,v44
v_dot2_f32_bf16 v60,v210,v40,v44
v_dot2_f32_bf16 v61,v210,v42,v44
v_dot2_f32_bf16 v62,v211,v40,v44
v_dot2_f32_bf16 v63,v211,v42,v44
CV v208,v56,v57
CV v209,v58,v59
CV v210,v60,v61
CV v211,v62,v63
v_dot2_f32_bf16 v56,v212,v41,v45
v_dot2_f32_bf16 v57,v212,v43,v45
v_dot2_f32_bf16 v58,v213,v41,v45
v_dot2_f32_bf16 v59,v213,v43,v45
v_dot2_f32_bf16 v60,v214,v41,v45
v_dot2_f32_bf16 v61,v214,v43,v45
v_dot2_f32_bf16 v62,v215,v41,v45
v_dot2_f32_bf16 v63,v215,v43,v45
CV v212,v56,v57
CV v213,v58,v59
CV v214,v60,v61
CV v215,v62,v63
v_dot2_f32_bf16 v56,v216,v40,v44
v_dot2_f32_bf16 v57,v216,v42,v44
v_dot2_f32_bf16 v58,v217,v40,v44
v_dot2_f32_bf16 v59,v217,v42,v44
v_dot2_f32_bf16 v60,v218,v40,v44
v_dot2_f32_bf16 v61,v218,v42,v44
v_dot2_f32_bf16 v62,v219,v40,v44
v_dot2_f32_bf16 v63,v219,v42,v44
CV v216,v56,v57
CV v217,v58,v59
CV v218,v60,v61
CV v219,v62,v63
v_dot2_f32_bf16 v56,v220,v41,v45
v_dot2_f32_bf16 v57,v220,v43,v45
v_dot2_f32_bf16 v58,v221,v41,v45
v_dot2_f32_bf16 v59,v221,v43,v45
v_dot2_f32_bf16 v60,v222,v41,v45
v_dot2_f32_bf16 v61,v222,v43,v45
v_dot2_f32_bf16 v62,v223,v41,v45
v_dot2_f32_bf16 v63,v223,v43,v45
CV v220,v56,v57
CV v221,v58,v59
CV v222,v60,v61
CV v223,v62,v63
WL 0
s_bitcmp1_b32 s3,0
s_cselect_b64 vcc,-1,0
v_cndmask_b32 v36,v0,v3,vcc
v_cndmask_b32 v37,v1,v4,vcc
v_cndmask_b32 v38,v2,v5,vcc
v_cndmask_b32 v39,v3,v6,vcc
s_waitcnt vmcnt(7)
s_barrier
RT v[12:13],v72,0
RT v[14:15],v72,1792
RT v[16:17],v72,40
RT v[18:19],v72,1832
RT v[20:21],v72,72
RT v[22:23],v72,1864
RT v[24:25],v72,112
RT v[26:27],v72,1904
RT v[28:29],v73,0
RT v[30:31],v73,1792
WL 6
MA a[0:3],v[12:15],v[80:83],0
RT v[32:33],v72,144
MA a[4:7],v[12:15],v[84:87],0
RT v[34:35],v72,1936
MA a[8:11],v[16:19],v[80:83],0
RT v[12:13],v72,176
MA a[12:15],v[16:19],v[84:87],0
RT v[14:15],v72,1968
WL 6
MA a[16:19],v[20:23],v[80:83],0
RT v[16:17],v72,208
s_add_u32 m0,s90,57344
s_nop 0
MA a[20:23],v[20:23],v[84:87],0
RT v[18:19],v72,2000
buffer_load_dwordx4 v64,s[24:27],s8 offen lds
MA a[24:27],v[24:27],v[80:83],0
RT v[20:21],v72,7168
MA a[28:31],v[24:27],v[84:87],0
RT v[22:23],v72,8960
WL 6
MA a[32:35],v[28:31],v[80:83],0
RT v[24:25],v72,7208
MA a[36:39],v[28:31],v[84:87],0
RT v[26:27],v72,9000
MA a[40:43],v[80:83],v[32:35],0
RT v[28:29],v72,7240
MA a[44:47],v[84:87],v[32:35],0
RT v[30:31],v72,9032
WL 6
MA a[48:51],v[80:83],v[12:15],0
RT v[32:33],v72,7280
s_add_u32 m0,s90,58368
s_nop 0
MA a[52:55],v[84:87],v[12:15],0
RT v[34:35],v72,9072
buffer_load_dwordx4 v65,s[24:27],s8 offen lds
MA a[56:59],v[80:83],v[16:19],0
RT v[12:13],v73,7168
MA a[60:63],v[84:87],v[16:19],0
RT v[14:15],v73,8960
WL 6
MA a[0:3],v[20:23],v[88:91],a[0:3]
RT v[16:17],v72,7312
MA a[4:7],v[20:23],v[92:95],a[4:7]
RT v[18:19],v72,9104
MA a[8:11],v[24:27],v[88:91],a[8:11]
RT v[20:21],v72,7344
MA a[12:15],v[24:27],v[92:95],a[12:15]
RT v[22:23],v72,9136
WL 6
MA a[16:19],v[28:31],v[88:91],a[16:19]
RT v[24:25],v72,7376
s_add_u32 m0,s90,59392
s_nop 0
MA a[20:23],v[28:31],v[92:95],a[20:23]
RT v[26:27],v72,9168
buffer_load_dwordx4 v66,s[24:27],s8 offen lds
MA a[24:27],v[32:35],v[88:91],a[24:27]
RT v[28:29],v72,14336
MA a[28:31],v[32:35],v[92:95],a[28:31]
RT v[30:31],v72,16128
WL 6
MA a[32:35],v[12:15],v[88:91],a[32:35]
RT v[32:33],v72,14376
MA a[36:39],v[12:15],v[92:95],a[36:39]
RT v[34:35],v72,16168
MA a[40:43],v[88:91],v[16:19],a[40:43]
RT v[12:13],v72,14408
MA a[44:47],v[92:95],v[16:19],a[44:47]
RT v[14:15],v72,16200
WL 6
MA a[48:51],v[88:91],v[20:23],a[48:51]
RT v[16:17],v72,14448
s_add_u32 m0,s90,60416
s_nop 0
MA a[52:55],v[92:95],v[20:23],a[52:55]
RT v[18:19],v72,16240
buffer_load_dwordx4 v67,s[24:27],s8 offen lds
MA a[56:59],v[88:91],v[24:27],a[56:59]
RT v[20:21],v73,14336
MA a[60:63],v[92:95],v[24:27],a[60:63]
RT v[22:23],v73,16128
WL 6
MA a[0:3],v[28:31],v[96:99],a[0:3]
RT v[24:25],v72,14480
MA a[4:7],v[28:31],v[100:103],a[4:7]
RT v[26:27],v72,16272
MA a[8:11],v[32:35],v[96:99],a[8:11]
RT v[28:29],v72,14512
MA a[12:15],v[32:35],v[100:103],a[12:15]
RT v[30:31],v72,16304
WL 6
MA a[16:19],v[12:15],v[96:99],a[16:19]
RT v[32:33],v72,14544
s_add_u32 m0,s90,61440
s_nop 0
MA a[20:23],v[12:15],v[100:103],a[20:23]
RT v[34:35],v72,16336
buffer_load_dwordx4 v68,s[24:27],s8 offen lds
MA a[24:27],v[16:19],v[96:99],a[24:27]
RT v[12:13],v72,21504
MA a[28:31],v[16:19],v[100:103],a[28:31]
RT v[14:15],v72,23296
WL 6
MA a[32:35],v[20:23],v[96:99],a[32:35]
RT v[16:17],v72,21544
MA a[36:39],v[20:23],v[100:103],a[36:39]
RT v[18:19],v72,23336
MA a[40:43],v[96:99],v[24:27],a[40:43]
RT v[20:21],v72,21576
MA a[44:47],v[100:103],v[24:27],a[44:47]
RT v[22:23],v72,23368
WL 6
MA a[48:51],v[96:99],v[28:31],a[48:51]
RT v[24:25],v72,21616
s_add_u32 m0,s90,62464
s_nop 0
MA a[52:55],v[100:103],v[28:31],a[52:55]
RT v[26:27],v72,23408
buffer_load_dwordx4 v69,s[24:27],s8 offen lds
MA a[56:59],v[96:99],v[32:35],a[56:59]
RT v[28:29],v73,21504
MA a[60:63],v[100:103],v[32:35],a[60:63]
RT v[30:31],v73,23296
WL 6
MA a[0:3],v[12:15],v[104:107],a[0:3]
RT v[32:33],v72,21648
MA a[4:7],v[12:15],v[108:111],a[4:7]
RT v[34:35],v72,23440
MA a[8:11],v[16:19],v[104:107],a[8:11]
RT v[12:13],v72,21680
MA a[12:15],v[16:19],v[108:111],a[12:15]
RT v[14:15],v72,23472
WL 6
MA a[16:19],v[20:23],v[104:107],a[16:19]
RT v[16:17],v72,21712
s_add_u32 m0,s90,63488
s_nop 0
MA a[20:23],v[20:23],v[108:111],a[20:23]
RT v[18:19],v72,23504
buffer_load_dwordx4 v70,s[24:27],s8 offen lds
MA a[24:27],v[24:27],v[104:107],a[24:27]
s_waitcnt vmcnt(7)
s_barrier
RT v[20:21],v72,28672
MA a[28:31],v[24:27],v[108:111],a[28:31]
RT v[22:23],v72,30464
WL 6
MA a[32:35],v[28:31],v[104:107],a[32:35]
RT v[24:25],v72,28712
MA a[36:39],v[28:31],v[108:111],a[36:39]
RT v[26:27],v72,30504
MA a[40:43],v[104:107],v[32:35],a[40:43]
RT v[28:29],v72,28744
s_add_u32 m0,s90,86016
s_nop 0
MA a[44:47],v[108:111],v[32:35],a[44:47]
RT v[30:31],v72,30536
buffer_load_dwordx4 v64,s[24:27],s9 offen lds
WL 6
MA a[48:51],v[104:107],v[12:15],a[48:51]
RT v[32:33],v72,28784
MA a[52:55],v[108:111],v[12:15],a[52:55]
RT v[34:35],v72,30576
MA a[56:59],v[104:107],v[16:19],a[56:59]
RT v[12:13],v73,28672
MA a[60:63],v[108:111],v[16:19],a[60:63]
RT v[14:15],v73,30464
WL 6
MA a[0:3],v[20:23],v[112:115],a[0:3]
RT v[16:17],v72,28816
MA a[4:7],v[20:23],v[116:119],a[4:7]
RT v[18:19],v72,30608
MA a[8:11],v[24:27],v[112:115],a[8:11]
RT v[20:21],v72,28848
s_add_u32 m0,s90,87040
s_nop 0
MA a[12:15],v[24:27],v[116:119],a[12:15]
RT v[22:23],v72,30640
buffer_load_dwordx4 v65,s[24:27],s9 offen lds
WL 6
MA a[16:19],v[28:31],v[112:115],a[16:19]
RT v[24:25],v72,28880
MA a[20:23],v[28:31],v[116:119],a[20:23]
RT v[26:27],v72,30672
MA a[24:27],v[32:35],v[112:115],a[24:27]
RT v[28:29],v72,35840
MA a[28:31],v[32:35],v[116:119],a[28:31]
RT v[30:31],v72,37632
WL 6
MA a[32:35],v[12:15],v[112:115],a[32:35]
RT v[32:33],v72,35880
MA a[36:39],v[12:15],v[116:119],a[36:39]
RT v[34:35],v72,37672
MA a[40:43],v[112:115],v[16:19],a[40:43]
RT v[12:13],v72,35912
s_add_u32 m0,s90,88064
s_nop 0
MA a[44:47],v[116:119],v[16:19],a[44:47]
RT v[14:15],v72,37704
buffer_load_dwordx4 v66,s[24:27],s9 offen lds
WL 6
MA a[48:51],v[112:115],v[20:23],a[48:51]
RT v[16:17],v72,35952
MA a[52:55],v[116:119],v[20:23],a[52:55]
RT v[18:19],v72,37744
MA a[56:59],v[112:115],v[24:27],a[56:59]
RT v[20:21],v73,35840
MA a[60:63],v[116:119],v[24:27],a[60:63]
RT v[22:23],v73,37632
WL 6
MA a[0:3],v[28:31],v[120:123],a[0:3]
RT v[24:25],v72,35984
MA a[4:7],v[28:31],v[124:127],a[4:7]
RT v[26:27],v72,37776
MA a[8:11],v[32:35],v[120:123],a[8:11]
RT v[28:29],v72,36016
s_add_u32 m0,s90,89088
s_nop 0
MA a[12:15],v[32:35],v[124:127],a[12:15]
RT v[30:31],v72,37808
buffer_load_dwordx4 v67,s[24:27],s9 offen lds
WL 6
MA a[16:19],v[12:15],v[120:123],a[16:19]
RT v[32:33],v72,36048
MA a[20:23],v[12:15],v[124:127],a[20:23]
RT v[34:35],v72,37840
MA a[24:27],v[16:19],v[120:123],a[24:27]
RT v[12:13],v72,43008
MA a[28:31],v[16:19],v[124:127],a[28:31]
RT v[14:15],v72,44800
WL 6
MA a[32:35],v[20:23],v[120:123],a[32:35]
RT v[16:17],v72,43048
MA a[36:39],v[20:23],v[124:127],a[36:39]
RT v[18:19],v72,44840
MA a[40:43],v[120:123],v[24:27],a[40:43]
RT v[20:21],v72,43080
s_add_u32 m0,s90,90112
s_nop 0
MA a[44:47],v[124:127],v[24:27],a[44:47]
RT v[22:23],v72,44872
buffer_load_dwordx4 v68,s[24:27],s9 offen lds
WL 6
MA a[48:51],v[120:123],v[28:31],a[48:51]
RT v[24:25],v72,43120
MA a[52:55],v[124:127],v[28:31],a[52:55]
RT v[26:27],v72,44912
MA a[56:59],v[120:123],v[32:35],a[56:59]
RT v[28:29],v73,43008
MA a[60:63],v[124:127],v[32:35],a[60:63]
RT v[30:31],v73,44800
WL 6
MA a[0:3],v[12:15],v[128:131],a[0:3]
RT v[32:33],v72,43152
MA a[4:7],v[12:15],v[132:135],a[4:7]
RT v[34:35],v72,44944
MA a[8:11],v[16:19],v[128:131],a[8:11]
RT v[12:13],v72,43184
s_add_u32 m0,s90,91136
s_nop 0
MA a[12:15],v[16:19],v[132:135],a[12:15]
RT v[14:15],v72,44976
buffer_load_dwordx4 v69,s[24:27],s9 offen lds
WL 6
MA a[16:19],v[20:23],v[128:131],a[16:19]
RT v[16:17],v72,43216
MA a[20:23],v[20:23],v[132:135],a[20:23]
RT v[18:19],v72,45008
MA a[24:27],v[24:27],v[128:131],a[24:27]
RT v[20:21],v72,50176
MA a[28:31],v[24:27],v[132:135],a[28:31]
RT v[22:23],v72,51968
WL 6
MA a[32:35],v[28:31],v[128:131],a[32:35]
RT v[24:25],v72,50216
MA a[36:39],v[28:31],v[132:135],a[36:39]
RT v[26:27],v72,52008
MA a[40:43],v[128:131],v[32:35],a[40:43]
RT v[28:29],v72,50248
s_add_u32 m0,s90,92160
s_nop 0
MA a[44:47],v[132:135],v[32:35],a[44:47]
RT v[30:31],v72,52040
buffer_load_dwordx4 v70,s[24:27],s9 offen lds
WL 6
MA a[48:51],v[128:131],v[12:15],a[48:51]
RT v[32:33],v72,50288
MA a[52:55],v[132:135],v[12:15],a[52:55]
RT v[34:35],v72,52080
MA a[56:59],v[128:131],v[16:19],a[56:59]
RT v[12:13],v73,50176
MA a[60:63],v[132:135],v[16:19],a[60:63]
RT v[14:15],v73,51968
WL 6
MA a[0:3],v[20:23],v[136:139],a[0:3]
RT v[16:17],v72,50320
s_add_u32 m0,s11,114688
s_nop 0
MA a[4:7],v[20:23],v[140:143],a[4:7]
RT v[18:19],v72,52112
buffer_load_dwordx4 v74,s[24:27],s10 offen lds
MA a[8:11],v[24:27],v[136:139],a[8:11]
RT v[20:21],v72,50352
MA a[12:15],v[24:27],v[140:143],a[12:15]
RT v[22:23],v72,52144
WL 6
MA a[16:19],v[28:31],v[136:139],a[16:19]
RT v[24:25],v72,50384
MA a[20:23],v[28:31],v[140:143],a[20:23]
RT v[26:27],v72,52176
MA a[24:27],v[32:35],v[136:139],a[24:27]
s_waitcnt vmcnt(8)
s_barrier
RT v[28:29],v72,57344
MA a[28:31],v[32:35],v[140:143],a[28:31]
RT v[30:31],v72,59136
WL 6
MA a[32:35],v[12:15],v[136:139],a[32:35]
RT v[32:33],v72,57384
s_add_u32 m0,s11,115712
s_nop 0
MA a[36:39],v[12:15],v[140:143],a[36:39]
RT v[34:35],v72,59176
buffer_load_dwordx4 v75,s[24:27],s10 offen lds
MA a[40:43],v[136:139],v[16:19],a[40:43]
RT v[12:13],v72,57416
MA a[44:47],v[140:143],v[16:19],a[44:47]
RT v[14:15],v72,59208
WL 6
MA a[48:51],v[136:139],v[20:23],a[48:51]
RT v[16:17],v72,57456
MA a[52:55],v[140:143],v[20:23],a[52:55]
RT v[18:19],v72,59248
MA a[56:59],v[136:139],v[24:27],a[56:59]
RT v[20:21],v73,57344
MA a[60:63],v[140:143],v[24:27],a[60:63]
RT v[22:23],v73,59136
WL 6
MA a[0:3],v[28:31],v[144:147],a[0:3]
RT v[24:25],v72,57488
s_add_u32 m0,s11,116736
s_nop 0
MA a[4:7],v[28:31],v[148:151],a[4:7]
RT v[26:27],v72,59280
buffer_load_dwordx4 v76,s[24:27],s10 offen lds
MA a[8:11],v[32:35],v[144:147],a[8:11]
RT v[28:29],v72,57520
MA a[12:15],v[32:35],v[148:151],a[12:15]
RT v[30:31],v72,59312
WL 6
MA a[16:19],v[12:15],v[144:147],a[16:19]
RT v[32:33],v72,57552
MA a[20:23],v[12:15],v[148:151],a[20:23]
RT v[34:35],v72,59344
MA a[24:27],v[16:19],v[144:147],a[24:27]
v_add_u32 v72,64512,v72
RT v[12:13],v72,0
MA a[28:31],v[16:19],v[148:151],a[28:31]
RT v[14:15],v72,1792
WL 6
MA a[32:35],v[20:23],v[144:147],a[32:35]
RT v[16:17],v72,40
s_add_u32 m0,s11,117760
s_nop 0
MA a[36:39],v[20:23],v[148:151],a[36:39]
RT v[18:19],v72,1832
buffer_load_dwordx4 v77,s[24:27],s10 offen lds
MA a[40:43],v[144:147],v[24:27],a[40:43]
RT v[20:21],v72,72
MA a[44:47],v[148:151],v[24:27],a[44:47]
RT v[22:23],v72,1864
WL 6
MA a[48:51],v[144:147],v[28:31],a[48:51]
RT v[24:25],v72,112
MA a[52:55],v[148:151],v[28:31],a[52:55]
RT v[26:27],v72,1904
MA a[56:59],v[144:147],v[32:35],a[56:59]
v_add_u32 v73,64512,v73
RT v[28:29],v73,0
s_add_u32 m0,s90,0
s_nop 0
MA a[60:63],v[148:151],v[32:35],a[60:63]
RT v[30:31],v73,1792
buffer_load_dwordx4 v0,s[24:27],s6 offen lds
WL 6
MA a[0:3],v[12:15],v[152:155],a[0:3]
RT v[32:33],v72,144
MA a[4:7],v[12:15],v[156:159],a[4:7]
RT v[34:35],v72,1936
MA a[8:11],v[16:19],v[152:155],a[8:11]
RT v[12:13],v72,176
MA a[12:15],v[16:19],v[156:159],a[12:15]
RT v[14:15],v72,1968
WL 6
MA a[16:19],v[20:23],v[152:155],a[16:19]
RT v[16:17],v72,208
MA a[20:23],v[20:23],v[156:159],a[20:23]
RT v[18:19],v72,2000
MA a[24:27],v[24:27],v[152:155],a[24:27]
RT v[20:21],v72,7168
MA a[28:31],v[24:27],v[156:159],a[28:31]
RT v[22:23],v72,8960
WL 6
MA a[32:35],v[28:31],v[152:155],a[32:35]
RT v[24:25],v72,7208
MA a[36:39],v[28:31],v[156:159],a[36:39]
RT v[26:27],v72,9000
MA a[40:43],v[152:155],v[32:35],a[40:43]
RT v[28:29],v72,7240
s_add_u32 m0,s90,1024
s_nop 0
MA a[44:47],v[156:159],v[32:35],a[44:47]
RT v[30:31],v72,9032
buffer_load_dwordx4 v1,s[24:27],s6 offen lds
WL 6
MA a[48:51],v[152:155],v[12:15],a[48:51]
RT v[32:33],v72,7280
MA a[52:55],v[156:159],v[12:15],a[52:55]
RT v[34:35],v72,9072
MA a[56:59],v[152:155],v[16:19],a[56:59]
RT v[12:13],v73,7168
MA a[60:63],v[156:159],v[16:19],a[60:63]
RT v[14:15],v73,8960
WL 6
MA a[0:3],v[20:23],v[160:163],a[0:3]
RT v[16:17],v72,7312
MA a[4:7],v[20:23],v[164:167],a[4:7]
RT v[18:19],v72,9104
MA a[8:11],v[24:27],v[160:163],a[8:11]
RT v[20:21],v72,7344
MA a[12:15],v[24:27],v[164:167],a[12:15]
RT v[22:23],v72,9136
WL 6
MA a[16:19],v[28:31],v[160:163],a[16:19]
RT v[24:25],v72,7376
MA a[20:23],v[28:31],v[164:167],a[20:23]
RT v[26:27],v72,9168
MA a[24:27],v[32:35],v[160:163],a[24:27]
RT v[28:29],v72,14336
s_add_u32 m0,s90,2048
s_nop 0
MA a[28:31],v[32:35],v[164:167],a[28:31]
RT v[30:31],v72,16128
buffer_load_dwordx4 v2,s[24:27],s6 offen lds
WL 6
MA a[32:35],v[12:15],v[160:163],a[32:35]
RT v[32:33],v72,14376
MA a[36:39],v[12:15],v[164:167],a[36:39]
RT v[34:35],v72,16168
MA a[40:43],v[160:163],v[16:19],a[40:43]
RT v[12:13],v72,14408
MA a[44:47],v[164:167],v[16:19],a[44:47]
RT v[14:15],v72,16200
WL 6
MA a[48:51],v[160:163],v[20:23],a[48:51]
RT v[16:17],v72,14448
MA a[52:55],v[164:167],v[20:23],a[52:55]
RT v[18:19],v72,16240
MA a[56:59],v[160:163],v[24:27],a[56:59]
RT v[20:21],v73,14336
MA a[60:63],v[164:167],v[24:27],a[60:63]
RT v[22:23],v73,16128
WL 6
MA a[0:3],v[28:31],v[168:171],a[0:3]
RT v[24:25],v72,14480
MA a[4:7],v[28:31],v[172:175],a[4:7]
RT v[26:27],v72,16272
MA a[8:11],v[32:35],v[168:171],a[8:11]
RT v[28:29],v72,14512
s_add_u32 m0,s90,3072
s_nop 0
MA a[12:15],v[32:35],v[172:175],a[12:15]
RT v[30:31],v72,16304
buffer_load_dwordx4 v3,s[24:27],s6 offen lds
WL 6
MA a[16:19],v[12:15],v[168:171],a[16:19]
RT v[32:33],v72,14544
MA a[20:23],v[12:15],v[172:175],a[20:23]
RT v[34:35],v72,16336
MA a[24:27],v[16:19],v[168:171],a[24:27]
s_waitcnt vmcnt(8)
s_barrier
RT v[12:13],v72,21504
MA a[28:31],v[16:19],v[172:175],a[28:31]
RT v[14:15],v72,23296
WL 6
MA a[32:35],v[20:23],v[168:171],a[32:35]
RT v[16:17],v72,21544
MA a[36:39],v[20:23],v[172:175],a[36:39]
RT v[18:19],v72,23336
MA a[40:43],v[168:171],v[24:27],a[40:43]
RT v[20:21],v72,21576
MA a[44:47],v[172:175],v[24:27],a[44:47]
RT v[22:23],v72,23368
WL 6
MA a[48:51],v[168:171],v[28:31],a[48:51]
RT v[24:25],v72,21616
MA a[52:55],v[172:175],v[28:31],a[52:55]
RT v[26:27],v72,23408
MA a[56:59],v[168:171],v[32:35],a[56:59]
RT v[28:29],v73,21504
s_add_u32 m0,s90,4096
s_nop 0
MA a[60:63],v[172:175],v[32:35],a[60:63]
RT v[30:31],v73,23296
buffer_load_dwordx4 v4,s[24:27],s6 offen lds
WL 6
MA a[0:3],v[12:15],v[176:179],a[0:3]
RT v[32:33],v72,21648
MA a[4:7],v[12:15],v[180:183],a[4:7]
RT v[34:35],v72,23440
MA a[8:11],v[16:19],v[176:179],a[8:11]
RT v[12:13],v72,21680
MA a[12:15],v[16:19],v[180:183],a[12:15]
RT v[14:15],v72,23472
WL 6
MA a[16:19],v[20:23],v[176:179],a[16:19]
RT v[16:17],v72,21712
MA a[20:23],v[20:23],v[180:183],a[20:23]
RT v[18:19],v72,23504
MA a[24:27],v[24:27],v[176:179],a[24:27]
RT v[20:21],v72,28672
MA a[28:31],v[24:27],v[180:183],a[28:31]
RT v[22:23],v72,30464
WL 6
MA a[32:35],v[28:31],v[176:179],a[32:35]
RT v[24:25],v72,28712
MA a[36:39],v[28:31],v[180:183],a[36:39]
RT v[26:27],v72,30504
MA a[40:43],v[176:179],v[32:35],a[40:43]
RT v[28:29],v72,28744
s_add_u32 m0,s90,5120
s_nop 0
MA a[44:47],v[180:183],v[32:35],a[44:47]
RT v[30:31],v72,30536
buffer_load_dwordx4 v5,s[24:27],s6 offen lds
WL 6
MA a[48:51],v[176:179],v[12:15],a[48:51]
RT v[32:33],v72,28784
MA a[52:55],v[180:183],v[12:15],a[52:55]
RT v[34:35],v72,30576
MA a[56:59],v[176:179],v[16:19],a[56:59]
RT v[12:13],v73,28672
MA a[60:63],v[180:183],v[16:19],a[60:63]
RT v[14:15],v73,30464
WL 6
MA a[0:3],v[20:23],v[184:187],a[0:3]
RT v[16:17],v72,28816
MA a[4:7],v[20:23],v[188:191],a[4:7]
RT v[18:19],v72,30608
MA a[8:11],v[24:27],v[184:187],a[8:11]
RT v[20:21],v72,28848
MA a[12:15],v[24:27],v[188:191],a[12:15]
RT v[22:23],v72,30640
WL 6
MA a[16:19],v[28:31],v[184:187],a[16:19]
RT v[24:25],v72,28880
MA a[20:23],v[28:31],v[188:191],a[20:23]
RT v[26:27],v72,30672
MA a[24:27],v[32:35],v[184:187],a[24:27]
RT v[28:29],v72,35840
MA a[28:31],v[32:35],v[188:191],a[28:31]
RT v[30:31],v72,37632
WL 6
MA a[32:35],v[12:15],v[184:187],a[32:35]
RT v[32:33],v72,35880
s_add_u32 m0,s90,6144
s_nop 0
MA a[36:39],v[12:15],v[188:191],a[36:39]
RT v[34:35],v72,37672
buffer_load_dwordx4 v6,s[24:27],s6 offen lds
MA a[40:43],v[184:187],v[16:19],a[40:43]
RT v[12:13],v72,35912
MA a[44:47],v[188:191],v[16:19],a[44:47]
RT v[14:15],v72,37704
WL 6
MA a[48:51],v[184:187],v[20:23],a[48:51]
RT v[16:17],v72,35952
s_add_u32 m0,s90,28672
s_nop 0
MA a[52:55],v[188:191],v[20:23],a[52:55]
RT v[18:19],v72,37744
buffer_load_dwordx4 v0,s[24:27],s7 offen lds
MA a[56:59],v[184:187],v[24:27],a[56:59]
RT v[20:21],v73,35840
MA a[60:63],v[188:191],v[24:27],a[60:63]
RT v[22:23],v73,37632
WL 6
MA a[0:3],v[28:31],v[192:195],a[0:3]
RT v[24:25],v72,35984
MA a[4:7],v[28:31],v[196:199],a[4:7]
RT v[26:27],v72,37776
MA a[8:11],v[32:35],v[192:195],a[8:11]
RT v[28:29],v72,36016
MA a[12:15],v[32:35],v[196:199],a[12:15]
RT v[30:31],v72,37808
WL 6
MA a[16:19],v[12:15],v[192:195],a[16:19]
RT v[32:33],v72,36048
s_add_u32 m0,s90,29696
s_nop 0
MA a[20:23],v[12:15],v[196:199],a[20:23]
RT v[34:35],v72,37840
buffer_load_dwordx4 v1,s[24:27],s7 offen lds
MA a[24:27],v[16:19],v[192:195],a[24:27]
RT v[12:13],v72,43008
MA a[28:31],v[16:19],v[196:199],a[28:31]
RT v[14:15],v72,44800
WL 6
MA a[32:35],v[20:23],v[192:195],a[32:35]
RT v[16:17],v72,43048
MA a[36:39],v[20:23],v[196:199],a[36:39]
RT v[18:19],v72,44840
MA a[40:43],v[192:195],v[24:27],a[40:43]
RT v[20:21],v72,43080
MA a[44:47],v[196:199],v[24:27],a[44:47]
RT v[22:23],v72,44872
WL 6
MA a[48:51],v[192:195],v[28:31],a[48:51]
RT v[24:25],v72,43120
s_add_u32 m0,s90,30720
s_nop 0
MA a[52:55],v[196:199],v[28:31],a[52:55]
RT v[26:27],v72,44912
buffer_load_dwordx4 v2,s[24:27],s7 offen lds
MA a[56:59],v[192:195],v[32:35],a[56:59]
RT v[28:29],v73,43008
MA a[60:63],v[196:199],v[32:35],a[60:63]
RT v[30:31],v73,44800
WL 6
MA a[0:3],v[12:15],v[200:203],a[0:3]
RT v[32:33],v72,43152
MA a[4:7],v[12:15],v[204:207],a[4:7]
RT v[34:35],v72,44944
MA a[8:11],v[16:19],v[200:203],a[8:11]
RT v[12:13],v72,43184
MA a[12:15],v[16:19],v[204:207],a[12:15]
RT v[14:15],v72,44976
WL 6
MA a[16:19],v[20:23],v[200:203],a[16:19]
RT v[16:17],v72,43216
MA a[20:23],v[20:23],v[204:207],a[20:23]
RT v[18:19],v72,45008
MA a[24:27],v[24:27],v[200:203],a[24:27]
s_waitcnt vmcnt(10)
s_barrier
RT v[20:21],v72,50176
s_add_u32 m0,s90,31744
s_nop 0
MA a[28:31],v[24:27],v[204:207],a[28:31]
RT v[22:23],v72,51968
buffer_load_dwordx4 v3,s[24:27],s7 offen lds
WL 6
MA a[32:35],v[28:31],v[200:203],a[32:35]
RT v[24:25],v72,50216
MA a[36:39],v[28:31],v[204:207],a[36:39]
RT v[26:27],v72,52008
MA a[40:43],v[200:203],v[32:35],a[40:43]
RT v[28:29],v72,50248
MA a[44:47],v[204:207],v[32:35],a[44:47]
RT v[30:31],v72,52040
WL 6
MA a[48:51],v[200:203],v[12:15],a[48:51]
RT v[32:33],v72,50288
MA a[52:55],v[204:207],v[12:15],a[52:55]
RT v[34:35],v72,52080
MA a[56:59],v[200:203],v[16:19],a[56:59]
RT v[12:13],v73,50176
s_add_u32 m0,s90,32768
s_nop 0
MA a[60:63],v[204:207],v[16:19],a[60:63]
RT v[14:15],v73,51968
buffer_load_dwordx4 v4,s[24:27],s7 offen lds
WL 6
MA a[0:3],v[20:23],v[208:211],a[0:3]
RT v[16:17],v72,50320
MA a[4:7],v[20:23],v[212:215],a[4:7]
RT v[18:19],v72,52112
MA a[8:11],v[24:27],v[208:211],a[8:11]
RT v[20:21],v72,50352
MA a[12:15],v[24:27],v[212:215],a[12:15]
RT v[22:23],v72,52144
WL 6
MA a[16:19],v[28:31],v[208:211],a[16:19]
RT v[24:25],v72,50384
MA a[20:23],v[28:31],v[212:215],a[20:23]
RT v[26:27],v72,52176
MA a[24:27],v[32:35],v[208:211],a[24:27]
RT v[28:29],v72,57344
s_add_u32 m0,s90,33792
s_nop 0
MA a[28:31],v[32:35],v[212:215],a[28:31]
RT v[30:31],v72,59136
buffer_load_dwordx4 v5,s[24:27],s7 offen lds
WL 6
MA a[32:35],v[12:15],v[208:211],a[32:35]
RT v[32:33],v72,57384
MA a[36:39],v[12:15],v[212:215],a[36:39]
RT v[34:35],v72,59176
MA a[40:43],v[208:211],v[16:19],a[40:43]
RT v[12:13],v72,57416
MA a[44:47],v[212:215],v[16:19],a[44:47]
RT v[14:15],v72,59208
WL 6
MA a[48:51],v[208:211],v[20:23],a[48:51]
RT v[16:17],v72,57456
MA a[52:55],v[212:215],v[20:23],a[52:55]
RT v[18:19],v72,59248
MA a[56:59],v[208:211],v[24:27],a[56:59]
RT v[20:21],v73,57344
MA a[60:63],v[212:215],v[24:27],a[60:63]
RT v[22:23],v73,59136
WL 6
MA a[0:3],v[28:31],v[216:219],a[0:3]
RT v[24:25],v72,57488
s_add_u32 m0,s90,34816
s_nop 0
MA a[4:7],v[28:31],v[220:223],a[4:7]
RT v[26:27],v72,59280
buffer_load_dwordx4 v6,s[24:27],s7 offen lds
MA a[8:11],v[32:35],v[216:219],a[8:11]
RT v[28:29],v72,57520
MA a[12:15],v[32:35],v[220:223],a[12:15]
RT v[30:31],v72,59312
WL 6
MA a[16:19],v[12:15],v[216:219],a[16:19]
RT v[32:33],v72,57552
s_add_u32 m0,s90,57344
s_nop 0
MA a[20:23],v[12:15],v[220:223],a[20:23]
RT v[34:35],v72,59344
buffer_load_dwordx4 v0,s[24:27],s8 offen lds
MA a[24:27],v[16:19],v[216:219],a[24:27]
s_waitcnt vmcnt(8)
s_barrier
v_add_u32 v72,4294902784,v72
RT v[12:13],v72,0
MA a[28:31],v[16:19],v[220:223],a[28:31]
RT v[14:15],v72,1792
WL 6
MA a[32:35],v[20:23],v[216:219],a[32:35]
RT v[16:17],v72,40
MA a[36:39],v[20:23],v[220:223],a[36:39]
RT v[18:19],v72,1832
MA a[40:43],v[216:219],v[24:27],a[40:43]
RT v[20:21],v72,72
MA a[44:47],v[220:223],v[24:27],a[44:47]
RT v[22:23],v72,1864
WL 6
MA a[48:51],v[216:219],v[28:31],a[48:51]
RT v[24:25],v72,112
s_add_u32 m0,s90,58368
s_nop 0
MA a[52:55],v[220:223],v[28:31],a[52:55]
RT v[26:27],v72,1904
buffer_load_dwordx4 v1,s[24:27],s8 offen lds
MA a[56:59],v[216:219],v[32:35],a[56:59]
v_add_u32 v73,4294902784,v73
RT v[28:29],v73,0
MA a[60:63],v[220:223],v[32:35],a[60:63]
RT v[30:31],v73,1792
WL 6
MA a[64:67],v[12:15],v[80:83],0
RT v[32:33],v72,144
MA a[68:71],v[12:15],v[84:87],0
RT v[34:35],v72,1936
MA a[72:75],v[16:19],v[80:83],0
RT v[12:13],v72,176
MA a[76:79],v[16:19],v[84:87],0
RT v[14:15],v72,1968
WL 6
MA a[80:83],v[20:23],v[80:83],0
RT v[16:17],v72,208
s_add_u32 m0,s90,59392
s_nop 0
MA a[84:87],v[20:23],v[84:87],0
RT v[18:19],v72,2000
buffer_load_dwordx4 v2,s[24:27],s8 offen lds
MA a[88:91],v[24:27],v[80:83],0
RT v[20:21],v72,7168
MA a[92:95],v[24:27],v[84:87],0
RT v[22:23],v72,8960
WL 6
MA a[96:99],v[28:31],v[80:83],0
RT v[24:25],v72,7208
MA a[100:103],v[28:31],v[84:87],0
RT v[26:27],v72,9000
MA a[104:107],v[80:83],v[32:35],0
RT v[28:29],v72,7240
MA a[108:111],v[84:87],v[32:35],0
RT v[30:31],v72,9032
WL 6
MA a[112:115],v[80:83],v[12:15],0
RT v[32:33],v72,7280
v_accvgpr_read_b32 v244,a0
MA a[116:119],v[84:87],v[12:15],0
RT v[34:35],v72,9072
v_accvgpr_read_b32 v245,a1
MA a[120:123],v[80:83],v[16:19],0
RT v[12:13],v73,7168
s_add_u32 m0,s90,60416
s_nop 0
MA a[124:127],v[84:87],v[16:19],0
RT v[14:15],v73,8960
buffer_load_dwordx4 v3,s[24:27],s8 offen lds
WL 6
MA a[64:67],v[20:23],v[88:91],a[64:67]
RT v[16:17],v72,7312
v_accvgpr_read_b32 v246,a2
MA a[68:71],v[20:23],v[92:95],a[68:71]
RT v[18:19],v72,9104
v_accvgpr_read_b32 v247,a3
MA a[72:75],v[24:27],v[88:91],a[72:75]
RT v[20:21],v72,7344
v_accvgpr_read_b32 v248,a4
MA a[76:79],v[24:27],v[92:95],a[76:79]
RT v[22:23],v72,9136
WL 6
MA a[80:83],v[28:31],v[88:91],a[80:83]
RT v[24:25],v72,7376
v_accvgpr_read_b32 v249,a5
MA a[84:87],v[28:31],v[92:95],a[84:87]
RT v[26:27],v72,9168
v_accvgpr_read_b32 v250,a6
MA a[88:91],v[32:35],v[88:91],a[88:91]
RT v[28:29],v72,14336
s_add_u32 m0,s90,61440
s_nop 0
MA a[92:95],v[32:35],v[92:95],a[92:95]
RT v[30:31],v72,16128
buffer_load_dwordx4 v4,s[24:27],s8 offen lds
WL 6
MA a[96:99],v[12:15],v[88:91],a[96:99]
RT v[32:33],v72,14376
v_accvgpr_read_b32 v251,a7
MA a[100:103],v[12:15],v[92:95],a[100:103]
RT v[34:35],v72,16168
v_mul_f32 v244,v244,v224
MA a[104:107],v[88:91],v[16:19],a[104:107]
RT v[12:13],v72,14408
v_mul_f32 v245,v245,v224
MA a[108:111],v[92:95],v[16:19],a[108:111]
RT v[14:15],v72,16200
WL 6
MA a[112:115],v[88:91],v[20:23],a[112:115]
RT v[16:17],v72,14448
v_mul_f32 v246,v246,v224
MA a[116:119],v[92:95],v[20:23],a[116:119]
RT v[18:19],v72,16240
v_mul_f32 v247,v247,v224
MA a[120:123],v[88:91],v[24:27],a[120:123]
RT v[20:21],v73,14336
s_add_u32 m0,s90,62464
s_nop 0
MA a[124:127],v[92:95],v[24:27],a[124:127]
RT v[22:23],v73,16128
buffer_load_dwordx4 v5,s[24:27],s8 offen lds
WL 6
MA a[64:67],v[28:31],v[96:99],a[64:67]
RT v[24:25],v72,14480
v_mul_f32 v248,v248,v225
MA a[68:71],v[28:31],v[100:103],a[68:71]
RT v[26:27],v72,16272
v_mul_f32 v249,v249,v225
MA a[72:75],v[32:35],v[96:99],a[72:75]
RT v[28:29],v72,14512
v_mul_f32 v250,v250,v225
MA a[76:79],v[32:35],v[100:103],a[76:79]
RT v[30:31],v72,16304
WL 6
MA a[80:83],v[12:15],v[96:99],a[80:83]
RT v[32:33],v72,14544
v_mul_f32 v251,v251,v225
MA a[84:87],v[12:15],v[100:103],a[84:87]
RT v[34:35],v72,16336
CV v240,v244,v245
MA a[88:91],v[16:19],v[96:99],a[88:91]
RT v[12:13],v72,21504
CV v241,v246,v247
MA a[92:95],v[16:19],v[100:103],a[92:95]
RT v[14:15],v72,23296
WL 6
MA a[96:99],v[20:23],v[96:99],a[96:99]
RT v[16:17],v72,21544
s_add_u32 m0,s90,63488
CV v242,v248,v249
MA a[100:103],v[20:23],v[100:103],a[100:103]
RT v[18:19],v72,23336
buffer_load_dwordx4 v6,s[24:27],s8 offen lds
MA a[104:107],v[96:99],v[24:27],a[104:107]
RT v[20:21],v72,21576
CV v243,v250,v251
s_add_u32 s88,s84,0
MA a[108:111],v[100:103],v[24:27],a[108:111]
RT v[22:23],v72,23368
s_nop 0
WL 6
MA a[112:115],v[96:99],v[28:31],a[112:115]
RT v[24:25],v72,21616
s_add_u32 m0,s90,86016
s_nop 0
MA a[116:119],v[100:103],v[28:31],a[116:119]
RT v[26:27],v72,23408
buffer_load_dwordx4 v0,s[24:27],s9 offen lds
MA a[120:123],v[96:99],v[32:35],a[120:123]
RT v[28:29],v73,21504
v_permlane16_swap_b32 v240,v242
MA a[124:127],v[100:103],v[32:35],a[124:127]
RT v[30:31],v73,23296
WL 6
MA a[64:67],v[12:15],v[104:107],a[64:67]
RT v[32:33],v72,21648
v_permlane16_swap_b32 v241,v243
MA a[68:71],v[12:15],v[108:111],a[68:71]
RT v[34:35],v72,23440
buffer_store_dwordx4 v[240:243],v234,s[40:43],s88 offen sc1
MA a[72:75],v[16:19],v[104:107],a[72:75]
RT v[12:13],v72,21680
v_accvgpr_read_b32 v244,a8
MA a[76:79],v[16:19],v[108:111],a[76:79]
RT v[14:15],v72,23472
WL 6
MA a[80:83],v[20:23],v[104:107],a[80:83]
RT v[16:17],v72,21712
s_add_u32 m0,s90,87040
v_accvgpr_read_b32 v245,a9
MA a[84:87],v[20:23],v[108:111],a[84:87]
RT v[18:19],v72,23504
buffer_load_dwordx4 v1,s[24:27],s9 offen lds
MA a[88:91],v[24:27],v[104:107],a[88:91]
s_waitcnt vmcnt(10)
s_barrier
RT v[20:21],v72,28672
v_accvgpr_read_b32 v246,a10
MA a[92:95],v[24:27],v[108:111],a[92:95]
RT v[22:23],v72,30464
WL 6
MA a[96:99],v[28:31],v[104:107],a[96:99]
RT v[24:25],v72,28712
v_accvgpr_read_b32 v247,a11
MA a[100:103],v[28:31],v[108:111],a[100:103]
RT v[26:27],v72,30504
v_accvgpr_read_b32 v248,a12
MA a[104:107],v[104:107],v[32:35],a[104:107]
RT v[28:29],v72,28744
v_accvgpr_read_b32 v249,a13
MA a[108:111],v[108:111],v[32:35],a[108:111]
RT v[30:31],v72,30536
WL 6
MA a[112:115],v[104:107],v[12:15],a[112:115]
RT v[32:33],v72,28784
s_add_u32 m0,s90,88064
v_accvgpr_read_b32 v250,a14
MA a[116:119],v[108:111],v[12:15],a[116:119]
RT v[34:35],v72,30576
buffer_load_dwordx4 v2,s[24:27],s9 offen lds
v_accvgpr_read_b32 v251,a15
MA a[120:123],v[104:107],v[16:19],a[120:123]
RT v[12:13],v73,28672
v_mul_f32 v244,v244,v224
MA a[124:127],v[108:111],v[16:19],a[124:127]
RT v[14:15],v73,30464
WL 6
MA a[64:67],v[20:23],v[112:115],a[64:67]
RT v[16:17],v72,28816
v_mul_f32 v245,v245,v224
MA a[68:71],v[20:23],v[116:119],a[68:71]
RT v[18:19],v72,30608
v_mul_f32 v246,v246,v224
MA a[72:75],v[24:27],v[112:115],a[72:75]
RT v[20:21],v72,28848
v_mul_f32 v247,v247,v224
MA a[76:79],v[24:27],v[116:119],a[76:79]
RT v[22:23],v72,30640
WL 6
MA a[80:83],v[28:31],v[112:115],a[80:83]
RT v[24:25],v72,28880
v_mul_f32 v248,v248,v225
MA a[84:87],v[28:31],v[116:119],a[84:87]
RT v[26:27],v72,30672
v_mul_f32 v249,v249,v225
MA a[88:91],v[32:35],v[112:115],a[88:91]
RT v[28:29],v72,35840
s_add_u32 m0,s90,89088
v_mul_f32 v250,v250,v225
MA a[92:95],v[32:35],v[116:119],a[92:95]
RT v[30:31],v72,37632
buffer_load_dwordx4 v3,s[24:27],s9 offen lds
WL 6
MA a[96:99],v[12:15],v[112:115],a[96:99]
RT v[32:33],v72,35880
v_mul_f32 v251,v251,v225
MA a[100:103],v[12:15],v[116:119],a[100:103]
RT v[34:35],v72,37672
CV v240,v244,v245
MA a[104:107],v[112:115],v[16:19],a[104:107]
RT v[12:13],v72,35912
CV v241,v246,v247
MA a[108:111],v[116:119],v[16:19],a[108:111]
RT v[14:15],v72,37704
WL 6
MA a[112:115],v[112:115],v[20:23],a[112:115]
RT v[16:17],v72,35952
CV v242,v248,v249
CV v243,v250,v251
MA a[116:119],v[116:119],v[20:23],a[116:119]
RT v[18:19],v72,37744
s_add_u32 s88,s84,65536
s_nop 0
MA a[120:123],v[112:115],v[24:27],a[120:123]
RT v[20:21],v73,35840
s_add_u32 m0,s90,90112
s_nop 0
MA a[124:127],v[116:119],v[24:27],a[124:127]
RT v[22:23],v73,37632
buffer_load_dwordx4 v4,s[24:27],s9 offen lds
WL 6
MA a[64:67],v[28:31],v[120:123],a[64:67]
RT v[24:25],v72,35984
v_permlane16_swap_b32 v240,v242
v_permlane16_swap_b32 v241,v243
MA a[68:71],v[28:31],v[124:127],a[68:71]
RT v[26:27],v72,37776
buffer_store_dwordx4 v[240:243],v234,s[40:43],s88 offen sc1
MA a[72:75],v[32:35],v[120:123],a[72:75]
RT v[28:29],v72,36016
v_accvgpr_read_b32 v244,a16
MA a[76:79],v[32:35],v[124:127],a[76:79]
RT v[30:31],v72,37808
WL 6
MA a[80:83],v[12:15],v[120:123],a[80:83]
RT v[32:33],v72,36048
v_accvgpr_read_b32 v245,a17
MA a[84:87],v[12:15],v[124:127],a[84:87]
RT v[34:35],v72,37840
v_accvgpr_read_b32 v246,a18
MA a[88:91],v[16:19],v[120:123],a[88:91]
RT v[12:13],v72,43008
s_add_u32 m0,s90,91136
s_nop 0
MA a[92:95],v[16:19],v[124:127],a[92:95]
RT v[14:15],v72,44800
buffer_load_dwordx4 v5,s[24:27],s9 offen lds
WL 6
MA a[96:99],v[20:23],v[120:123],a[96:99]
RT v[16:17],v72,43048
v_accvgpr_read_b32 v247,a19
MA a[100:103],v[20:23],v[124:127],a[100:103]
RT v[18:19],v72,44840
v_accvgpr_read_b32 v248,a20
MA a[104:107],v[120:123],v[24:27],a[104:107]
RT v[20:21],v72,43080
v_accvgpr_read_b32 v249,a21
MA a[108:111],v[124:127],v[24:27],a[108:111]
RT v[22:23],v72,44872
WL 6
MA a[112:115],v[120:123],v[28:31],a[112:115]
RT v[24:25],v72,43120
v_accvgpr_read_b32 v250,a22
MA a[116:119],v[124:127],v[28:31],a[116:119]
RT v[26:27],v72,44912
v_accvgpr_read_b32 v251,a23
MA a[120:123],v[120:123],v[32:35],a[120:123]
RT v[28:29],v73,43008
v_mul_f32 v244,v244,v224
MA a[124:127],v[124:127],v[32:35],a[124:127]
RT v[30:31],v73,44800
WL 6
MA a[64:67],v[12:15],v[128:131],a[64:67]
RT v[32:33],v72,43152
s_add_u32 m0,s90,92160
s_nop 0
MA a[68:71],v[12:15],v[132:135],a[68:71]
RT v[34:35],v72,44944
buffer_load_dwordx4 v6,s[24:27],s9 offen lds
MA a[72:75],v[16:19],v[128:131],a[72:75]
RT v[12:13],v72,43184
v_mul_f32 v245,v245,v224
MA a[76:79],v[16:19],v[132:135],a[76:79]
RT v[14:15],v72,44976
WL 6
MA a[80:83],v[20:23],v[128:131],a[80:83]
RT v[16:17],v72,43216
s_add_u32 m0,s11,114688
v_mul_f32 v246,v246,v224
MA a[84:87],v[20:23],v[132:135],a[84:87]
RT v[18:19],v72,45008
buffer_load_dwordx4 v36,s[24:27],s10 offen lds
v_mul_f32 v247,v247,v224
MA a[88:91],v[24:27],v[128:131],a[88:91]
RT v[20:21],v72,50176
v_mul_f32 v248,v248,v225
MA a[92:95],v[24:27],v[132:135],a[92:95]
RT v[22:23],v72,51968
WL 6
MA a[96:99],v[28:31],v[128:131],a[96:99]
RT v[24:25],v72,50216
v_mul_f32 v249,v249,v225
MA a[100:103],v[28:31],v[132:135],a[100:103]
RT v[26:27],v72,52008
v_mul_f32 v250,v250,v225
MA a[104:107],v[128:131],v[32:35],a[104:107]
RT v[28:29],v72,50248
v_mul_f32 v251,v251,v225
MA a[108:111],v[132:135],v[32:35],a[108:111]
RT v[30:31],v72,52040
CV v240,v244,v245
WL 6
MA a[112:115],v[128:131],v[12:15],a[112:115]
RT v[32:33],v72,50288
s_add_u32 m0,s11,115712
CV v241,v246,v247
MA a[116:119],v[132:135],v[12:15],a[116:119]
RT v[34:35],v72,52080
buffer_load_dwordx4 v37,s[24:27],s10 offen lds
MA a[120:123],v[128:131],v[16:19],a[120:123]
RT v[12:13],v73,50176
CV v242,v248,v249
CV v243,v250,v251
MA a[124:127],v[132:135],v[16:19],a[124:127]
RT v[14:15],v73,51968
s_add_u32 s88,s84,131072
s_nop 0
WL 6
MA a[64:67],v[20:23],v[136:139],a[64:67]
RT v[16:17],v72,50320
v_permlane16_swap_b32 v240,v242
v_permlane16_swap_b32 v241,v243
MA a[68:71],v[20:23],v[140:143],a[68:71]
RT v[18:19],v72,52112
buffer_store_dwordx4 v[240:243],v234,s[40:43],s88 offen sc1
MA a[72:75],v[24:27],v[136:139],a[72:75]
RT v[20:21],v72,50352
v_accvgpr_read_b32 v244,a24
MA a[76:79],v[24:27],v[140:143],a[76:79]
RT v[22:23],v72,52144
WL 6
MA a[80:83],v[28:31],v[136:139],a[80:83]
RT v[24:25],v72,50384
v_accvgpr_read_b32 v245,a25
MA a[84:87],v[28:31],v[140:143],a[84:87]
RT v[26:27],v72,52176
v_accvgpr_read_b32 v246,a26
MA a[88:91],v[32:35],v[136:139],a[88:91]
s_waitcnt vmcnt(12)
s_barrier
RT v[28:29],v72,57344
s_add_u32 m0,s11,116736
s_nop 0
MA a[92:95],v[32:35],v[140:143],a[92:95]
RT v[30:31],v72,59136
buffer_load_dwordx4 v38,s[24:27],s10 offen lds
WL 6
MA a[96:99],v[12:15],v[136:139],a[96:99]
RT v[32:33],v72,57384
v_accvgpr_read_b32 v247,a27
MA a[100:103],v[12:15],v[140:143],a[100:103]
RT v[34:35],v72,59176
v_accvgpr_read_b32 v248,a28
MA a[104:107],v[136:139],v[16:19],a[104:107]
RT v[12:13],v72,57416
v_accvgpr_read_b32 v249,a29
MA a[108:111],v[140:143],v[16:19],a[108:111]
RT v[14:15],v72,59208
WL 6
MA a[112:115],v[136:139],v[20:23],a[112:115]
RT v[16:17],v72,57456
v_accvgpr_read_b32 v250,a30
MA a[116:119],v[140:143],v[20:23],a[116:119]
RT v[18:19],v72,59248
v_accvgpr_read_b32 v251,a31
MA a[120:123],v[136:139],v[24:27],a[120:123]
RT v[20:21],v73,57344
v_mul_f32 v244,v244,v224
MA a[124:127],v[140:143],v[24:27],a[124:127]
RT v[22:23],v73,59136
WL 6
MA a[64:67],v[28:31],v[144:147],a[64:67]
RT v[24:25],v72,57488
s_add_u32 m0,s11,117760
s_nop 0
MA a[68:71],v[28:31],v[148:151],a[68:71]
RT v[26:27],v72,59280
buffer_load_dwordx4 v39,s[24:27],s10 offen lds
MA a[72:75],v[32:35],v[144:147],a[72:75]
RT v[28:29],v72,57520
v_mul_f32 v245,v245,v224
MA a[76:79],v[32:35],v[148:151],a[76:79]
RT v[30:31],v72,59312
WL 6
MA a[80:83],v[12:15],v[144:147],a[80:83]
RT v[32:33],v72,57552
v_mul_f32 v246,v246,v224
MA a[84:87],v[12:15],v[148:151],a[84:87]
RT v[34:35],v72,59344
v_mul_f32 v247,v247,v224
MA a[88:91],v[16:19],v[144:147],a[88:91]
v_add_u32 v72,64512,v72
RT v[12:13],v72,0
v_mul_f32 v248,v248,v225
MA a[92:95],v[16:19],v[148:151],a[92:95]
RT v[14:15],v72,1792
WL 6
MA a[96:99],v[20:23],v[144:147],a[96:99]
RT v[16:17],v72,40
v_mul_f32 v249,v249,v225
MA a[100:103],v[20:23],v[148:151],a[100:103]
RT v[18:19],v72,1832
v_mul_f32 v250,v250,v225
MA a[104:107],v[144:147],v[24:27],a[104:107]
RT v[20:21],v72,72
v_mul_f32 v251,v251,v225
MA a[108:111],v[148:151],v[24:27],a[108:111]
RT v[22:23],v72,1864
WL 6
MA a[112:115],v[144:147],v[28:31],a[112:115]
RT v[24:25],v72,112
CV v240,v244,v245
MA a[116:119],v[148:151],v[28:31],a[116:119]
RT v[26:27],v72,1904
CV v241,v246,v247
MA a[120:123],v[144:147],v[32:35],a[120:123]
v_add_u32 v73,64512,v73
RT v[28:29],v73,0
CV v242,v248,v249
MA a[124:127],v[148:151],v[32:35],a[124:127]
RT v[30:31],v73,1792
WL 6
MA a[64:67],v[12:15],v[152:155],a[64:67]
RT v[32:33],v72,144
CV v243,v250,v251
MA a[68:71],v[12:15],v[156:159],a[68:71]
RT v[34:35],v72,1936
s_add_u32 s88,s84,196608
s_nop 0
MA a[72:75],v[16:19],v[152:155],a[72:75]
RT v[12:13],v72,176
v_permlane16_swap_b32 v240,v242
MA a[76:79],v[16:19],v[156:159],a[76:79]
RT v[14:15],v72,1968
WL 6
MA a[80:83],v[20:23],v[152:155],a[80:83]
RT v[16:17],v72,208
v_permlane16_swap_b32 v241,v243
MA a[84:87],v[20:23],v[156:159],a[84:87]
RT v[18:19],v72,2000
buffer_store_dwordx4 v[240:243],v234,s[40:43],s88 offen sc1
MA a[88:91],v[24:27],v[152:155],a[88:91]
RT v[20:21],v72,7168
v_accvgpr_read_b32 v244,a32
MA a[92:95],v[24:27],v[156:159],a[92:95]
RT v[22:23],v72,8960
WL 6
MA a[96:99],v[28:31],v[152:155],a[96:99]
RT v[24:25],v72,7208
v_accvgpr_read_b32 v245,a33
MA a[100:103],v[28:31],v[156:159],a[100:103]
RT v[26:27],v72,9000
v_accvgpr_read_b32 v246,a34
MA a[104:107],v[152:155],v[32:35],a[104:107]
RT v[28:29],v72,7240
v_accvgpr_read_b32 v247,a35
MA a[108:111],v[156:159],v[32:35],a[108:111]
RT v[30:31],v72,9032
WL 6
MA a[112:115],v[152:155],v[12:15],a[112:115]
RT v[32:33],v72,7280
v_accvgpr_read_b32 v248,a36
MA a[116:119],v[156:159],v[12:15],a[116:119]
RT v[34:35],v72,9072
v_accvgpr_read_b32 v249,a37
MA a[120:123],v[152:155],v[16:19],a[120:123]
RT v[12:13],v73,7168
v_accvgpr_read_b32 v250,a38
MA a[124:127],v[156:159],v[16:19],a[124:127]
RT v[14:15],v73,8960
WL 6
MA a[64:67],v[20:23],v[160:163],a[64:67]
RT v[16:17],v72,7312
v_accvgpr_read_b32 v251,a39
MA a[68:71],v[20:23],v[164:167],a[68:71]
RT v[18:19],v72,9104
v_mul_f32 v244,v244,v224
MA a[72:75],v[24:27],v[160:163],a[72:75]
RT v[20:21],v72,7344
v_mul_f32 v245,v245,v224
MA a[76:79],v[24:27],v[164:167],a[76:79]
RT v[22:23],v72,9136
WL 6
MA a[80:83],v[28:31],v[160:163],a[80:83]
RT v[24:25],v72,7376
v_mul_f32 v246,v246,v224
MA a[84:87],v[28:31],v[164:167],a[84:87]
RT v[26:27],v72,9168
v_mul_f32 v247,v247,v224
MA a[88:91],v[32:35],v[160:163],a[88:91]
RT v[28:29],v72,14336
v_mul_f32 v248,v248,v225
MA a[92:95],v[32:35],v[164:167],a[92:95]
RT v[30:31],v72,16128
WL 6
MA a[96:99],v[12:15],v[160:163],a[96:99]
RT v[32:33],v72,14376
v_mul_f32 v249,v249,v225
MA a[100:103],v[12:15],v[164:167],a[100:103]
RT v[34:35],v72,16168
v_mul_f32 v250,v250,v225
MA a[104:107],v[160:163],v[16:19],a[104:107]
RT v[12:13],v72,14408
v_mul_f32 v251,v251,v225
MA a[108:111],v[164:167],v[16:19],a[108:111]
RT v[14:15],v72,16200
WL 6
MA a[112:115],v[160:163],v[20:23],a[112:115]
RT v[16:17],v72,14448
CV v240,v244,v245
MA a[116:119],v[164:167],v[20:23],a[116:119]
RT v[18:19],v72,16240
CV v241,v246,v247
MA a[120:123],v[160:163],v[24:27],a[120:123]
RT v[20:21],v73,14336
CV v242,v248,v249
MA a[124:127],v[164:167],v[24:27],a[124:127]
RT v[22:23],v73,16128
WL 6
MA a[64:67],v[28:31],v[168:171],a[64:67]
RT v[24:25],v72,14480
CV v243,v250,v251
MA a[68:71],v[28:31],v[172:175],a[68:71]
RT v[26:27],v72,16272
s_add_u32 s88,s85,0
s_add_u32 s89,s85,8192
MA a[72:75],v[32:35],v[168:171],a[72:75]
RT v[28:29],v72,14512
buffer_store_dword v240,v235,s[40:43],s88 offen offset:0 sc1
MA a[76:79],v[32:35],v[172:175],a[76:79]
RT v[30:31],v72,16304
WL 6
MA a[80:83],v[12:15],v[168:171],a[80:83]
RT v[32:33],v72,14544
RT v[34:35],v72,16336
MA a[84:87],v[12:15],v[172:175],a[84:87]
buffer_store_dword v241,v235,s[40:43],s89 offen offset:0 sc1
MA a[88:91],v[16:19],v[168:171],a[88:91]
s_waitcnt vmcnt(8)
s_barrier
RT v[12:13],v72,21504
MA a[92:95],v[16:19],v[172:175],a[92:95]
RT v[14:15],v72,23296
WL 6
MA a[96:99],v[20:23],v[168:171],a[96:99]
RT v[16:17],v72,21544
RT v[18:19],v72,23336
MA a[100:103],v[20:23],v[172:175],a[100:103]
buffer_store_dword v242,v235,s[40:43],s88 offen offset:64 sc1
MA a[104:107],v[168:171],v[24:27],a[104:107]
RT v[20:21],v72,21576
buffer_store_dword v243,v235,s[40:43],s89 offen offset:64 sc1
MA a[108:111],v[172:175],v[24:27],a[108:111]
RT v[22:23],v72,23368
WL 6
MA a[112:115],v[168:171],v[28:31],a[112:115]
RT v[24:25],v72,21616
MA a[116:119],v[172:175],v[28:31],a[116:119]
RT v[26:27],v72,23408
s_add_u32 s88,s86,0
MA a[120:123],v[168:171],v[32:35],a[120:123]
RT v[28:29],v73,21504
v_accvgpr_read_b32 v244,a40
MA a[124:127],v[172:175],v[32:35],a[124:127]
RT v[30:31],v73,23296
WL 6
MA a[64:67],v[12:15],v[176:179],a[64:67]
RT v[32:33],v72,21648
MA a[68:71],v[12:15],v[180:183],a[68:71]
RT v[34:35],v72,23440
v_accvgpr_read_b32 v245,a41
MA a[72:75],v[16:19],v[176:179],a[72:75]
RT v[12:13],v72,21680
v_accvgpr_read_b32 v246,a42
MA a[76:79],v[16:19],v[180:183],a[76:79]
RT v[14:15],v72,23472
WL 6
MA a[80:83],v[20:23],v[176:179],a[80:83]
RT v[16:17],v72,21712
v_accvgpr_read_b32 v247,a43
MA a[84:87],v[20:23],v[180:183],a[84:87]
RT v[18:19],v72,23504
v_accvgpr_read_b32 v248,a44
MA a[88:91],v[24:27],v[176:179],a[88:91]
RT v[20:21],v72,28672
v_accvgpr_read_b32 v249,a45
MA a[92:95],v[24:27],v[180:183],a[92:95]
RT v[22:23],v72,30464
WL 6
MA a[96:99],v[28:31],v[176:179],a[96:99]
RT v[24:25],v72,28712
v_accvgpr_read_b32 v250,a46
MA a[100:103],v[28:31],v[180:183],a[100:103]
RT v[26:27],v72,30504
v_accvgpr_read_b32 v251,a47
MA a[104:107],v[176:179],v[32:35],a[104:107]
RT v[28:29],v72,28744
v_mul_f32 v244,v244,v226
MA a[108:111],v[180:183],v[32:35],a[108:111]
RT v[30:31],v72,30536
WL 6
MA a[112:115],v[176:179],v[12:15],a[112:115]
RT v[32:33],v72,28784
v_mul_f32 v245,v245,v227
MA a[116:119],v[180:183],v[12:15],a[116:119]
RT v[34:35],v72,30576
v_mul_f32 v246,v246,v228
MA a[120:123],v[176:179],v[16:19],a[120:123]
RT v[12:13],v73,28672
v_mul_f32 v247,v247,v229
MA a[124:127],v[180:183],v[16:19],a[124:127]
RT v[14:15],v73,30464
WL 6
MA a[64:67],v[20:23],v[184:187],a[64:67]
RT v[16:17],v72,28816
v_mul_f32 v248,v248,v230
MA a[68:71],v[20:23],v[188:191],a[68:71]
RT v[18:19],v72,30608
v_mul_f32 v249,v249,v231
MA a[72:75],v[24:27],v[184:187],a[72:75]
RT v[20:21],v72,28848
v_mul_f32 v250,v250,v232
MA a[76:79],v[24:27],v[188:191],a[76:79]
RT v[22:23],v72,30640
WL 6
MA a[80:83],v[28:31],v[184:187],a[80:83]
RT v[24:25],v72,28880
v_mul_f32 v251,v251,v233
MA a[84:87],v[28:31],v[188:191],a[84:87]
RT v[26:27],v72,30672
CV v240,v244,v245
MA a[88:91],v[32:35],v[184:187],a[88:91]
RT v[28:29],v72,35840
CV v241,v246,v247
MA a[92:95],v[32:35],v[188:191],a[92:95]
RT v[30:31],v72,37632
WL 6
MA a[96:99],v[12:15],v[184:187],a[96:99]
RT v[32:33],v72,35880
CV v242,v248,v249
CV v243,v250,v251
MA a[100:103],v[12:15],v[188:191],a[100:103]
RT v[34:35],v72,37672
buffer_store_dwordx4 v[240:243],v236,s[40:43],s88 offen sc1
MA a[104:107],v[184:187],v[16:19],a[104:107]
RT v[12:13],v72,35912
v_accvgpr_read_b32 v244,a48
MA a[108:111],v[188:191],v[16:19],a[108:111]
RT v[14:15],v72,37704
WL 6
MA a[112:115],v[184:187],v[20:23],a[112:115]
RT v[16:17],v72,35952
MA a[116:119],v[188:191],v[20:23],a[116:119]
RT v[18:19],v72,37744
v_accvgpr_read_b32 v245,a49
MA a[120:123],v[184:187],v[24:27],a[120:123]
RT v[20:21],v73,35840
v_accvgpr_read_b32 v246,a50
MA a[124:127],v[188:191],v[24:27],a[124:127]
RT v[22:23],v73,37632
WL 6
MA a[64:67],v[28:31],v[192:195],a[64:67]
RT v[24:25],v72,35984
v_accvgpr_read_b32 v247,a51
MA a[68:71],v[28:31],v[196:199],a[68:71]
RT v[26:27],v72,37776
v_accvgpr_read_b32 v248,a52
MA a[72:75],v[32:35],v[192:195],a[72:75]
RT v[28:29],v72,36016
v_accvgpr_read_b32 v249,a53
MA a[76:79],v[32:35],v[196:199],a[76:79]
RT v[30:31],v72,37808
WL 6
MA a[80:83],v[12:15],v[192:195],a[80:83]
RT v[32:33],v72,36048
v_accvgpr_read_b32 v250,a54
MA a[84:87],v[12:15],v[196:199],a[84:87]
RT v[34:35],v72,37840
v_accvgpr_read_b32 v251,a55
MA a[88:91],v[16:19],v[192:195],a[88:91]
RT v[12:13],v72,43008
v_mul_f32 v244,v244,v226
MA a[92:95],v[16:19],v[196:199],a[92:95]
RT v[14:15],v72,44800
WL 6
MA a[96:99],v[20:23],v[192:195],a[96:99]
RT v[16:17],v72,43048
v_mul_f32 v245,v245,v227
MA a[100:103],v[20:23],v[196:199],a[100:103]
RT v[18:19],v72,44840
v_mul_f32 v246,v246,v228
MA a[104:107],v[192:195],v[24:27],a[104:107]
RT v[20:21],v72,43080
v_mul_f32 v247,v247,v229
MA a[108:111],v[196:199],v[24:27],a[108:111]
RT v[22:23],v72,44872
WL 6
MA a[112:115],v[192:195],v[28:31],a[112:115]
RT v[24:25],v72,43120
v_mul_f32 v248,v248,v230
MA a[116:119],v[196:199],v[28:31],a[116:119]
RT v[26:27],v72,44912
v_mul_f32 v249,v249,v231
MA a[120:123],v[192:195],v[32:35],a[120:123]
RT v[28:29],v73,43008
v_mul_f32 v250,v250,v232
MA a[124:127],v[196:199],v[32:35],a[124:127]
RT v[30:31],v73,44800
WL 6
MA a[64:67],v[12:15],v[200:203],a[64:67]
RT v[32:33],v72,43152
v_mul_f32 v251,v251,v233
MA a[68:71],v[12:15],v[204:207],a[68:71]
RT v[34:35],v72,44944
CV v240,v244,v245
MA a[72:75],v[16:19],v[200:203],a[72:75]
RT v[12:13],v72,43184
CV v241,v246,v247
MA a[76:79],v[16:19],v[204:207],a[76:79]
RT v[14:15],v72,44976
WL 6
MA a[80:83],v[20:23],v[200:203],a[80:83]
RT v[16:17],v72,43216
CV v242,v248,v249
MA a[84:87],v[20:23],v[204:207],a[84:87]
RT v[18:19],v72,45008
CV v243,v250,v251
MA a[88:91],v[24:27],v[200:203],a[88:91]
s_waitcnt vmcnt(6)
s_barrier
RT v[20:21],v72,50176
buffer_store_dwordx4 v[240:243],v237,s[40:43],s88 offen sc1
MA a[92:95],v[24:27],v[204:207],a[92:95]
RT v[22:23],v72,51968
WL 6
MA a[96:99],v[28:31],v[200:203],a[96:99]
RT v[24:25],v72,50216
MA a[100:103],v[28:31],v[204:207],a[100:103]
RT v[26:27],v72,52008
v_accvgpr_read_b32 v244,a56
MA a[104:107],v[200:203],v[32:35],a[104:107]
RT v[28:29],v72,50248
v_accvgpr_read_b32 v245,a57
MA a[108:111],v[204:207],v[32:35],a[108:111]
RT v[30:31],v72,52040
WL 6
MA a[112:115],v[200:203],v[12:15],a[112:115]
RT v[32:33],v72,50288
v_accvgpr_read_b32 v246,a58
MA a[116:119],v[204:207],v[12:15],a[116:119]
RT v[34:35],v72,52080
v_accvgpr_read_b32 v247,a59
MA a[120:123],v[200:203],v[16:19],a[120:123]
RT v[12:13],v73,50176
v_accvgpr_read_b32 v248,a60
MA a[124:127],v[204:207],v[16:19],a[124:127]
RT v[14:15],v73,51968
WL 6
MA a[64:67],v[20:23],v[208:211],a[64:67]
RT v[16:17],v72,50320
MA a[68:71],v[20:23],v[212:215],a[68:71]
RT v[18:19],v72,52112
v_accvgpr_read_b32 v249,a61
MA a[72:75],v[24:27],v[208:211],a[72:75]
RT v[20:21],v72,50352
v_accvgpr_read_b32 v250,a62
MA a[76:79],v[24:27],v[212:215],a[76:79]
RT v[22:23],v72,52144
WL 6
MA a[80:83],v[28:31],v[208:211],a[80:83]
RT v[24:25],v72,50384
v_accvgpr_read_b32 v251,a63
MA a[84:87],v[28:31],v[212:215],a[84:87]
RT v[26:27],v72,52176
v_mul_f32 v244,v244,v226
MA a[88:91],v[32:35],v[208:211],a[88:91]
RT v[28:29],v72,57344
v_mul_f32 v245,v245,v227
MA a[92:95],v[32:35],v[212:215],a[92:95]
RT v[30:31],v72,59136
WL 6
MA a[96:99],v[12:15],v[208:211],a[96:99]
RT v[32:33],v72,57384
v_mul_f32 v246,v246,v228
MA a[100:103],v[12:15],v[212:215],a[100:103]
RT v[34:35],v72,59176
v_mul_f32 v247,v247,v229
MA a[104:107],v[208:211],v[16:19],a[104:107]
RT v[12:13],v72,57416
v_mul_f32 v248,v248,v230
MA a[108:111],v[212:215],v[16:19],a[108:111]
RT v[14:15],v72,59208
WL 6
MA a[112:115],v[208:211],v[20:23],a[112:115]
RT v[16:17],v72,57456
v_mul_f32 v249,v249,v231
MA a[116:119],v[212:215],v[20:23],a[116:119]
RT v[18:19],v72,59248
v_mul_f32 v250,v250,v232
MA a[120:123],v[208:211],v[24:27],a[120:123]
RT v[20:21],v73,57344
v_mul_f32 v251,v251,v233
MA a[124:127],v[212:215],v[24:27],a[124:127]
RT v[22:23],v73,59136
WL 6
MA a[64:67],v[28:31],v[216:219],a[64:67]
RT v[24:25],v72,57488
CV v240,v244,v245
MA a[68:71],v[28:31],v[220:223],a[68:71]
RT v[26:27],v72,59280
CV v241,v246,v247
MA a[72:75],v[32:35],v[216:219],a[72:75]
RT v[28:29],v72,57520
CV v242,v248,v249
MA a[76:79],v[32:35],v[220:223],a[76:79]
RT v[30:31],v72,59312
WL 6
MA a[80:83],v[12:15],v[216:219],a[80:83]
RT v[32:33],v72,57552
CV v243,v250,v251
MA a[84:87],v[12:15],v[220:223],a[84:87]
RT v[34:35],v72,59344
buffer_store_dwordx4 v[240:243],v238,s[40:43],s88 offen sc1
MA a[88:91],v[16:19],v[216:219],a[88:91]
MA a[92:95],v[16:19],v[220:223],a[92:95]
WL 4
MA a[96:99],v[20:23],v[216:219],a[96:99]
MA a[100:103],v[20:23],v[220:223],a[100:103]
MA a[104:107],v[216:219],v[24:27],a[104:107]
MA a[108:111],v[220:223],v[24:27],a[108:111]
WL 0
MA a[112:115],v[216:219],v[28:31],a[112:115]
MA a[116:119],v[220:223],v[28:31],a[116:119]
MA a[120:123],v[216:219],v[32:35],a[120:123]
MA a[124:127],v[220:223],v[32:35],a[124:127]
s_nop 7
v_accvgpr_read_b32 v244,a64
v_accvgpr_read_b32 v245,a65
v_accvgpr_read_b32 v246,a66
v_accvgpr_read_b32 v247,a67
v_accvgpr_read_b32 v248,a68
v_accvgpr_read_b32 v249,a69
v_accvgpr_read_b32 v250,a70
v_accvgpr_read_b32 v251,a71
v_mul_f32 v244,v244,v7
v_mul_f32 v245,v245,v7
v_mul_f32 v246,v246,v7
v_mul_f32 v247,v247,v7
v_mul_f32 v248,v248,v8
v_mul_f32 v249,v249,v8
v_mul_f32 v250,v250,v8
v_mul_f32 v251,v251,v8
CV v240,v244,v245
CV v241,v246,v247
CV v242,v248,v249
CV v243,v250,v251
s_add_u32 s88,s84,2097152
s_nop 0
v_permlane16_swap_b32 v240,v242
v_permlane16_swap_b32 v241,v243
buffer_store_dwordx4 v[240:243],v234,s[40:43],s88 offen sc1
v_accvgpr_read_b32 v244,a72
v_accvgpr_read_b32 v245,a73
v_accvgpr_read_b32 v246,a74
v_accvgpr_read_b32 v247,a75
v_accvgpr_read_b32 v248,a76
v_accvgpr_read_b32 v249,a77
v_accvgpr_read_b32 v250,a78
v_accvgpr_read_b32 v251,a79
v_mul_f32 v244,v244,v7
v_mul_f32 v245,v245,v7
v_mul_f32 v246,v246,v7
v_mul_f32 v247,v247,v7
v_mul_f32 v248,v248,v8
v_mul_f32 v249,v249,v8
v_mul_f32 v250,v250,v8
v_mul_f32 v251,v251,v8
CV v240,v244,v245
CV v241,v246,v247
CV v242,v248,v249
CV v243,v250,v251
s_add_u32 s88,s84,2162688
s_nop 0
v_permlane16_swap_b32 v240,v242
v_permlane16_swap_b32 v241,v243
buffer_store_dwordx4 v[240:243],v234,s[40:43],s88 offen sc1
v_accvgpr_read_b32 v244,a80
v_accvgpr_read_b32 v245,a81
v_accvgpr_read_b32 v246,a82
v_accvgpr_read_b32 v247,a83
v_accvgpr_read_b32 v248,a84
v_accvgpr_read_b32 v249,a85
v_accvgpr_read_b32 v250,a86
v_accvgpr_read_b32 v251,a87
v_mul_f32 v244,v244,v7
v_mul_f32 v245,v245,v7
v_mul_f32 v246,v246,v7
v_mul_f32 v247,v247,v7
v_mul_f32 v248,v248,v8
v_mul_f32 v249,v249,v8
v_mul_f32 v250,v250,v8
v_mul_f32 v251,v251,v8
CV v240,v244,v245
CV v241,v246,v247
CV v242,v248,v249
CV v243,v250,v251
s_add_u32 s88,s84,2228224
s_nop 0
v_permlane16_swap_b32 v240,v242
v_permlane16_swap_b32 v241,v243
buffer_store_dwordx4 v[240:243],v234,s[40:43],s88 offen sc1
v_accvgpr_read_b32 v244,a88
v_accvgpr_read_b32 v245,a89
v_accvgpr_read_b32 v246,a90
v_accvgpr_read_b32 v247,a91
v_accvgpr_read_b32 v248,a92
v_accvgpr_read_b32 v249,a93
v_accvgpr_read_b32 v250,a94
v_accvgpr_read_b32 v251,a95
v_mul_f32 v244,v244,v7
v_mul_f32 v245,v245,v7
v_mul_f32 v246,v246,v7
v_mul_f32 v247,v247,v7
v_mul_f32 v248,v248,v8
v_mul_f32 v249,v249,v8
v_mul_f32 v250,v250,v8
v_mul_f32 v251,v251,v8
CV v240,v244,v245
CV v241,v246,v247
CV v242,v248,v249
CV v243,v250,v251
s_add_u32 s88,s84,2293760
s_nop 0
v_permlane16_swap_b32 v240,v242
v_permlane16_swap_b32 v241,v243
buffer_store_dwordx4 v[240:243],v234,s[40:43],s88 offen sc1
v_accvgpr_read_b32 v244,a96
v_accvgpr_read_b32 v245,a97
v_accvgpr_read_b32 v246,a98
v_accvgpr_read_b32 v247,a99
v_accvgpr_read_b32 v248,a100
v_accvgpr_read_b32 v249,a101
v_accvgpr_read_b32 v250,a102
v_accvgpr_read_b32 v251,a103
v_mul_f32 v244,v244,v7
v_mul_f32 v245,v245,v7
v_mul_f32 v246,v246,v7
v_mul_f32 v247,v247,v7
v_mul_f32 v248,v248,v8
v_mul_f32 v249,v249,v8
v_mul_f32 v250,v250,v8
v_mul_f32 v251,v251,v8
CV v240,v244,v245
CV v241,v246,v247
CV v242,v248,v249
CV v243,v250,v251
s_add_u32 s88,s85,262144
s_add_u32 s89,s85,270336
buffer_store_dword v240,v235,s[40:43],s88 offen offset:0 sc1
buffer_store_dword v241,v235,s[40:43],s89 offen offset:0 sc1
buffer_store_dword v242,v235,s[40:43],s88 offen offset:64 sc1
buffer_store_dword v243,v235,s[40:43],s89 offen offset:64 sc1
s_add_u32 s88,s86,163840
v_accvgpr_read_b32 v244,a104
v_accvgpr_read_b32 v245,a105
v_accvgpr_read_b32 v246,a106
v_accvgpr_read_b32 v247,a107
v_accvgpr_read_b32 v248,a108
v_accvgpr_read_b32 v249,a109
v_accvgpr_read_b32 v250,a110
v_accvgpr_read_b32 v251,a111
v_mul_f32 v244,v244,v226
v_mul_f32 v245,v245,v227
v_mul_f32 v246,v246,v228
v_mul_f32 v247,v247,v229
v_mul_f32 v248,v248,v230
v_mul_f32 v249,v249,v231
v_mul_f32 v250,v250,v232
v_mul_f32 v251,v251,v233
CV v240,v244,v245
CV v241,v246,v247
CV v242,v248,v249
CV v243,v250,v251
buffer_store_dwordx4 v[240:243],v236,s[40:43],s88 offen sc1
v_accvgpr_read_b32 v244,a112
v_accvgpr_read_b32 v245,a113
v_accvgpr_read_b32 v246,a114
v_accvgpr_read_b32 v247,a115
v_accvgpr_read_b32 v248,a116
v_accvgpr_read_b32 v249,a117
v_accvgpr_read_b32 v250,a118
v_accvgpr_read_b32 v251,a119
v_mul_f32 v244,v244,v226
v_mul_f32 v245,v245,v227
v_mul_f32 v246,v246,v228
v_mul_f32 v247,v247,v229
v_mul_f32 v248,v248,v230
v_mul_f32 v249,v249,v231
v_mul_f32 v250,v250,v232
v_mul_f32 v251,v251,v233
CV v240,v244,v245
CV v241,v246,v247
CV v242,v248,v249
CV v243,v250,v251
buffer_store_dwordx4 v[240:243],v237,s[40:43],s88 offen sc1
v_accvgpr_read_b32 v244,a120
v_accvgpr_read_b32 v245,a121
v_accvgpr_read_b32 v246,a122
v_accvgpr_read_b32 v247,a123
v_accvgpr_read_b32 v248,a124
v_accvgpr_read_b32 v249,a125
v_accvgpr_read_b32 v250,a126
v_accvgpr_read_b32 v251,a127
v_mul_f32 v244,v244,v226
v_mul_f32 v245,v245,v227
v_mul_f32 v246,v246,v228
v_mul_f32 v247,v247,v229
v_mul_f32 v248,v248,v230
v_mul_f32 v249,v249,v231
v_mul_f32 v250,v250,v232
v_mul_f32 v251,v251,v233
CV v240,v244,v245
CV v241,v246,v247
CV v242,v248,v249
CV v243,v250,v251
buffer_store_dwordx4 v[240:243],v238,s[40:43],s88 offen sc1
s_waitcnt vmcnt(0)
s_barrier
s_lshl_b32 s73,s64,2
buffer_atomic_add v254,v255,s[80:83],s73 offen sc0
s_cmp_lg_u32 s3,0
s_cbranch_scc1 L_qkv_notlast
s_waitcnt vmcnt(0)
v_readfirstlane_b32 s72,v254
s_cmp_lg_u32 s72,15
s_cbranch_scc1 L_qkv_notlast
v_mov_b32 v9,1
s_add_u32 s72,s64,8
s_lshl_b32 s72,s72,10
s_add_u32 s72,s72,53739528
v_lshlrev_b32 v10,14,v252
v_lshrrev_b32 v11,4,v252
v_min_u32 v11,1,v11
v_lshl_or_b32 v10,v11,31,v10
buffer_store_dword v9,v10,s[40:43],s72 offen sc1
L_qkv_notlast:
s_load_dwordx2 s[6:7],s[0:1],0
s_load_dwordx2 s[8:9],s[0:1],16
s_load_dwordx2 s[10:11],s[0:1],56
v_mbcnt_lo_u32_b32 v90,-1,0
v_mbcnt_hi_u32_b32 v90,-1,v90
v_add_u32 v100,s3,v90
v_min_u32 v100,1,v100
v_lshlrev_b32 v100,31,v100
v_mov_b32 v99,1
s_lshr_b32 s48,s2,4
s_cmp_ge_u32 s48,9
s_cselect_b32 s49,1,0
s_mul_i32 s50,s49,9
s_sub_u32 s59,s48,s50
s_bfe_u32 s50,s2,0x10003
s_xor_b32 s50,s50,1
s_or_b32 s49,s49,s50
s_and_b32 s58,s2,7
s_lshl_b32 s58,s58,1
s_add_u32 s58,s58,s49
v_and_b32 v10,31,v90
v_lshlrev_b32 v10,3,v10
v_lshrrev_b32 v11,5,v90
v_mul_u32_u24 v11,36864,v11
v_add_u32 v91,v10,v11
v_lshrrev_b32 v12,4,v90
v_lshlrev_b32 v12,5,v12
v_and_b32 v13,1,v90
v_lshl_add_u32 v12,v13,4,v12
s_lshl_b32 s48,s59,7
v_add_u32 v12,s48,v12
v_bfe_u32 v10,v90,3,1
v_bfe_u32 v11,v90,1,2
v_lshl_add_u32 v13,v10,3,v11
v_mul_u32_u24 v13,1152,v13
v_add_u32 v92,v13,v12
v_lshrrev_b32 v13,1,v11
v_lshl_add_u32 v13,v10,2,v13
v_mul_u32_u24 v13,18,v13
v_and_b32 v11,1,v11
v_add_u32 v13,v13,v11
v_mul_u32_u24 v13,1152,v13
v_add_u32 v93,v13,v12
s_and_b32 s52,s3,1
s_cmp_eq_u32 s52,1
s_cselect_b64 vcc,-1,0
v_cndmask_b32 v93,v92,v93,vcc
s_mul_i32 s65,s3,18432
v_lshrrev_b32 v10,5,v90
v_lshlrev_b32 v10,16,v10
v_and_b32 v11,15,v90
v_lshl_add_u32 v10,v11,5,v10
v_bfe_u32 v12,v90,4,1
v_lshl_add_u32 v94,v12,4,v10
v_lshlrev_b32 v10,7,v11
v_lshrrev_b32 v12,4,v90
v_lshl_add_u32 v95,v12,4,v10
v_lshlrev_b32 v96,4,v90
s_lshl_b32 s48,s58,7
s_lshl_b32 s49,s3,5
s_add_u32 s48,s48,s49
s_lshl_b32 s66,s48,5
s_add_u32 s66,s66,51380224
s_lshl_b32 s67,s48,7
s_add_u32 s67,s67,53477376
s_mul_i32 s69,s48,1152
s_lshl_b32 s49,s59,7
s_add_u32 s69,s69,s49
s_lshl_b32 s68,s58,2
s_add_u32 s68,s68,s3
s_mul_i32 s68,s68,36
s_lshl_b32 s49,s59,2
s_add_u32 s68,s68,s49
s_lshl_b32 s68,s68,10
s_add_u32 s68,s68,8388608
v_and_b32 v10,15,v90
v_mul_u32_u24 v10,1152,v10
v_lshrrev_b32 v11,4,v90
v_lshl_add_u32 v97,v11,3,v10
v_and_b32 v12,1,v11
v_lshl_add_u32 v10,v12,5,v10
v_lshrrev_b32 v11,1,v11
v_lshl_add_u32 v98,v11,4,v10
s_lshr_b32 s51,s3,1
s_mul_i32 s90,s51,18
s_mul_i32 s53,s52,324
s_add_u32 s90,s90,s53
s_mul_i32 s90,s90,1152
s_mul_i32 s53,s51,165888
s_add_u32 s54,s90,290304
s_add_u32 s55,s53,18432
s_cmp_eq_u32 s52,1
s_cselect_b32 s84,s55,s54
s_add_u32 s54,s90,294912
s_add_u32 s55,s53,59904
s_cmp_eq_u32 s52,1
s_cselect_b32 s85,s55,s54
s_add_u32 s54,s90,331776
s_add_u32 s55,s53,350208
s_cmp_eq_u32 s52,1
s_cselect_b32 s86,s55,s54
s_add_u32 s54,s90,336384
s_add_u32 s55,s53,391680
s_cmp_eq_u32 s52,1
s_cselect_b32 s87,s55,s54
s_mov_b32 s70,0x00003f80
s_mov_b32 s71,0x3f800000
WL 0
s_mov_b32 s28,s8
s_mov_b32 s29,s9
s_mov_b32 s30,663552
s_mov_b32 s31,0x20000
s_mov_b32 s20,s6
s_mov_b32 s21,s7
s_mov_b32 s22,2359296
s_mov_b32 s23,0x20000
s_mov_b32 s32,s10
s_mov_b32 s33,s11
s_mov_b32 s34,2359296
s_mov_b32 s35,0x20000
s_lshl_b32 s44,s64,2
s_lshr_b32 s72,s4,2
s_add_u32 s44,s44,s72
s_and_b32 s45,s4,3
s_add_u32 s72,s44,32
s_lshl_b32 s46,s72,16
s_lshl_b32 s49,s3,12
s_add_u32 s46,s46,s49
s_mul_i32 s47,s44,81920
s_mul_i32 s50,s3,5120
s_add_u32 s47,s47,s50
s_add_u32 s47,s47,5242880
s_add_u32 s50,s50,65536
s_lshl_b32 s48,s72,13
s_lshl_b32 s51,s3,9
s_add_u32 s48,s48,s51
s_add_u32 s48,s48,4194304
s_add_u32 s51,s51,147456
s_lshl_b32 s72,s45,4
s_lshl_b32 s73,s3,1
s_add_u32 s72,s72,s73
s_lshl_b32 s53,s44,16
s_lshl_b32 s73,s72,10
s_add_u32 s53,s53,s73
s_lshl_b32 s54,s44,13
s_lshl_b32 s73,s72,7
s_add_u32 s54,s54,s73
s_add_u32 s54,s54,4194304
s_lshl_b32 s57,s44,16
s_lshl_b32 s73,s72,10
s_add_u32 s57,s57,s73
s_add_u32 s57,s57,51380224
s_lshl_b32 s58,s72,12
s_lshl_b32 s73,s44,2
s_add_u32 s58,s58,s73
s_add_u32 s58,s58,53477376
s_mov_b32 s52,0
s_mov_b32 s62,0
s_mov_b32 s55,0
v_mov_b32 v75,0
v_mbcnt_lo_u32_b32 v76,-1,0
v_mbcnt_hi_u32_b32 v76,-1,v76
v_lshlrev_b32 v52,4,v76
v_and_b32 v54,3,v76
v_lshlrev_b32 v54,5,v54
v_lshrrev_b32 v55,2,v76
v_add_u32 v54,v54,v55
v_lshlrev_b32 v53,2,v54
v_and_b32 v54,7,v76
v_bfe_u32 v55,v76,3,1
v_lshl_or_b32 v54,v55,4,v54
v_bfe_u32 v55,v76,4,1
v_lshl_or_b32 v54,v55,3,v54
v_lshlrev_b32 v54,4,v54
v_lshrrev_b32 v55,5,v76
v_lshl_add_u32 v48,v55,9,v54
v_add_u32 v54,147456,v54
v_mov_b32 v56,155648
v_cmp_eq_u32 vcc,0,v55
v_mov_b32 v57,512
v_mov_b32 v58,0
v_cndmask_b32 v49,v56,v54,vcc
v_cndmask_b32 v50,v58,v57,vcc
v_and_b32 v54,31,v76
v_min_u32 v54,19,v54
v_lshlrev_b32 v54,6,v54
v_lshl_add_u32 v54,v55,4,v54
v_add_u32 v51,65536,v54
v_mov_b32 v79,0x80000000
v_cmp_eq_u32 vcc,0,v76
s_cmp_eq_u32 s3,0
s_nop 1
s_cselect_b64 s[72:73],vcc,0
v_cndmask_b32 v79,v79,v75,s[72:73]
v_mov_b32 v54,155648
v_mov_b32 v0,0x3f803f80
v_mov_b32 v1,0x3f803f80
v_mov_b32 v2,0x3f803f80
v_mov_b32 v3,0x3f803f80
ds_write_b128 v54,v[0:3]
s_lshl_b32 s73,s2,10
s_add_u32 s73,s73,53739528
s_cmp_lg_u32 s3,0
s_cbranch_scc1 L_pollok_qkv
s_mov_b32 s61,0
L_poll_qkv:
buffer_load_dword v74,v79,s[40:43],s73 offen sc1
s_waitcnt vmcnt(0)
v_readfirstlane_b32 s72,v74
s_add_u32 s61,s61,1
s_cmp_lg_u32 s72,0
s_cbranch_scc1 L_pollok_qkv
s_cmp_lt_u32 s61,0x8000
s_cbranch_scc1 L_poll_qkv
L_pollok_qkv:
WL 0
s_barrier
s_add_u32 m0,s49,0
s_add_u32 s88,s46,0
buffer_load_dwordx4 v52,s[40:43],s88 offen offset:0 sc1 lds
buffer_load_dwordx4 v52,s[40:43],s88 offen offset:1024 sc1 lds
buffer_load_dwordx4 v52,s[40:43],s88 offen offset:2048 sc1 lds
buffer_load_dwordx4 v52,s[40:43],s88 offen offset:3072 sc1 lds
s_add_u32 m0,s50,0
s_add_u32 s88,s47,0
buffer_load_dwordx4 v52,s[40:43],s88 offen offset:0 sc1 lds
buffer_load_dwordx4 v52,s[40:43],s88 offen offset:1024 sc1 lds
buffer_load_dwordx4 v52,s[40:43],s88 offen offset:2048 sc1 lds
buffer_load_dwordx4 v52,s[40:43],s88 offen offset:3072 sc1 lds
s_add_u32 m0,s50,4096
s_add_u32 s88,s47,4096
buffer_load_dwordx4 v52,s[40:43],s88 offen sc1 lds
s_add_u32 m0,s51,0
s_add_u32 s88,s48,0
buffer_load_dword v53,s[40:43],s88 offen sc1 lds
s_add_u32 m0,s51,256
s_add_u32 s88,s48,64
buffer_load_dword v53,s[40:43],s88 offen sc1 lds
v_and_b32 v54,31,v76
v_lshlrev_b32 v54,2,v54
s_add_u32 s72,s53,0
s_add_u32 s73,s54,0
buffer_load_dwordx4 v[62:65],v52,s[40:43],s72 offen sc1
buffer_load_dwordx4 v[66:69],v52,s[40:43],s72 offen offset:1024 sc1
buffer_load_dword v70,v54,s[40:43],s73 offen sc1
buffer_load_dword v71,v54,s[40:43],s73 offen offset:128 sc1
s_waitcnt vmcnt(0)
s_barrier
L_attn_pass:
ds_read_b128 a[40:43],v48 offset:0
ds_read_b128 a[48:51],v49
v_accvgpr_write_b32 a0,v62
v_accvgpr_write_b32 a4,v66
v_accvgpr_write_b32 a1,v63
v_accvgpr_write_b32 a5,v67
v_accvgpr_write_b32 a2,v64
v_accvgpr_write_b32 a6,v68
v_accvgpr_write_b32 a3,v65
v_accvgpr_write_b32 a7,v69
v_mbcnt_lo_u32_b32 v54,-1,0
v_mbcnt_hi_u32_b32 v54,-1,v54
v_cmp_gt_u32 vcc,32,v54
v_mov_b32 v55,0
s_nop 0
v_cndmask_b32 v56,v55,v70,vcc
v_cndmask_b32 v57,v55,v71,vcc
v_accvgpr_write_b32 a8,v56
v_accvgpr_write_b32 a9,v55
v_accvgpr_write_b32 a10,v55
v_accvgpr_write_b32 a11,v55
v_accvgpr_write_b32 a12,v55
v_accvgpr_write_b32 a13,v56
v_accvgpr_write_b32 a14,v55
v_accvgpr_write_b32 a15,v55
v_accvgpr_write_b32 a16,v55
v_accvgpr_write_b32 a17,v55
v_accvgpr_write_b32 a18,v56
v_accvgpr_write_b32 a19,v55
v_accvgpr_write_b32 a20,v55
v_accvgpr_write_b32 a21,v55
v_accvgpr_write_b32 a22,v55
v_accvgpr_write_b32 a23,v56
v_accvgpr_write_b32 a24,v57
v_accvgpr_write_b32 a25,v55
v_accvgpr_write_b32 a26,v55
v_accvgpr_write_b32 a27,v55
v_accvgpr_write_b32 a28,v55
v_accvgpr_write_b32 a29,v57
v_accvgpr_write_b32 a30,v55
v_accvgpr_write_b32 a31,v55
v_accvgpr_write_b32 a32,v55
v_accvgpr_write_b32 a33,v55
v_accvgpr_write_b32 a34,v57
v_accvgpr_write_b32 a35,v55
v_accvgpr_write_b32 a36,v55
v_accvgpr_write_b32 a37,v55
v_accvgpr_write_b32 a38,v55
v_accvgpr_write_b32 a39,v57
WL 0
MB v[0:15],a[40:43],a[0:3],0
MB v[0:15],a[48:51],a[8:11],v[0:15]
MB v[16:31],a[40:43],a[4:7],0
MB v[16:31],a[48:51],a[24:27],v[16:31]
s_nop 7
s_nop 3
v_max3_f32 v72,v0,v1,v2
v_max3_f32 v72,v72,v3,v4
v_max3_f32 v72,v72,v5,v6
v_max3_f32 v72,v72,v7,v8
v_max3_f32 v72,v72,v9,v10
v_max3_f32 v72,v72,v11,v12
v_max3_f32 v72,v72,v13,v14
v_max_f32 v72,v72,v15
v_mov_b32 v54,v72
s_nop 1
v_permlane32_swap_b32 v72,v54
s_nop 1
v_max_f32 v72,v72,v54
v_max3_f32 v73,v16,v17,v18
v_max3_f32 v73,v73,v19,v20
v_max3_f32 v73,v73,v21,v22
v_max3_f32 v73,v73,v23,v24
v_max3_f32 v73,v73,v25,v26
v_max3_f32 v73,v73,v27,v28
v_max3_f32 v73,v73,v29,v30
v_max_f32 v73,v73,v31
v_mov_b32 v54,v73
s_nop 1
v_permlane32_swap_b32 v73,v54
s_nop 1
v_max_f32 v73,v73,v54
v_sub_f32 v72,0,v72
CV v54,v72,v72
v_lshlrev_b32 v54,16,v54
v_sub_f32 v72,v72,v54
CV v72,v54,v72
v_sub_f32 v73,0,v73
CV v54,v73,v73
v_lshlrev_b32 v54,16,v54
v_sub_f32 v73,v73,v54
CV v73,v54,v73
v_mbcnt_lo_u32_b32 v54,-1,0
v_mbcnt_hi_u32_b32 v54,-1,v54
v_cmp_gt_u32 vcc,32,v54
v_mov_b32 v55,0
s_nop 0
v_cndmask_b32 v56,v72,v70,vcc
v_cndmask_b32 v57,v73,v71,vcc
v_accvgpr_write_b32 a8,v56
v_accvgpr_write_b32 a9,v55
v_accvgpr_write_b32 a10,v55
v_accvgpr_write_b32 a11,v55
v_accvgpr_write_b32 a12,v55
v_accvgpr_write_b32 a13,v56
v_accvgpr_write_b32 a14,v55
v_accvgpr_write_b32 a15,v55
v_accvgpr_write_b32 a16,v55
v_accvgpr_write_b32 a17,v55
v_accvgpr_write_b32 a18,v56
v_accvgpr_write_b32 a19,v55
v_accvgpr_write_b32 a20,v55
v_accvgpr_write_b32 a21,v55
v_accvgpr_write_b32 a22,v55
v_accvgpr_write_b32 a23,v56
v_accvgpr_write_b32 a24,v57
v_accvgpr_write_b32 a25,v55
v_accvgpr_write_b32 a26,v55
v_accvgpr_write_b32 a27,v55
v_accvgpr_write_b32 a28,v55
v_accvgpr_write_b32 a29,v57
v_accvgpr_write_b32 a30,v55
v_accvgpr_write_b32 a31,v55
v_accvgpr_write_b32 a32,v55
v_accvgpr_write_b32 a33,v55
v_accvgpr_write_b32 a34,v57
v_accvgpr_write_b32 a35,v55
v_accvgpr_write_b32 a36,v55
v_accvgpr_write_b32 a37,v55
v_accvgpr_write_b32 a38,v55
v_accvgpr_write_b32 a39,v57
L_attn_main:
v_accvgpr_write_b32 a72,0
v_accvgpr_write_b32 a88,0
v_accvgpr_write_b32 a73,0
v_accvgpr_write_b32 a89,0
v_accvgpr_write_b32 a74,0
v_accvgpr_write_b32 a90,0
v_accvgpr_write_b32 a75,0
v_accvgpr_write_b32 a91,0
v_accvgpr_write_b32 a76,0
v_accvgpr_write_b32 a92,0
v_accvgpr_write_b32 a77,0
v_accvgpr_write_b32 a93,0
v_accvgpr_write_b32 a78,0
v_accvgpr_write_b32 a94,0
v_accvgpr_write_b32 a79,0
v_accvgpr_write_b32 a95,0
v_accvgpr_write_b32 a80,0
v_accvgpr_write_b32 a96,0
v_accvgpr_write_b32 a81,0
v_accvgpr_write_b32 a97,0
v_accvgpr_write_b32 a82,0
v_accvgpr_write_b32 a98,0
v_accvgpr_write_b32 a83,0
v_accvgpr_write_b32 a99,0
v_accvgpr_write_b32 a84,0
v_accvgpr_write_b32 a100,0
v_accvgpr_write_b32 a85,0
v_accvgpr_write_b32 a101,0
v_accvgpr_write_b32 a86,0
v_accvgpr_write_b32 a102,0
v_accvgpr_write_b32 a87,0
v_accvgpr_write_b32 a103,0
v_accvgpr_write_b32 a64,0
v_accvgpr_write_b32 a65,0
v_accvgpr_write_b32 a66,0
v_accvgpr_write_b32 a67,0
v_accvgpr_write_b32 a68,0
v_accvgpr_write_b32 a69,0
v_accvgpr_write_b32 a70,0
v_accvgpr_write_b32 a71,0
MB v[0:15],a[40:43],a[0:3],0
MB v[0:15],a[48:51],a[8:11],v[0:15]
v_mov_b32 v40,0
v_mov_b32 v41,0
v_mov_b32 v42,0
v_mov_b32 v43,0
v_mov_b32 v44,0
v_mov_b32 v45,0
v_mov_b32 v46,0
v_mov_b32 v30,0
v_mov_b32 v31,0
s_mov_b32 s56,0
s_cmp_lg_u32 s62,0
s_mov_b32 s59,0
s_cselect_b32 s59,99,s59
s_nop 3
L_attn_loop:
s_cmp_eq_u32 s56,s59
s_cbranch_scc1 L_attn_sync
L_attn_back:
v_exp_f32 v0,v0
v_exp_f32 v1,v1
CV v47,v30,v31
MB v[16:31],a[40:43],a[4:7],0
ds_read_b128 a[44:47],v48 offset:1024
v_exp_f32 v2,v2
v_exp_f32 v3,v3
CV v32,v0,v1
v_exp_f32 v4,v4
v_exp_f32 v5,v5
CV v33,v2,v3
MB v[16:31],a[48:51],a[24:27],v[16:31]
ds_read_b128 a[56:59],v51 offset:0
ds_read_b128 a[60:63],v51 offset:32
v_exp_f32 v6,v6
v_exp_f32 v7,v7
CV v34,v4,v5
v_exp_f32 v8,v8
v_exp_f32 v9,v9
CV v35,v6,v7
MB a[88:103],a[64:67],v[40:43],a[88:103]
v_exp_f32 v10,v10
v_exp_f32 v11,v11
CV v36,v8,v9
v_exp_f32 v12,v12
v_exp_f32 v13,v13
CV v37,v10,v11
MB a[88:103],a[68:71],v[44:47],a[88:103]
v_exp_f32 v14,v14
v_exp_f32 v15,v15
CV v38,v12,v13
WL 0
v_exp_f32 v16,v16
v_exp_f32 v17,v17
CV v39,v14,v15
MB v[0:15],a[44:47],a[0:3],0
v_exp_f32 v18,v18
v_exp_f32 v19,v19
CV v40,v16,v17
v_exp_f32 v20,v20
v_exp_f32 v21,v21
CV v41,v18,v19
MB v[0:15],a[48:51],a[12:15],v[0:15]
v_exp_f32 v22,v22
v_exp_f32 v23,v23
CV v42,v20,v21
v_exp_f32 v24,v24
v_exp_f32 v25,v25
CV v43,v22,v23
MB a[72:87],a[56:59],v[32:35],a[72:87]
v_exp_f32 v26,v26
v_exp_f32 v27,v27
CV v44,v24,v25
v_exp_f32 v28,v28
v_exp_f32 v29,v29
CV v45,v26,v27
MB a[72:87],a[60:63],v[36:39],a[72:87]
v_exp_f32 v30,v30
v_exp_f32 v31,v31
CV v46,v28,v29
v_exp_f32 v0,v0
v_exp_f32 v1,v1
CV v47,v30,v31
MB v[16:31],a[44:47],a[4:7],0
ds_read_b128 a[40:43],v48 offset:2048
v_exp_f32 v2,v2
v_exp_f32 v3,v3
CV v32,v0,v1
v_exp_f32 v4,v4
v_exp_f32 v5,v5
CV v33,v2,v3
MB v[16:31],a[48:51],a[28:31],v[16:31]
ds_read_b128 a[64:67],v51 offset:1280
ds_read_b128 a[68:71],v51 offset:1312
v_exp_f32 v6,v6
v_exp_f32 v7,v7
CV v34,v4,v5
v_exp_f32 v8,v8
v_exp_f32 v9,v9
CV v35,v6,v7
MB a[88:103],a[56:59],v[40:43],a[88:103]
v_exp_f32 v10,v10
v_exp_f32 v11,v11
CV v36,v8,v9
v_exp_f32 v12,v12
v_exp_f32 v13,v13
CV v37,v10,v11
MB a[88:103],a[60:63],v[44:47],a[88:103]
v_exp_f32 v14,v14
v_exp_f32 v15,v15
CV v38,v12,v13
WL 0
v_exp_f32 v16,v16
v_exp_f32 v17,v17
CV v39,v14,v15
MB v[0:15],a[40:43],a[0:3],0
v_exp_f32 v18,v18
v_exp_f32 v19,v19
CV v40,v16,v17
v_exp_f32 v20,v20
v_exp_f32 v21,v21
CV v41,v18,v19
MB v[0:15],a[48:51],a[16:19],v[0:15]
v_exp_f32 v22,v22
v_exp_f32 v23,v23
CV v42,v20,v21
v_exp_f32 v24,v24
v_exp_f32 v25,v25
CV v43,v22,v23
MB a[72:87],a[64:67],v[32:35],a[72:87]
v_exp_f32 v26,v26
v_exp_f32 v27,v27
CV v44,v24,v25
v_exp_f32 v28,v28
v_exp_f32 v29,v29
CV v45,v26,v27
MB a[72:87],a[68:71],v[36:39],a[72:87]
v_exp_f32 v30,v30
v_exp_f32 v31,v31
CV v46,v28,v29
v_exp_f32 v0,v0
v_exp_f32 v1,v1
CV v47,v30,v31
MB v[16:31],a[40:43],a[4:7],0
ds_read_b128 a[44:47],v48 offset:3072
v_exp_f32 v2,v2
v_exp_f32 v3,v3
CV v32,v0,v1
v_exp_f32 v4,v4
v_exp_f32 v5,v5
CV v33,v2,v3
MB v[16:31],a[48:51],a[32:35],v[16:31]
ds_read_b128 a[56:59],v51 offset:2560
ds_read_b128 a[60:63],v51 offset:2592
v_exp_f32 v6,v6
v_exp_f32 v7,v7
CV v34,v4,v5
v_exp_f32 v8,v8
v_exp_f32 v9,v9
CV v35,v6,v7
MB a[88:103],a[64:67],v[40:43],a[88:103]
v_exp_f32 v10,v10
v_exp_f32 v11,v11
CV v36,v8,v9
v_exp_f32 v12,v12
v_exp_f32 v13,v13
CV v37,v10,v11
MB a[88:103],a[68:71],v[44:47],a[88:103]
v_exp_f32 v14,v14
v_exp_f32 v15,v15
CV v38,v12,v13
WL 0
v_exp_f32 v16,v16
v_exp_f32 v17,v17
CV v39,v14,v15
MB v[0:15],a[44:47],a[0:3],0
v_exp_f32 v18,v18
v_exp_f32 v19,v19
CV v40,v16,v17
v_exp_f32 v20,v20
v_exp_f32 v21,v21
CV v41,v18,v19
MB v[0:15],a[48:51],a[20:23],v[0:15]
v_exp_f32 v22,v22
v_exp_f32 v23,v23
CV v42,v20,v21
v_exp_f32 v24,v24
v_exp_f32 v25,v25
CV v43,v22,v23
MB a[72:87],a[56:59],v[32:35],a[72:87]
v_exp_f32 v26,v26
v_exp_f32 v27,v27
CV v44,v24,v25
v_exp_f32 v28,v28
v_exp_f32 v29,v29
CV v45,v26,v27
MB a[72:87],a[60:63],v[36:39],a[72:87]
v_exp_f32 v30,v30
v_exp_f32 v31,v31
CV v46,v28,v29
v_exp_f32 v0,v0
v_exp_f32 v1,v1
CV v47,v30,v31
MB v[16:31],a[44:47],a[4:7],0
ds_read_b128 a[40:43],v48 offset:4096
v_exp_f32 v2,v2
v_exp_f32 v3,v3
CV v32,v0,v1
v_exp_f32 v4,v4
v_exp_f32 v5,v5
CV v33,v2,v3
MB v[16:31],a[48:51],a[36:39],v[16:31]
v_add_u32 v49,v49,v50
ds_read_b128 a[48:51],v49
ds_read_b128 a[64:67],v51 offset:3840
ds_read_b128 a[68:71],v51 offset:3872
v_exp_f32 v6,v6
v_exp_f32 v7,v7
CV v34,v4,v5
v_exp_f32 v8,v8
v_exp_f32 v9,v9
CV v35,v6,v7
MB a[88:103],a[56:59],v[40:43],a[88:103]
v_exp_f32 v10,v10
v_exp_f32 v11,v11
CV v36,v8,v9
v_exp_f32 v12,v12
v_exp_f32 v13,v13
CV v37,v10,v11
MB a[88:103],a[60:63],v[44:47],a[88:103]
v_exp_f32 v14,v14
v_exp_f32 v15,v15
CV v38,v12,v13
WL 0
v_exp_f32 v16,v16
v_exp_f32 v17,v17
CV v39,v14,v15
MB v[0:15],a[40:43],a[0:3],0
v_add_u32 v48,4096,v48
v_exp_f32 v18,v18
v_exp_f32 v19,v19
CV v40,v16,v17
v_exp_f32 v20,v20
v_exp_f32 v21,v21
CV v41,v18,v19
MB v[0:15],a[48:51],a[8:11],v[0:15]
v_add_u32 v51,5120,v51
v_exp_f32 v22,v22
v_exp_f32 v23,v23
CV v42,v20,v21
v_exp_f32 v24,v24
v_exp_f32 v25,v25
CV v43,v22,v23
MB a[72:87],a[64:67],v[32:35],a[72:87]
s_add_u32 s56,s56,1
v_exp_f32 v26,v26
v_exp_f32 v27,v27
CV v44,v24,v25
v_exp_f32 v28,v28
v_exp_f32 v29,v29
CV v45,v26,v27
MB a[72:87],a[68:71],v[36:39],a[72:87]
v_exp_f32 v30,v30
v_exp_f32 v31,v31
CV v46,v28,v29
s_cmp_lt_u32 s56,16
s_cbranch_scc1 L_attn_loop
CV v47,v30,v31
s_nop 1
MB a[88:103],a[64:67],v[40:43],a[88:103]
MB a[88:103],a[68:71],v[44:47],a[88:103]
v_subrev_u32 v48,65536,v48
v_subrev_u32 v51,81920,v51
v_lshlrev_b32 v54,4,v50
v_sub_u32 v49,v49,v54
s_nop 7
s_nop 3
v_accvgpr_read_b32 v54,a82
v_accvgpr_read_b32 v55,a98
v_mov_b32 v56,v54
v_mov_b32 v57,v55
s_nop 1
v_permlane32_swap_b32 v54,v56
v_permlane32_swap_b32 v55,v57
s_mov_b32 s72,0x4f800000
v_cmp_ngt_f32 vcc,s72,v54
s_nop 3
s_mov_b64 s[74:75],vcc
v_cmp_ngt_f32 vcc,s72,v55
s_nop 3
s_or_b64 s[74:75],s[74:75],vcc
s_cmp_eq_u64 s[74:75],0
s_cbranch_scc1 L_attn_ok
s_cmp_lg_u32 s52,0
s_cbranch_scc1 L_attn_ok
s_branch L_attn_fallback
L_attn_ok:
v_mbcnt_lo_u32_b32 v58,-1,0
v_mbcnt_hi_u32_b32 v58,-1,v58
v_and_b32 v59,31,v58
v_lshrrev_b32 v60,5,v58
v_lshlrev_b32 v61,5,v59
v_lshl_add_u32 v61,v60,4,v61
v_lshlrev_b32 v59,7,v59
v_lshl_or_b32 v59,v60,31,v59
v_rcp_f32 v54,v54
v_accvgpr_read_b32 v0,a72
v_accvgpr_read_b32 v1,a73
v_accvgpr_read_b32 v2,a74
v_accvgpr_read_b32 v3,a75
v_accvgpr_read_b32 v4,a76
v_accvgpr_read_b32 v5,a77
v_accvgpr_read_b32 v6,a78
v_accvgpr_read_b32 v7,a79
v_accvgpr_read_b32 v8,a80
v_accvgpr_read_b32 v9,a81
v_mul_f32 v0,v0,v54
v_mul_f32 v1,v1,v54
v_mul_f32 v2,v2,v54
v_mul_f32 v3,v3,v54
v_mul_f32 v4,v4,v54
v_mul_f32 v5,v5,v54
v_mul_f32 v6,v6,v54
v_mul_f32 v7,v7,v54
v_mul_f32 v8,v8,v54
v_mul_f32 v9,v9,v54
CV v32,v0,v1
CV v33,v2,v3
CV v34,v4,v5
CV v35,v6,v7
CV v36,v8,v9
s_nop 0
v_permlane32_swap_b32 v32,v34
v_permlane32_swap_b32 v33,v35
buffer_store_dwordx4 v[32:35],v61,s[40:43],s57 offen offset:0 sc1
s_add_u32 s72,s58,0
buffer_store_dword v36,v59,s[40:43],s72 offen sc1
v_rcp_f32 v55,v55
v_accvgpr_read_b32 v16,a88
v_accvgpr_read_b32 v17,a89
v_accvgpr_read_b32 v18,a90
v_accvgpr_read_b32 v19,a91
v_accvgpr_read_b32 v20,a92
v_accvgpr_read_b32 v21,a93
v_accvgpr_read_b32 v22,a94
v_accvgpr_read_b32 v23,a95
v_accvgpr_read_b32 v24,a96
v_accvgpr_read_b32 v25,a97
v_mul_f32 v16,v16,v55
v_mul_f32 v17,v17,v55
v_mul_f32 v18,v18,v55
v_mul_f32 v19,v19,v55
v_mul_f32 v20,v20,v55
v_mul_f32 v21,v21,v55
v_mul_f32 v22,v22,v55
v_mul_f32 v23,v23,v55
v_mul_f32 v24,v24,v55
v_mul_f32 v25,v25,v55
CV v40,v16,v17
CV v41,v18,v19
CV v42,v20,v21
CV v43,v22,v23
CV v44,v24,v25
s_nop 0
v_permlane32_swap_b32 v40,v42
v_permlane32_swap_b32 v41,v43
buffer_store_dwordx4 v[40:43],v61,s[40:43],s57 offen offset:1024 sc1
s_add_u32 s72,s58,4096
buffer_store_dword v44,v59,s[40:43],s72 offen sc1
s_cmp_lg_u32 s55,0
s_cbranch_scc1 L_attn_done
s_mov_b32 s55,1
s_mov_b32 s62,1
s_mov_b32 s52,0
s_add_u32 s57,s57,8192
s_add_u32 s58,s58,32768
v_mov_b32 v62,v80
v_mov_b32 v63,v81
v_mov_b32 v64,v82
v_mov_b32 v65,v83
v_mov_b32 v66,v84
v_mov_b32 v67,v85
v_mov_b32 v68,v86
v_mov_b32 v69,v87
v_mov_b32 v70,v88
v_mov_b32 v71,v89
s_branch L_attn_pass
L_attn_done:
s_branch L_final
L_attn_sync:
s_cmp_eq_u32 s59,0
s_cbranch_scc0 L_attn_sync1
s_add_u32 m0,s49,16384
s_add_u32 s88,s46,16384
buffer_load_dwordx4 v52,s[40:43],s88 offen offset:0 sc1 lds
buffer_load_dwordx4 v52,s[40:43],s88 offen offset:1024 sc1 lds
buffer_load_dwordx4 v52,s[40:43],s88 offen offset:2048 sc1 lds
buffer_load_dwordx4 v52,s[40:43],s88 offen offset:3072 sc1 lds
s_add_u32 m0,s50,20480
s_add_u32 s88,s47,20480
buffer_load_dwordx4 v52,s[40:43],s88 offen offset:0 sc1 lds
buffer_load_dwordx4 v52,s[40:43],s88 offen offset:1024 sc1 lds
buffer_load_dwordx4 v52,s[40:43],s88 offen offset:2048 sc1 lds
buffer_load_dwordx4 v52,s[40:43],s88 offen offset:3072 sc1 lds
s_add_u32 m0,s50,24576
s_add_u32 s88,s47,24576
buffer_load_dwordx4 v52,s[40:43],s88 offen sc1 lds
s_add_u32 m0,s51,2048
s_add_u32 s88,s48,2048
buffer_load_dword v53,s[40:43],s88 offen sc1 lds
s_add_u32 m0,s51,2304
s_add_u32 s88,s48,2112
buffer_load_dword v53,s[40:43],s88 offen sc1 lds
v_and_b32 v54,31,v76
v_lshlrev_b32 v54,2,v54
s_add_u32 s72,s53,8192
s_add_u32 s73,s54,1024
buffer_load_dwordx4 v[80:83],v52,s[40:43],s72 offen sc1
buffer_load_dwordx4 v[84:87],v52,s[40:43],s72 offen offset:1024 sc1
buffer_load_dword v88,v54,s[40:43],s73 offen sc1
buffer_load_dword v89,v54,s[40:43],s73 offen offset:128 sc1
s_mov_b32 s59,1
s_branch L_attn_back
L_attn_sync1:
s_cmp_eq_u32 s59,1
s_cbranch_scc0 L_attn_sync2
s_add_u32 m0,s49,32768
s_add_u32 s88,s46,32768
buffer_load_dwordx4 v52,s[40:43],s88 offen offset:0 sc1 lds
buffer_load_dwordx4 v52,s[40:43],s88 offen offset:1024 sc1 lds
buffer_load_dwordx4 v52,s[40:43],s88 offen offset:2048 sc1 lds
buffer_load_dwordx4 v52,s[40:43],s88 offen offset:3072 sc1 lds
s_add_u32 m0,s50,40960
s_add_u32 s88,s47,40960
buffer_load_dwordx4 v52,s[40:43],s88 offen offset:0 sc1 lds
buffer_load_dwordx4 v52,s[40:43],s88 offen offset:1024 sc1 lds
buffer_load_dwordx4 v52,s[40:43],s88 offen offset:2048 sc1 lds
buffer_load_dwordx4 v52,s[40:43],s88 offen offset:3072 sc1 lds
s_add_u32 m0,s50,45056
s_add_u32 s88,s47,45056
buffer_load_dwordx4 v52,s[40:43],s88 offen sc1 lds
s_add_u32 m0,s51,4096
s_add_u32 s88,s48,4096
buffer_load_dword v53,s[40:43],s88 offen sc1 lds
s_add_u32 m0,s51,4352
s_add_u32 s88,s48,4160
buffer_load_dword v53,s[40:43],s88 offen sc1 lds
s_mov_b32 s59,2
s_branch L_attn_back
L_attn_sync2:
s_cmp_eq_u32 s59,2
s_cbranch_scc0 L_attn_sync3
s_add_u32 m0,s49,49152
s_add_u32 s88,s46,49152
buffer_load_dwordx4 v52,s[40:43],s88 offen offset:0 sc1 lds
buffer_load_dwordx4 v52,s[40:43],s88 offen offset:1024 sc1 lds
buffer_load_dwordx4 v52,s[40:43],s88 offen offset:2048 sc1 lds
buffer_load_dwordx4 v52,s[40:43],s88 offen offset:3072 sc1 lds
s_add_u32 m0,s50,61440
s_add_u32 s88,s47,61440
buffer_load_dwordx4 v52,s[40:43],s88 offen offset:0 sc1 lds
buffer_load_dwordx4 v52,s[40:43],s88 offen offset:1024 sc1 lds
buffer_load_dwordx4 v52,s[40:43],s88 offen offset:2048 sc1 lds
buffer_load_dwordx4 v52,s[40:43],s88 offen offset:3072 sc1 lds
s_add_u32 m0,s50,65536
s_add_u32 s88,s47,65536
buffer_load_dwordx4 v52,s[40:43],s88 offen sc1 lds
s_add_u32 m0,s51,6144
s_add_u32 s88,s48,6144
buffer_load_dword v53,s[40:43],s88 offen sc1 lds
s_add_u32 m0,s51,6400
s_add_u32 s88,s48,6208
buffer_load_dword v53,s[40:43],s88 offen sc1 lds
s_mov_b32 s59,3
s_branch L_attn_back
L_attn_sync3:
s_cmp_eq_u32 s59,3
s_cbranch_scc0 L_attn_sync7
s_waitcnt vmcnt(22)
s_barrier
s_mov_b32 s59,7
s_branch L_attn_back
L_attn_sync7:
s_waitcnt vmcnt(0)
s_barrier
s_mov_b32 s59,99
s_branch L_attn_back
L_attn_fallback:
s_mov_b32 s52,1
s_mov_b32 s62,1
v_mbcnt_lo_u32_b32 v54,-1,0
v_mbcnt_hi_u32_b32 v54,-1,v54
v_cmp_gt_u32 vcc,32,v54
v_mov_b32 v55,0
s_nop 0
v_cndmask_b32 v56,v55,v70,vcc
v_cndmask_b32 v57,v55,v71,vcc
v_accvgpr_write_b32 a8,v56
v_accvgpr_write_b32 a9,v55
v_accvgpr_write_b32 a10,v55
v_accvgpr_write_b32 a11,v55
v_accvgpr_write_b32 a12,v55
v_accvgpr_write_b32 a13,v56
v_accvgpr_write_b32 a14,v55
v_accvgpr_write_b32 a15,v55
v_accvgpr_write_b32 a16,v55
v_accvgpr_write_b32 a17,v55
v_accvgpr_write_b32 a18,v56
v_accvgpr_write_b32 a19,v55
v_accvgpr_write_b32 a20,v55
v_accvgpr_write_b32 a21,v55
v_accvgpr_write_b32 a22,v55
v_accvgpr_write_b32 a23,v56
v_accvgpr_write_b32 a24,v57
v_accvgpr_write_b32 a25,v55
v_accvgpr_write_b32 a26,v55
v_accvgpr_write_b32 a27,v55
v_accvgpr_write_b32 a28,v55
v_accvgpr_write_b32 a29,v57
v_accvgpr_write_b32 a30,v55
v_accvgpr_write_b32 a31,v55
v_accvgpr_write_b32 a32,v55
v_accvgpr_write_b32 a33,v55
v_accvgpr_write_b32 a34,v57
v_accvgpr_write_b32 a35,v55
v_accvgpr_write_b32 a36,v55
v_accvgpr_write_b32 a37,v55
v_accvgpr_write_b32 a38,v55
v_accvgpr_write_b32 a39,v57
v_mov_b32 v72,0xff800000
v_mov_b32 v73,0xff800000
v_mov_b32 v59,v48
v_mov_b32 v60,v49
s_mov_b32 s72,16
L_fb_loop:
ds_read_b128 a[48:51],v60
ds_read_b128 a[40:43],v59 offset:0
WL 0
MB v[0:15],a[40:43],a[0:3],0
MB v[0:15],a[48:51],a[8:11],v[0:15]
MB v[16:31],a[40:43],a[4:7],0
MB v[16:31],a[48:51],a[24:27],v[16:31]
s_nop 7
s_nop 3
v_max3_f32 v72,v72,v0,v1
v_max3_f32 v72,v72,v2,v3
v_max3_f32 v72,v72,v4,v5
v_max3_f32 v72,v72,v6,v7
v_max3_f32 v72,v72,v8,v9
v_max3_f32 v72,v72,v10,v11
v_max3_f32 v72,v72,v12,v13
v_max3_f32 v72,v72,v14,v15
v_max3_f32 v73,v73,v16,v17
v_max3_f32 v73,v73,v18,v19
v_max3_f32 v73,v73,v20,v21
v_max3_f32 v73,v73,v22,v23
v_max3_f32 v73,v73,v24,v25
v_max3_f32 v73,v73,v26,v27
v_max3_f32 v73,v73,v28,v29
v_max3_f32 v73,v73,v30,v31
ds_read_b128 a[40:43],v59 offset:1024
WL 0
MB v[0:15],a[40:43],a[0:3],0
MB v[0:15],a[48:51],a[12:15],v[0:15]
MB v[16:31],a[40:43],a[4:7],0
MB v[16:31],a[48:51],a[28:31],v[16:31]
s_nop 7
s_nop 3
v_max3_f32 v72,v72,v0,v1
v_max3_f32 v72,v72,v2,v3
v_max3_f32 v72,v72,v4,v5
v_max3_f32 v72,v72,v6,v7
v_max3_f32 v72,v72,v8,v9
v_max3_f32 v72,v72,v10,v11
v_max3_f32 v72,v72,v12,v13
v_max3_f32 v72,v72,v14,v15
v_max3_f32 v73,v73,v16,v17
v_max3_f32 v73,v73,v18,v19
v_max3_f32 v73,v73,v20,v21
v_max3_f32 v73,v73,v22,v23
v_max3_f32 v73,v73,v24,v25
v_max3_f32 v73,v73,v26,v27
v_max3_f32 v73,v73,v28,v29
v_max3_f32 v73,v73,v30,v31
ds_read_b128 a[40:43],v59 offset:2048
WL 0
MB v[0:15],a[40:43],a[0:3],0
MB v[0:15],a[48:51],a[16:19],v[0:15]
MB v[16:31],a[40:43],a[4:7],0
MB v[16:31],a[48:51],a[32:35],v[16:31]
s_nop 7
s_nop 3
v_max3_f32 v72,v72,v0,v1
v_max3_f32 v72,v72,v2,v3
v_max3_f32 v72,v72,v4,v5
v_max3_f32 v72,v72,v6,v7
v_max3_f32 v72,v72,v8,v9
v_max3_f32 v72,v72,v10,v11
v_max3_f32 v72,v72,v12,v13
v_max3_f32 v72,v72,v14,v15
v_max3_f32 v73,v73,v16,v17
v_max3_f32 v73,v73,v18,v19
v_max3_f32 v73,v73,v20,v21
v_max3_f32 v73,v73,v22,v23
v_max3_f32 v73,v73,v24,v25
v_max3_f32 v73,v73,v26,v27
v_max3_f32 v73,v73,v28,v29
v_max3_f32 v73,v73,v30,v31
ds_read_b128 a[40:43],v59 offset:3072
WL 0
MB v[0:15],a[40:43],a[0:3],0
MB v[0:15],a[48:51],a[20:23],v[0:15]
MB v[16:31],a[40:43],a[4:7],0
MB v[16:31],a[48:51],a[36:39],v[16:31]
s_nop 7
s_nop 3
v_max3_f32 v72,v72,v0,v1
v_max3_f32 v72,v72,v2,v3
v_max3_f32 v72,v72,v4,v5
v_max3_f32 v72,v72,v6,v7
v_max3_f32 v72,v72,v8,v9
v_max3_f32 v72,v72,v10,v11
v_max3_f32 v72,v72,v12,v13
v_max3_f32 v72,v72,v14,v15
v_max3_f32 v73,v73,v16,v17
v_max3_f32 v73,v73,v18,v19
v_max3_f32 v73,v73,v20,v21
v_max3_f32 v73,v73,v22,v23
v_max3_f32 v73,v73,v24,v25
v_max3_f32 v73,v73,v26,v27
v_max3_f32 v73,v73,v28,v29
v_max3_f32 v73,v73,v30,v31
v_add_u32 v59,4096,v59
v_add_u32 v60,v60,v50
s_sub_u32 s72,s72,1
s_cmp_lg_u32 s72,0
s_cbranch_scc1 L_fb_loop
v_mov_b32 v54,v72
s_nop 1
v_permlane32_swap_b32 v72,v54
s_nop 1
v_max_f32 v72,v72,v54
v_mov_b32 v54,v73
s_nop 1
v_permlane32_swap_b32 v73,v54
s_nop 1
v_max_f32 v73,v73,v54
v_sub_f32 v72,0,v72
CV v54,v72,v72
v_lshlrev_b32 v54,16,v54
v_sub_f32 v72,v72,v54
CV v72,v54,v72
v_sub_f32 v73,0,v73
CV v54,v73,v73
v_lshlrev_b32 v54,16,v54
v_sub_f32 v73,v73,v54
CV v73,v54,v73
v_mbcnt_lo_u32_b32 v54,-1,0
v_mbcnt_hi_u32_b32 v54,-1,v54
v_cmp_gt_u32 vcc,32,v54
v_mov_b32 v55,0
s_nop 0
v_cndmask_b32 v56,v72,v70,vcc
v_cndmask_b32 v57,v73,v71,vcc
v_accvgpr_write_b32 a8,v56
v_accvgpr_write_b32 a9,v55
v_accvgpr_write_b32 a10,v55
v_accvgpr_write_b32 a11,v55
v_accvgpr_write_b32 a12,v55
v_accvgpr_write_b32 a13,v56
v_accvgpr_write_b32 a14,v55
v_accvgpr_write_b32 a15,v55
v_accvgpr_write_b32 a16,v55
v_accvgpr_write_b32 a17,v55
v_accvgpr_write_b32 a18,v56
v_accvgpr_write_b32 a19,v55
v_accvgpr_write_b32 a20,v55
v_accvgpr_write_b32 a21,v55
v_accvgpr_write_b32 a22,v55
v_accvgpr_write_b32 a23,v56
v_accvgpr_write_b32 a24,v57
v_accvgpr_write_b32 a25,v55
v_accvgpr_write_b32 a26,v55
v_accvgpr_write_b32 a27,v55
v_accvgpr_write_b32 a28,v55
v_accvgpr_write_b32 a29,v57
v_accvgpr_write_b32 a30,v55
v_accvgpr_write_b32 a31,v55
v_accvgpr_write_b32 a32,v55
v_accvgpr_write_b32 a33,v55
v_accvgpr_write_b32 a34,v57
v_accvgpr_write_b32 a35,v55
v_accvgpr_write_b32 a36,v55
v_accvgpr_write_b32 a37,v55
v_accvgpr_write_b32 a38,v55
v_accvgpr_write_b32 a39,v57
ds_read_b128 a[40:43],v48
ds_read_b128 a[48:51],v49
WL 0
s_branch L_attn_main
L_final:
s_waitcnt vmcnt(0)
s_barrier
buffer_atomic_add v99,v100,s[80:83],0 offen offset:128 sc0
s_cmp_lg_u32 s3,0
s_cbranch_scc1 L_nolastarr_a
s_waitcnt vmcnt(0)
v_readfirstlane_b32 s48,v99
s_cmp_lg_u32 s48,255
s_cbranch_scc1 L_nolastarr_a
v_mov_b32 v102,1
s_mov_b32 s48,53739520
v_add_u32 v101,0,v90
v_lshlrev_b32 v101,10,v101
buffer_store_dword v102,v101,s[40:43],s48 offen sc1
v_add_u32 v101,64,v90
v_lshlrev_b32 v101,10,v101
buffer_store_dword v102,v101,s[40:43],s48 offen sc1
v_add_u32 v101,128,v90
v_lshlrev_b32 v101,10,v101
buffer_store_dword v102,v101,s[40:43],s48 offen sc1
v_add_u32 v101,192,v90
v_lshlrev_b32 v101,10,v101
buffer_store_dword v102,v101,s[40:43],s48 offen sc1
L_nolastarr_a:
s_add_u32 s53,s90,0
s_add_u32 m0,s65,0
s_nop 0
buffer_load_dwordx4 v92,s[28:31],s53 offen lds
s_add_u32 s53,s90,4608
s_add_u32 m0,s65,1024
s_nop 0
buffer_load_dwordx4 v92,s[28:31],s53 offen lds
s_add_u32 s53,s90,41472
s_add_u32 m0,s65,2048
s_nop 0
buffer_load_dwordx4 v92,s[28:31],s53 offen lds
s_add_u32 s53,s90,46080
s_add_u32 m0,s65,3072
s_nop 0
buffer_load_dwordx4 v92,s[28:31],s53 offen lds
s_add_u32 s53,s90,82944
s_add_u32 m0,s65,4096
s_nop 0
buffer_load_dwordx4 v92,s[28:31],s53 offen lds
s_add_u32 s53,s90,87552
s_add_u32 m0,s65,5120
s_nop 0
buffer_load_dwordx4 v92,s[28:31],s53 offen lds
s_add_u32 s53,s90,124416
s_add_u32 m0,s65,6144
s_nop 0
buffer_load_dwordx4 v92,s[28:31],s53 offen lds
s_add_u32 s53,s90,129024
s_add_u32 m0,s65,7168
s_nop 0
buffer_load_dwordx4 v92,s[28:31],s53 offen lds
s_add_u32 s53,s90,165888
s_add_u32 m0,s65,8192
s_nop 0
buffer_load_dwordx4 v92,s[28:31],s53 offen lds
s_add_u32 s53,s90,170496
s_add_u32 m0,s65,9216
s_nop 0
buffer_load_dwordx4 v92,s[28:31],s53 offen lds
s_add_u32 s53,s90,207360
s_add_u32 m0,s65,10240
s_nop 0
buffer_load_dwordx4 v92,s[28:31],s53 offen lds
s_add_u32 s53,s90,211968
s_add_u32 m0,s65,11264
s_nop 0
buffer_load_dwordx4 v92,s[28:31],s53 offen lds
s_add_u32 s53,s90,248832
s_add_u32 m0,s65,12288
s_nop 0
buffer_load_dwordx4 v92,s[28:31],s53 offen lds
s_add_u32 s53,s90,253440
s_add_u32 m0,s65,13312
s_nop 0
buffer_load_dwordx4 v92,s[28:31],s53 offen lds
s_add_u32 m0,s65,14336
s_nop 0
buffer_load_dwordx4 v93,s[28:31],s84 offen lds
s_add_u32 m0,s65,15360
s_nop 0
buffer_load_dwordx4 v93,s[28:31],s85 offen lds
s_add_u32 m0,s65,16384
s_nop 0
buffer_load_dwordx4 v93,s[28:31],s86 offen lds
s_add_u32 m0,s65,17408
s_nop 0
buffer_load_dwordx4 v93,s[28:31],s87 offen lds
s_waitcnt vmcnt(0)
s_lshl_b32 s49,s2,10
s_add_u32 s49,s49,53739520
s_cmp_lg_u32 s3,0
s_cbranch_scc1 L_fin_ok_go
s_mov_b32 s48,0
L_fin_poll_go:
buffer_load_dword v101,v100,s[40:43],s49 offen sc1
s_waitcnt vmcnt(0)
v_readfirstlane_b32 s50,v101
s_add_u32 s48,s48,1
s_cmp_lg_u32 s50,0
s_cbranch_scc1 L_fin_ok_go
s_cmp_lt_u32 s48,0x8000
s_cbranch_scc1 L_fin_poll_go
L_fin_ok_go:
s_barrier
s_add_u32 s91,s69,18432
s_add_u32 s53,s66,0
buffer_load_dwordx4 a[0:3],v94,s[40:43],s53 offen sc1
s_add_u32 s53,s66,512
buffer_load_dwordx4 a[4:7],v94,s[40:43],s53 offen sc1
s_add_u32 s53,s66,131072
buffer_load_dwordx4 a[8:11],v94,s[40:43],s53 offen sc1
s_add_u32 s53,s66,131584
buffer_load_dwordx4 a[12:15],v94,s[40:43],s53 offen sc1
s_add_u32 s53,s66,262144
buffer_load_dwordx4 a[16:19],v94,s[40:43],s53 offen sc1
s_add_u32 s53,s66,262656
buffer_load_dwordx4 a[20:23],v94,s[40:43],s53 offen sc1
s_add_u32 s53,s66,393216
buffer_load_dwordx4 a[24:27],v94,s[40:43],s53 offen sc1
s_add_u32 s53,s66,393728
buffer_load_dwordx4 a[28:31],v94,s[40:43],s53 offen sc1
s_add_u32 s53,s66,524288
buffer_load_dwordx4 a[32:35],v94,s[40:43],s53 offen sc1
s_add_u32 s53,s66,524800
buffer_load_dwordx4 a[36:39],v94,s[40:43],s53 offen sc1
s_add_u32 s53,s66,655360
buffer_load_dwordx4 a[40:43],v94,s[40:43],s53 offen sc1
s_add_u32 s53,s66,655872
buffer_load_dwordx4 a[44:47],v94,s[40:43],s53 offen sc1
s_add_u32 s53,s66,786432
buffer_load_dwordx4 a[48:51],v94,s[40:43],s53 offen sc1
s_add_u32 s53,s66,786944
buffer_load_dwordx4 a[52:55],v94,s[40:43],s53 offen sc1
s_add_u32 s53,s66,917504
buffer_load_dwordx4 a[56:59],v94,s[40:43],s53 offen sc1
s_add_u32 s53,s66,918016
buffer_load_dwordx4 a[60:63],v94,s[40:43],s53 offen sc1
s_add_u32 s53,s66,1048576
buffer_load_dwordx4 a[64:67],v94,s[40:43],s53 offen sc1
s_add_u32 s53,s66,1049088
buffer_load_dwordx4 a[68:71],v94,s[40:43],s53 offen sc1
s_add_u32 s53,s66,1179648
buffer_load_dwordx4 a[72:75],v94,s[40:43],s53 offen sc1
s_add_u32 s53,s66,1180160
buffer_load_dwordx4 a[76:79],v94,s[40:43],s53 offen sc1
s_add_u32 s53,s66,1310720
buffer_load_dwordx4 a[80:83],v94,s[40:43],s53 offen sc1
s_add_u32 s53,s66,1311232
buffer_load_dwordx4 a[84:87],v94,s[40:43],s53 offen sc1
s_add_u32 s53,s66,1441792
buffer_load_dwordx4 a[88:91],v94,s[40:43],s53 offen sc1
s_add_u32 s53,s66,1442304
buffer_load_dwordx4 a[92:95],v94,s[40:43],s53 offen sc1
s_add_u32 s53,s66,1572864
buffer_load_dwordx4 a[96:99],v94,s[40:43],s53 offen sc1
s_add_u32 s53,s66,1573376
buffer_load_dwordx4 a[100:103],v94,s[40:43],s53 offen sc1
s_add_u32 s53,s66,1703936
buffer_load_dwordx4 a[104:107],v94,s[40:43],s53 offen sc1
s_add_u32 s53,s66,1704448
buffer_load_dwordx4 a[108:111],v94,s[40:43],s53 offen sc1
s_add_u32 s53,s66,1835008
buffer_load_dwordx4 a[112:115],v94,s[40:43],s53 offen sc1
s_add_u32 s53,s66,1835520
buffer_load_dwordx4 a[116:119],v94,s[40:43],s53 offen sc1
s_add_u32 s53,s66,1966080
buffer_load_dwordx4 a[120:123],v94,s[40:43],s53 offen sc1
s_add_u32 s53,s66,1966592
buffer_load_dwordx4 a[124:127],v94,s[40:43],s53 offen sc1
s_add_u32 s53,s67,0
buffer_load_dwordx4 a[128:131],v95,s[40:43],s53 offen offset:0 sc1
s_add_u32 s53,s67,2048
buffer_load_dwordx4 a[132:135],v95,s[40:43],s53 offen offset:0 sc1
s_add_u32 s53,s67,0
buffer_load_dwordx4 a[136:139],v95,s[40:43],s53 offen offset:64 sc1
s_add_u32 s53,s67,2048
buffer_load_dwordx4 a[140:143],v95,s[40:43],s53 offen offset:64 sc1
buffer_load_dwordx2 v[68:69],v97,s[20:23],s69 offen offset:0
buffer_load_dwordx2 v[70:71],v97,s[20:23],s91 offen offset:0
buffer_load_dwordx2 v[72:73],v97,s[20:23],s69 offen offset:32
buffer_load_dwordx2 v[74:75],v97,s[20:23],s91 offen offset:32
buffer_load_dwordx2 v[76:77],v97,s[20:23],s69 offen offset:64
buffer_load_dwordx2 v[78:79],v97,s[20:23],s91 offen offset:64
buffer_load_dwordx2 v[80:81],v97,s[20:23],s69 offen offset:96
buffer_load_dwordx2 v[82:83],v97,s[20:23],s91 offen offset:96
s_add_u32 s53,s68,0
buffer_load_dwordx4 v[104:107],v96,s[40:43],s53 offen offset:0 sc1
buffer_load_dwordx4 v[108:111],v96,s[40:43],s53 offen offset:1024 sc1
buffer_load_dwordx4 v[112:115],v96,s[40:43],s53 offen offset:2048 sc1
buffer_load_dwordx4 v[116:119],v96,s[40:43],s53 offen offset:3072 sc1
s_add_u32 s53,s68,2359296
buffer_load_dwordx4 v[120:123],v96,s[40:43],s53 offen offset:0 sc1
buffer_load_dwordx4 v[124:127],v96,s[40:43],s53 offen offset:1024 sc1
buffer_load_dwordx4 v[128:131],v96,s[40:43],s53 offen offset:2048 sc1
buffer_load_dwordx4 v[132:135],v96,s[40:43],s53 offen offset:3072 sc1
s_add_u32 s53,s68,4718592
buffer_load_dwordx4 v[136:139],v96,s[40:43],s53 offen offset:0 sc1
buffer_load_dwordx4 v[140:143],v96,s[40:43],s53 offen offset:1024 sc1
buffer_load_dwordx4 v[144:147],v96,s[40:43],s53 offen offset:2048 sc1
buffer_load_dwordx4 v[148:151],v96,s[40:43],s53 offen offset:3072 sc1
s_add_u32 s53,s68,7077888
buffer_load_dwordx4 v[152:155],v96,s[40:43],s53 offen offset:0 sc1
buffer_load_dwordx4 v[156:159],v96,s[40:43],s53 offen offset:1024 sc1
buffer_load_dwordx4 v[160:163],v96,s[40:43],s53 offen offset:2048 sc1
buffer_load_dwordx4 v[164:167],v96,s[40:43],s53 offen offset:3072 sc1
s_add_u32 s53,s68,9437184
buffer_load_dwordx4 v[168:171],v96,s[40:43],s53 offen offset:0 sc1
buffer_load_dwordx4 v[172:175],v96,s[40:43],s53 offen offset:1024 sc1
buffer_load_dwordx4 v[176:179],v96,s[40:43],s53 offen offset:2048 sc1
RT v[16:17],v91,0
RT v[18:19],v91,1024
RT v[20:21],v91,256
RT v[22:23],v91,1280
RT v[24:25],v91,512
RT v[26:27],v91,1536
RT v[28:29],v91,768
RT v[30:31],v91,1792
s_waitcnt vmcnt(61)
WL 4
MA v[36:39],v[16:19],a[0:3],0
RT v[32:33],v91,2048
RT v[34:35],v91,3072
MA v[40:43],v[16:19],a[4:7],0
buffer_load_dwordx4 v[180:183],v96,s[40:43],s53 offen offset:3072 sc1
MA v[44:47],v[20:23],a[0:3],0
RT v[16:17],v91,2304
MA v[48:51],v[20:23],a[4:7],0
RT v[18:19],v91,3328
WL 4
MA v[52:55],v[24:27],a[0:3],0
RT v[20:21],v91,2560
s_add_u32 s53,s68,11796480
MA v[56:59],v[24:27],a[4:7],0
RT v[22:23],v91,3584
buffer_load_dwordx4 v[184:187],v96,s[40:43],s53 offen offset:0 sc1
MA v[60:63],v[28:31],a[0:3],0
RT v[24:25],v91,2816
MA v[64:67],v[28:31],a[4:7],0
RT v[26:27],v91,3840
s_waitcnt vmcnt(61)
WL 4
MA v[36:39],v[32:35],a[8:11],v[36:39]
RT v[28:29],v91,4096
MA v[40:43],v[32:35],a[12:15],v[40:43]
RT v[30:31],v91,5120
MA v[44:47],v[16:19],a[8:11],v[44:47]
RT v[32:33],v91,4352
buffer_load_dwordx4 v[188:191],v96,s[40:43],s53 offen offset:1024 sc1
MA v[48:51],v[16:19],a[12:15],v[48:51]
RT v[34:35],v91,5376
WL 4
MA v[52:55],v[20:23],a[8:11],v[52:55]
RT v[16:17],v91,4608
MA v[56:59],v[20:23],a[12:15],v[56:59]
RT v[18:19],v91,5632
MA v[60:63],v[24:27],a[8:11],v[60:63]
RT v[20:21],v91,4864
buffer_load_dwordx4 v[192:195],v96,s[40:43],s53 offen offset:2048 sc1
MA v[64:67],v[24:27],a[12:15],v[64:67]
RT v[22:23],v91,5888
s_waitcnt vmcnt(61)
WL 4
MA v[36:39],v[28:31],a[16:19],v[36:39]
RT v[24:25],v91,6144
MA v[40:43],v[28:31],a[20:23],v[40:43]
RT v[26:27],v91,7168
MA v[44:47],v[32:35],a[16:19],v[44:47]
RT v[28:29],v91,6400
MA v[48:51],v[32:35],a[20:23],v[48:51]
RT v[30:31],v91,7424
WL 4
MA v[52:55],v[16:19],a[16:19],v[52:55]
RT v[32:33],v91,6656
RT v[34:35],v91,7680
MA v[56:59],v[16:19],a[20:23],v[56:59]
buffer_load_dwordx4 v[196:199],v96,s[40:43],s53 offen offset:3072 sc1
MA v[60:63],v[20:23],a[16:19],v[60:63]
RT v[16:17],v91,6912
MA v[64:67],v[20:23],a[20:23],v[64:67]
RT v[18:19],v91,7936
s_waitcnt vmcnt(60)
WL 4
MA v[36:39],v[24:27],a[24:27],v[36:39]
RT v[20:21],v91,8192
s_add_u32 s53,s68,14155776
MA v[40:43],v[24:27],a[28:31],v[40:43]
RT v[22:23],v91,9216
buffer_load_dwordx4 v[200:203],v96,s[40:43],s53 offen offset:0 sc1
MA v[44:47],v[28:31],a[24:27],v[44:47]
RT v[24:25],v91,8448
MA v[48:51],v[28:31],a[28:31],v[48:51]
RT v[26:27],v91,9472
WL 4
MA v[52:55],v[32:35],a[24:27],v[52:55]
RT v[28:29],v91,8704
MA v[56:59],v[32:35],a[28:31],v[56:59]
RT v[30:31],v91,9728
MA v[60:63],v[16:19],a[24:27],v[60:63]
RT v[32:33],v91,8960
buffer_load_dwordx4 v[204:207],v96,s[40:43],s53 offen offset:1024 sc1
MA v[64:67],v[16:19],a[28:31],v[64:67]
RT v[34:35],v91,9984
s_waitcnt vmcnt(60)
WL 4
MA v[36:39],v[20:23],a[32:35],v[36:39]
RT v[16:17],v91,10240
MA v[40:43],v[20:23],a[36:39],v[40:43]
RT v[18:19],v91,11264
MA v[44:47],v[24:27],a[32:35],v[44:47]
RT v[20:21],v91,10496
buffer_load_dwordx4 v[208:211],v96,s[40:43],s53 offen offset:2048 sc1
MA v[48:51],v[24:27],a[36:39],v[48:51]
RT v[22:23],v91,11520
WL 4
MA v[52:55],v[28:31],a[32:35],v[52:55]
RT v[24:25],v91,10752
MA v[56:59],v[28:31],a[36:39],v[56:59]
RT v[26:27],v91,11776
MA v[60:63],v[32:35],a[32:35],v[60:63]
RT v[28:29],v91,11008
MA v[64:67],v[32:35],a[36:39],v[64:67]
RT v[30:31],v91,12032
s_waitcnt vmcnt(59)
WL 4
MA v[36:39],v[16:19],a[40:43],v[36:39]
RT v[32:33],v91,12288
RT v[34:35],v91,13312
MA v[40:43],v[16:19],a[44:47],v[40:43]
buffer_load_dwordx4 v[212:215],v96,s[40:43],s53 offen offset:3072 sc1
MA v[44:47],v[20:23],a[40:43],v[44:47]
RT v[16:17],v91,12544
MA v[48:51],v[20:23],a[44:47],v[48:51]
RT v[18:19],v91,13568
WL 4
MA v[52:55],v[24:27],a[40:43],v[52:55]
RT v[20:21],v91,12800
s_add_u32 s53,s68,16515072
MA v[56:59],v[24:27],a[44:47],v[56:59]
RT v[22:23],v91,13824
buffer_load_dwordx4 v[216:219],v96,s[40:43],s53 offen offset:0 sc1
MA v[60:63],v[28:31],a[40:43],v[60:63]
RT v[24:25],v91,13056
MA v[64:67],v[28:31],a[44:47],v[64:67]
RT v[26:27],v91,14080
s_waitcnt vmcnt(59)
WL 4
MA v[36:39],v[32:35],a[48:51],v[36:39]
RT v[28:29],v91,14336
MA v[40:43],v[32:35],a[52:55],v[40:43]
RT v[30:31],v91,15360
MA v[44:47],v[16:19],a[48:51],v[44:47]
RT v[32:33],v91,14592
buffer_load_dwordx4 v[220:223],v96,s[40:43],s53 offen offset:1024 sc1
MA v[48:51],v[16:19],a[52:55],v[48:51]
RT v[34:35],v91,15616
WL 4
MA v[52:55],v[20:23],a[48:51],v[52:55]
RT v[16:17],v91,14848
MA v[56:59],v[20:23],a[52:55],v[56:59]
RT v[18:19],v91,15872
MA v[60:63],v[24:27],a[48:51],v[60:63]
RT v[20:21],v91,15104
buffer_load_dwordx4 v[224:227],v96,s[40:43],s53 offen offset:2048 sc1
MA v[64:67],v[24:27],a[52:55],v[64:67]
RT v[22:23],v91,16128
s_waitcnt vmcnt(59)
WL 4
MA v[36:39],v[28:31],a[56:59],v[36:39]
RT v[24:25],v91,16384
MA v[40:43],v[28:31],a[60:63],v[40:43]
RT v[26:27],v91,17408
MA v[44:47],v[32:35],a[56:59],v[44:47]
RT v[28:29],v91,16640
MA v[48:51],v[32:35],a[60:63],v[48:51]
RT v[30:31],v91,17664
WL 4
MA v[52:55],v[16:19],a[56:59],v[52:55]
RT v[32:33],v91,16896
RT v[34:35],v91,17920
MA v[56:59],v[16:19],a[60:63],v[56:59]
buffer_load_dwordx4 v[228:231],v96,s[40:43],s53 offen offset:3072 sc1
MA v[60:63],v[20:23],a[56:59],v[60:63]
RT v[16:17],v91,17152
MA v[64:67],v[20:23],a[60:63],v[64:67]
RT v[18:19],v91,18176
s_waitcnt vmcnt(58)
WL 4
MA v[36:39],v[24:27],a[64:67],v[36:39]
RT v[20:21],v91,18432
MA v[40:43],v[24:27],a[68:71],v[40:43]
RT v[22:23],v91,19456
MA v[44:47],v[28:31],a[64:67],v[44:47]
RT v[24:25],v91,18688
MA v[48:51],v[28:31],a[68:71],v[48:51]
RT v[26:27],v91,19712
WL 4
MA v[52:55],v[32:35],a[64:67],v[52:55]
RT v[28:29],v91,18944
MA v[56:59],v[32:35],a[68:71],v[56:59]
RT v[30:31],v91,19968
MA v[60:63],v[16:19],a[64:67],v[60:63]
RT v[32:33],v91,19200
MA v[64:67],v[16:19],a[68:71],v[64:67]
RT v[34:35],v91,20224
s_waitcnt vmcnt(56)
WL 4
MA v[36:39],v[20:23],a[72:75],v[36:39]
RT v[16:17],v91,20480
MA v[40:43],v[20:23],a[76:79],v[40:43]
RT v[18:19],v91,21504
MA v[44:47],v[24:27],a[72:75],v[44:47]
RT v[20:21],v91,20736
MA v[48:51],v[24:27],a[76:79],v[48:51]
RT v[22:23],v91,21760
WL 4
MA v[52:55],v[28:31],a[72:75],v[52:55]
RT v[24:25],v91,20992
MA v[56:59],v[28:31],a[76:79],v[56:59]
RT v[26:27],v91,22016
MA v[60:63],v[32:35],a[72:75],v[60:63]
RT v[28:29],v91,21248
MA v[64:67],v[32:35],a[76:79],v[64:67]
RT v[30:31],v91,22272
s_waitcnt vmcnt(54)
WL 4
MA v[36:39],v[16:19],a[80:83],v[36:39]
RT v[32:33],v91,22528
MA v[40:43],v[16:19],a[84:87],v[40:43]
RT v[34:35],v91,23552
MA v[44:47],v[20:23],a[80:83],v[44:47]
RT v[16:17],v91,22784
MA v[48:51],v[20:23],a[84:87],v[48:51]
RT v[18:19],v91,23808
WL 4
MA v[52:55],v[24:27],a[80:83],v[52:55]
RT v[20:21],v91,23040
MA v[56:59],v[24:27],a[84:87],v[56:59]
RT v[22:23],v91,24064
MA v[60:63],v[28:31],a[80:83],v[60:63]
RT v[24:25],v91,23296
MA v[64:67],v[28:31],a[84:87],v[64:67]
RT v[26:27],v91,24320
s_waitcnt vmcnt(52)
WL 4
MA v[36:39],v[32:35],a[88:91],v[36:39]
RT v[28:29],v91,24576
MA v[40:43],v[32:35],a[92:95],v[40:43]
RT v[30:31],v91,25600
MA v[44:47],v[16:19],a[88:91],v[44:47]
RT v[32:33],v91,24832
MA v[48:51],v[16:19],a[92:95],v[48:51]
RT v[34:35],v91,25856
WL 4
MA v[52:55],v[20:23],a[88:91],v[52:55]
RT v[16:17],v91,25088
MA v[56:59],v[20:23],a[92:95],v[56:59]
RT v[18:19],v91,26112
MA v[60:63],v[24:27],a[88:91],v[60:63]
RT v[20:21],v91,25344
MA v[64:67],v[24:27],a[92:95],v[64:67]
RT v[22:23],v91,26368
s_waitcnt vmcnt(50)
WL 4
MA v[36:39],v[28:31],a[96:99],v[36:39]
RT v[24:25],v91,26624
MA v[40:43],v[28:31],a[100:103],v[40:43]
RT v[26:27],v91,27648
MA v[44:47],v[32:35],a[96:99],v[44:47]
RT v[28:29],v91,26880
MA v[48:51],v[32:35],a[100:103],v[48:51]
RT v[30:31],v91,27904
WL 4
MA v[52:55],v[16:19],a[96:99],v[52:55]
RT v[32:33],v91,27136
MA v[56:59],v[16:19],a[100:103],v[56:59]
RT v[34:35],v91,28160
MA v[60:63],v[20:23],a[96:99],v[60:63]
RT v[16:17],v91,27392
MA v[64:67],v[20:23],a[100:103],v[64:67]
RT v[18:19],v91,28416
s_waitcnt vmcnt(48)
WL 4
MA v[36:39],v[24:27],a[104:107],v[36:39]
RT v[20:21],v91,28672
MA v[40:43],v[24:27],a[108:111],v[40:43]
RT v[22:23],v91,29696
MA v[44:47],v[28:31],a[104:107],v[44:47]
RT v[24:25],v91,28928
MA v[48:51],v[28:31],a[108:111],v[48:51]
RT v[26:27],v91,29952
WL 4
MA v[52:55],v[32:35],a[104:107],v[52:55]
RT v[28:29],v91,29184
MA v[56:59],v[32:35],a[108:111],v[56:59]
RT v[30:31],v91,30208
MA v[60:63],v[16:19],a[104:107],v[60:63]
RT v[32:33],v91,29440
MA v[64:67],v[16:19],a[108:111],v[64:67]
RT v[34:35],v91,30464
s_waitcnt vmcnt(46)
WL 4
MA v[36:39],v[20:23],a[112:115],v[36:39]
RT v[16:17],v91,30720
MA v[40:43],v[20:23],a[116:119],v[40:43]
RT v[18:19],v91,31744
MA v[44:47],v[24:27],a[112:115],v[44:47]
RT v[20:21],v91,30976
MA v[48:51],v[24:27],a[116:119],v[48:51]
RT v[22:23],v91,32000
WL 4
MA v[52:55],v[28:31],a[112:115],v[52:55]
RT v[24:25],v91,31232
MA v[56:59],v[28:31],a[116:119],v[56:59]
RT v[26:27],v91,32256
MA v[60:63],v[32:35],a[112:115],v[60:63]
RT v[28:29],v91,31488
MA v[64:67],v[32:35],a[116:119],v[64:67]
RT v[30:31],v91,32512
s_waitcnt vmcnt(44)
WL 4
MA v[36:39],v[16:19],a[120:123],v[36:39]
RT v[32:33],v91,32768
MA v[40:43],v[16:19],a[124:127],v[40:43]
RT v[34:35],v91,33792
MA v[44:47],v[20:23],a[120:123],v[44:47]
RT v[16:17],v91,33024
MA v[48:51],v[20:23],a[124:127],v[48:51]
RT v[18:19],v91,34048
WL 4
MA v[52:55],v[24:27],a[120:123],v[52:55]
RT v[20:21],v91,33280
MA v[56:59],v[24:27],a[124:127],v[56:59]
RT v[22:23],v91,34304
MA v[60:63],v[28:31],a[120:123],v[60:63]
RT v[24:25],v91,33536
MA v[64:67],v[28:31],a[124:127],v[64:67]
RT v[26:27],v91,34560
s_waitcnt vmcnt(42)
WL 4
MA v[36:39],v[32:35],a[128:131],v[36:39]
RT v[28:29],v91,34816
MA v[40:43],v[32:35],a[132:135],v[40:43]
RT v[30:31],v91,35840
MA v[44:47],v[16:19],a[128:131],v[44:47]
RT v[32:33],v91,35072
MA v[48:51],v[16:19],a[132:135],v[48:51]
RT v[34:35],v91,36096
WL 4
MA v[52:55],v[20:23],a[128:131],v[52:55]
RT v[16:17],v91,35328
MA v[56:59],v[20:23],a[132:135],v[56:59]
RT v[18:19],v91,36352
MA v[60:63],v[24:27],a[128:131],v[60:63]
RT v[20:21],v91,35584
MA v[64:67],v[24:27],a[132:135],v[64:67]
RT v[22:23],v91,36608
s_waitcnt vmcnt(40)
WL 4
MA v[36:39],v[28:31],a[136:139],v[36:39]
MA v[40:43],v[28:31],a[140:143],v[40:43]
MA v[44:47],v[32:35],a[136:139],v[44:47]
MA v[48:51],v[32:35],a[140:143],v[48:51]
WL 0
MA v[52:55],v[16:19],a[136:139],v[52:55]
MA v[56:59],v[16:19],a[140:143],v[56:59]
MA v[60:63],v[20:23],a[136:139],v[60:63]
MA v[64:67],v[20:23],a[140:143],v[64:67]
s_waitcnt vmcnt(32)
s_nop 7
v_dot2c_f32_bf16 v36,s70,v68
v_dot2c_f32_bf16 v37,s71,v68
v_dot2c_f32_bf16 v38,s70,v69
v_dot2c_f32_bf16 v39,s71,v69
v_dot2c_f32_bf16 v40,s70,v70
v_dot2c_f32_bf16 v41,s71,v70
v_dot2c_f32_bf16 v42,s70,v71
v_dot2c_f32_bf16 v43,s71,v71
v_dot2c_f32_bf16 v44,s70,v72
v_dot2c_f32_bf16 v45,s71,v72
v_dot2c_f32_bf16 v46,s70,v73
v_dot2c_f32_bf16 v47,s71,v73
v_dot2c_f32_bf16 v48,s70,v74
v_dot2c_f32_bf16 v49,s71,v74
v_dot2c_f32_bf16 v50,s70,v75
v_dot2c_f32_bf16 v51,s71,v75
v_dot2c_f32_bf16 v52,s70,v76
v_dot2c_f32_bf16 v53,s71,v76
v_dot2c_f32_bf16 v54,s70,v77
v_dot2c_f32_bf16 v55,s71,v77
v_dot2c_f32_bf16 v56,s70,v78
v_dot2c_f32_bf16 v57,s71,v78
v_dot2c_f32_bf16 v58,s70,v79
v_dot2c_f32_bf16 v59,s71,v79
v_dot2c_f32_bf16 v60,s70,v80
v_dot2c_f32_bf16 v61,s71,v80
v_dot2c_f32_bf16 v62,s70,v81
v_dot2c_f32_bf16 v63,s71,v81
v_dot2c_f32_bf16 v64,s70,v82
v_dot2c_f32_bf16 v65,s71,v82
v_dot2c_f32_bf16 v66,s70,v83
v_dot2c_f32_bf16 v67,s71,v83
s_waitcnt vmcnt(28)
v_dot2c_f32_bf16 v36,s70,v104
v_dot2c_f32_bf16 v37,s71,v104
v_dot2c_f32_bf16 v38,s70,v105
v_dot2c_f32_bf16 v39,s71,v105
v_dot2c_f32_bf16 v40,s70,v106
v_dot2c_f32_bf16 v41,s71,v106
v_dot2c_f32_bf16 v42,s70,v107
v_dot2c_f32_bf16 v43,s71,v107
v_dot2c_f32_bf16 v44,s70,v108
v_dot2c_f32_bf16 v45,s71,v108
v_dot2c_f32_bf16 v46,s70,v109
v_dot2c_f32_bf16 v47,s71,v109
v_dot2c_f32_bf16 v48,s70,v110
v_dot2c_f32_bf16 v49,s71,v110
v_dot2c_f32_bf16 v50,s70,v111
v_dot2c_f32_bf16 v51,s71,v111
v_dot2c_f32_bf16 v52,s70,v112
v_dot2c_f32_bf16 v53,s71,v112
v_dot2c_f32_bf16 v54,s70,v113
v_dot2c_f32_bf16 v55,s71,v113
v_dot2c_f32_bf16 v56,s70,v114
v_dot2c_f32_bf16 v57,s71,v114
v_dot2c_f32_bf16 v58,s70,v115
v_dot2c_f32_bf16 v59,s71,v115
v_dot2c_f32_bf16 v60,s70,v116
v_dot2c_f32_bf16 v61,s71,v116
v_dot2c_f32_bf16 v62,s70,v117
v_dot2c_f32_bf16 v63,s71,v117
v_dot2c_f32_bf16 v64,s70,v118
v_dot2c_f32_bf16 v65,s71,v118
v_dot2c_f32_bf16 v66,s70,v119
v_dot2c_f32_bf16 v67,s71,v119
s_waitcnt vmcnt(24)
v_dot2c_f32_bf16 v36,s70,v120
v_dot2c_f32_bf16 v37,s71,v120
v_dot2c_f32_bf16 v38,s70,v121
v_dot2c_f32_bf16 v39,s71,v121
v_dot2c_f32_bf16 v40,s70,v122
v_dot2c_f32_bf16 v41,s71,v122
v_dot2c_f32_bf16 v42,s70,v123
v_dot2c_f32_bf16 v43,s71,v123
v_dot2c_f32_bf16 v44,s70,v124
v_dot2c_f32_bf16 v45,s71,v124
v_dot2c_f32_bf16 v46,s70,v125
v_dot2c_f32_bf16 v47,s71,v125
v_dot2c_f32_bf16 v48,s70,v126
v_dot2c_f32_bf16 v49,s71,v126
v_dot2c_f32_bf16 v50,s70,v127
v_dot2c_f32_bf16 v51,s71,v127
v_dot2c_f32_bf16 v52,s70,v128
v_dot2c_f32_bf16 v53,s71,v128
v_dot2c_f32_bf16 v54,s70,v129
v_dot2c_f32_bf16 v55,s71,v129
v_dot2c_f32_bf16 v56,s70,v130
v_dot2c_f32_bf16 v57,s71,v130
v_dot2c_f32_bf16 v58,s70,v131
v_dot2c_f32_bf16 v59,s71,v131
v_dot2c_f32_bf16 v60,s70,v132
v_dot2c_f32_bf16 v61,s71,v132
v_dot2c_f32_bf16 v62,s70,v133
v_dot2c_f32_bf16 v63,s71,v133
v_dot2c_f32_bf16 v64,s70,v134
v_dot2c_f32_bf16 v65,s71,v134
v_dot2c_f32_bf16 v66,s70,v135
v_dot2c_f32_bf16 v67,s71,v135
s_waitcnt vmcnt(20)
v_dot2c_f32_bf16 v36,s70,v136
v_dot2c_f32_bf16 v37,s71,v136
v_dot2c_f32_bf16 v38,s70,v137
v_dot2c_f32_bf16 v39,s71,v137
v_dot2c_f32_bf16 v40,s70,v138
v_dot2c_f32_bf16 v41,s71,v138
v_dot2c_f32_bf16 v42,s70,v139
v_dot2c_f32_bf16 v43,s71,v139
v_dot2c_f32_bf16 v44,s70,v140
v_dot2c_f32_bf16 v45,s71,v140
v_dot2c_f32_bf16 v46,s70,v141
v_dot2c_f32_bf16 v47,s71,v141
v_dot2c_f32_bf16 v48,s70,v142
v_dot2c_f32_bf16 v49,s71,v142
v_dot2c_f32_bf16 v50,s70,v143
v_dot2c_f32_bf16 v51,s71,v143
v_dot2c_f32_bf16 v52,s70,v144
v_dot2c_f32_bf16 v53,s71,v144
v_dot2c_f32_bf16 v54,s70,v145
v_dot2c_f32_bf16 v55,s71,v145
v_dot2c_f32_bf16 v56,s70,v146
v_dot2c_f32_bf16 v57,s71,v146
v_dot2c_f32_bf16 v58,s70,v147
v_dot2c_f32_bf16 v59,s71,v147
v_dot2c_f32_bf16 v60,s70,v148
v_dot2c_f32_bf16 v61,s71,v148
v_dot2c_f32_bf16 v62,s70,v149
v_dot2c_f32_bf16 v63,s71,v149
v_dot2c_f32_bf16 v64,s70,v150
v_dot2c_f32_bf16 v65,s71,v150
v_dot2c_f32_bf16 v66,s70,v151
v_dot2c_f32_bf16 v67,s71,v151
s_waitcnt vmcnt(16)
v_dot2c_f32_bf16 v36,s70,v152
v_dot2c_f32_bf16 v37,s71,v152
v_dot2c_f32_bf16 v38,s70,v153
v_dot2c_f32_bf16 v39,s71,v153
v_dot2c_f32_bf16 v40,s70,v154
v_dot2c_f32_bf16 v41,s71,v154
v_dot2c_f32_bf16 v42,s70,v155
v_dot2c_f32_bf16 v43,s71,v155
v_dot2c_f32_bf16 v44,s70,v156
v_dot2c_f32_bf16 v45,s71,v156
v_dot2c_f32_bf16 v46,s70,v157
v_dot2c_f32_bf16 v47,s71,v157
v_dot2c_f32_bf16 v48,s70,v158
v_dot2c_f32_bf16 v49,s71,v158
v_dot2c_f32_bf16 v50,s70,v159
v_dot2c_f32_bf16 v51,s71,v159
v_dot2c_f32_bf16 v52,s70,v160
v_dot2c_f32_bf16 v53,s71,v160
v_dot2c_f32_bf16 v54,s70,v161
v_dot2c_f32_bf16 v55,s71,v161
v_dot2c_f32_bf16 v56,s70,v162
v_dot2c_f32_bf16 v57,s71,v162
v_dot2c_f32_bf16 v58,s70,v163
v_dot2c_f32_bf16 v59,s71,v163
v_dot2c_f32_bf16 v60,s70,v164
v_dot2c_f32_bf16 v61,s71,v164
v_dot2c_f32_bf16 v62,s70,v165
v_dot2c_f32_bf16 v63,s71,v165
v_dot2c_f32_bf16 v64,s70,v166
v_dot2c_f32_bf16 v65,s71,v166
v_dot2c_f32_bf16 v66,s70,v167
v_dot2c_f32_bf16 v67,s71,v167
s_waitcnt vmcnt(12)
v_dot2c_f32_bf16 v36,s70,v168
v_dot2c_f32_bf16 v37,s71,v168
v_dot2c_f32_bf16 v38,s70,v169
v_dot2c_f32_bf16 v39,s71,v169
v_dot2c_f32_bf16 v40,s70,v170
v_dot2c_f32_bf16 v41,s71,v170
v_dot2c_f32_bf16 v42,s70,v171
v_dot2c_f32_bf16 v43,s71,v171
v_dot2c_f32_bf16 v44,s70,v172
v_dot2c_f32_bf16 v45,s71,v172
v_dot2c_f32_bf16 v46,s70,v173
v_dot2c_f32_bf16 v47,s71,v173
v_dot2c_f32_bf16 v48,s70,v174
v_dot2c_f32_bf16 v49,s71,v174
v_dot2c_f32_bf16 v50,s70,v175
v_dot2c_f32_bf16 v51,s71,v175
v_dot2c_f32_bf16 v52,s70,v176
v_dot2c_f32_bf16 v53,s71,v176
v_dot2c_f32_bf16 v54,s70,v177
v_dot2c_f32_bf16 v55,s71,v177
v_dot2c_f32_bf16 v56,s70,v178
v_dot2c_f32_bf16 v57,s71,v178
v_dot2c_f32_bf16 v58,s70,v179
v_dot2c_f32_bf16 v59,s71,v179
v_dot2c_f32_bf16 v60,s70,v180
v_dot2c_f32_bf16 v61,s71,v180
v_dot2c_f32_bf16 v62,s70,v181
v_dot2c_f32_bf16 v63,s71,v181
v_dot2c_f32_bf16 v64,s70,v182
v_dot2c_f32_bf16 v65,s71,v182
v_dot2c_f32_bf16 v66,s70,v183
v_dot2c_f32_bf16 v67,s71,v183
s_waitcnt vmcnt(8)
v_dot2c_f32_bf16 v36,s70,v184
v_dot2c_f32_bf16 v37,s71,v184
v_dot2c_f32_bf16 v38,s70,v185
v_dot2c_f32_bf16 v39,s71,v185
v_dot2c_f32_bf16 v40,s70,v186
v_dot2c_f32_bf16 v41,s71,v186
v_dot2c_f32_bf16 v42,s70,v187
v_dot2c_f32_bf16 v43,s71,v187
v_dot2c_f32_bf16 v44,s70,v188
v_dot2c_f32_bf16 v45,s71,v188
v_dot2c_f32_bf16 v46,s70,v189
v_dot2c_f32_bf16 v47,s71,v189
v_dot2c_f32_bf16 v48,s70,v190
v_dot2c_f32_bf16 v49,s71,v190
v_dot2c_f32_bf16 v50,s70,v191
v_dot2c_f32_bf16 v51,s71,v191
v_dot2c_f32_bf16 v52,s70,v192
v_dot2c_f32_bf16 v53,s71,v192
v_dot2c_f32_bf16 v54,s70,v193
v_dot2c_f32_bf16 v55,s71,v193
v_dot2c_f32_bf16 v56,s70,v194
v_dot2c_f32_bf16 v57,s71,v194
v_dot2c_f32_bf16 v58,s70,v195
v_dot2c_f32_bf16 v59,s71,v195
v_dot2c_f32_bf16 v60,s70,v196
v_dot2c_f32_bf16 v61,s71,v196
v_dot2c_f32_bf16 v62,s70,v197
v_dot2c_f32_bf16 v63,s71,v197
v_dot2c_f32_bf16 v64,s70,v198
v_dot2c_f32_bf16 v65,s71,v198
v_dot2c_f32_bf16 v66,s70,v199
v_dot2c_f32_bf16 v67,s71,v199
s_waitcnt vmcnt(4)
v_dot2c_f32_bf16 v36,s70,v200
v_dot2c_f32_bf16 v37,s71,v200
v_dot2c_f32_bf16 v38,s70,v201
v_dot2c_f32_bf16 v39,s71,v201
v_dot2c_f32_bf16 v40,s70,v202
v_dot2c_f32_bf16 v41,s71,v202
v_dot2c_f32_bf16 v42,s70,v203
v_dot2c_f32_bf16 v43,s71,v203
v_dot2c_f32_bf16 v44,s70,v204
v_dot2c_f32_bf16 v45,s71,v204
v_dot2c_f32_bf16 v46,s70,v205
v_dot2c_f32_bf16 v47,s71,v205
v_dot2c_f32_bf16 v48,s70,v206
v_dot2c_f32_bf16 v49,s71,v206
v_dot2c_f32_bf16 v50,s70,v207
v_dot2c_f32_bf16 v51,s71,v207
v_dot2c_f32_bf16 v52,s70,v208
v_dot2c_f32_bf16 v53,s71,v208
v_dot2c_f32_bf16 v54,s70,v209
v_dot2c_f32_bf16 v55,s71,v209
v_dot2c_f32_bf16 v56,s70,v210
v_dot2c_f32_bf16 v57,s71,v210
v_dot2c_f32_bf16 v58,s70,v211
v_dot2c_f32_bf16 v59,s71,v211
v_dot2c_f32_bf16 v60,s70,v212
v_dot2c_f32_bf16 v61,s71,v212
v_dot2c_f32_bf16 v62,s70,v213
v_dot2c_f32_bf16 v63,s71,v213
v_dot2c_f32_bf16 v64,s70,v214
v_dot2c_f32_bf16 v65,s71,v214
v_dot2c_f32_bf16 v66,s70,v215
v_dot2c_f32_bf16 v67,s71,v215
s_waitcnt vmcnt(0)
v_dot2c_f32_bf16 v36,s70,v216
v_dot2c_f32_bf16 v37,s71,v216
v_dot2c_f32_bf16 v38,s70,v217
v_dot2c_f32_bf16 v39,s71,v217
v_dot2c_f32_bf16 v40,s70,v218
v_dot2c_f32_bf16 v41,s71,v218
v_dot2c_f32_bf16 v42,s70,v219
v_dot2c_f32_bf16 v43,s71,v219
v_dot2c_f32_bf16 v44,s70,v220
v_dot2c_f32_bf16 v45,s71,v220
v_dot2c_f32_bf16 v46,s70,v221
v_dot2c_f32_bf16 v47,s71,v221
v_dot2c_f32_bf16 v48,s70,v222
v_dot2c_f32_bf16 v49,s71,v222
v_dot2c_f32_bf16 v50,s70,v223
v_dot2c_f32_bf16 v51,s71,v223
v_dot2c_f32_bf16 v52,s70,v224
v_dot2c_f32_bf16 v53,s71,v224
v_dot2c_f32_bf16 v54,s70,v225
v_dot2c_f32_bf16 v55,s71,v225
v_dot2c_f32_bf16 v56,s70,v226
v_dot2c_f32_bf16 v57,s71,v226
v_dot2c_f32_bf16 v58,s70,v227
v_dot2c_f32_bf16 v59,s71,v227
v_dot2c_f32_bf16 v60,s70,v228
v_dot2c_f32_bf16 v61,s71,v228
v_dot2c_f32_bf16 v62,s70,v229
v_dot2c_f32_bf16 v63,s71,v229
v_dot2c_f32_bf16 v64,s70,v230
v_dot2c_f32_bf16 v65,s71,v230
v_dot2c_f32_bf16 v66,s70,v231
v_dot2c_f32_bf16 v67,s71,v231
s_add_u32 s91,s69,18432
s_nop 1
CV v16,v36,v37
CV v17,v38,v39
CV v18,v44,v45
CV v19,v46,v47
s_nop 1
v_permlane16_swap_b32 v16,v18
v_permlane16_swap_b32 v17,v19
buffer_store_dwordx4 v[16:19],v98,s[32:35],s69 offen offset:0
CV v20,v40,v41
CV v21,v42,v43
CV v22,v48,v49
CV v23,v50,v51
s_nop 1
v_permlane16_swap_b32 v20,v22
v_permlane16_swap_b32 v21,v23
buffer_store_dwordx4 v[20:23],v98,s[32:35],s91 offen offset:0
CV v24,v52,v53
CV v25,v54,v55
CV v26,v60,v61
CV v27,v62,v63
s_nop 1
v_permlane16_swap_b32 v24,v26
v_permlane16_swap_b32 v25,v27
buffer_store_dwordx4 v[24:27],v98,s[32:35],s69 offen offset:64
CV v28,v56,v57
CV v29,v58,v59
CV v30,v64,v65
CV v31,v66,v67
s_nop 1
v_permlane16_swap_b32 v28,v30
v_permlane16_swap_b32 v29,v31
buffer_store_dwordx4 v[28:31],v98,s[32:35],s91 offen offset:64
s_endpgm
L_code_end:
s_endpgm
.section .rodata,"a"
.p2align 6
.amdhsa_kernel parallel_sum__softmax_full_mha__glu_gated_geglu__prompt_kernel
  .amdhsa_next_free_vgpr 512
  .amdhsa_next_free_sgpr 102
  .amdhsa_accum_offset 256
  .amdhsa_group_segment_fixed_size 0
  .amdhsa_kernarg_size 80
  .amdhsa_user_sgpr_count 2
  .amdhsa_user_sgpr_kernarg_segment_ptr 1
  .amdhsa_system_sgpr_workgroup_id_x 1
  .amdhsa_float_denorm_mode_32 3
.end_amdhsa_kernel
```
